```python
import torch

def _softmax(x, axis=-1):
    return torch.softmax(x, dim=axis)
def _gelu(x):
    return torch.nn.functional.gelu(x, approximate="tanh")
def _silu(x):
    return torch.nn.functional.silu(x)
def _sigmoid(x):
    return torch.sigmoid(x)
def _layernorm(x, axis=-1, eps=1e-5):
    m = x.mean(dim=axis, keepdim=True)
    v = x.var(dim=axis, keepdim=True, unbiased=False)
    return (x - m) / torch.sqrt(v + eps)
def _scatter_add(tgt, idx, src, axis=0):
    return tgt.clone().index_add_(axis, idx, src)
def _segment_sum(src, seg, n):
    out = torch.zeros((n,) + src.shape[1:], dtype=src.dtype)
    return out.index_add_(0, seg, src)
def _pad(x, pw):
    flat = tuple(v for pair in reversed(pw) for v in pair)
    return torch.nn.functional.pad(x, flat)

kernel_name = 'recurrent_scan__sliding_local_dilated__glu_gated_reglu__prompt'

def setup_inputs():

    _w = (lambda a: (lambda t: t.to(torch.bfloat16) if t.is_floating_point() else t)(torch.as_tensor(a)))
    def _A_setup():
        B, S, D = 1, 2048, 512
        return {
            "x": _w((lambda *s: torch.randn(*s, dtype=torch.bfloat16) * 0.05)(B, S, D)),
            "wqkv": _w((lambda *s: torch.randn(*s, dtype=torch.bfloat16) * 0.2)(D, 3 * D)),
            "wo": _w((lambda *s: torch.randn(*s, dtype=torch.bfloat16) * 0.2)(D, D)),
        }
    _A_in = _A_setup()

    def _B_setup():
        B, S, D, F = 1, 2048, 512, 1792
        return {
            "x": _w((lambda *s: torch.randn(*s, dtype=torch.bfloat16) * 0.05)(B, S, D)),
            "W_gate": _w((lambda *s: torch.randn(*s, dtype=torch.bfloat16) * 0.1)(D, F) * (2.0 / D) ** 0.5),
            "W_up": _w((lambda *s: torch.randn(*s, dtype=torch.bfloat16) * 0.1)(D, F) * (2.0 / D) ** 0.5),
            "W_down": _w((lambda *s: torch.randn(*s, dtype=torch.bfloat16) * 0.1)(F, D) * (1.0 / F) ** 0.5),
        }
    _B_in = _B_setup()

    return {
        "A_x": _A_in["x"],
        "A_wqkv": _A_in["wqkv"],
        "A_wo": _A_in["wo"],
        "B_x": _B_in["x"],
        "B_W_gate": _B_in["W_gate"],
        "B_W_up": _B_in["W_up"],
        "B_W_down": _B_in["W_down"],
    }

def reference(A_x, A_wqkv, A_wo, B_x, B_W_gate, B_W_up, B_W_down):
    def _A_ref(x, wqkv, wo):
        B, S, D = x.shape
        H = 32; Dh = D // H
        W, dil = 8, 2
        qkv = (lambda x, *d: x.permute(*d))((x @ wqkv).reshape(B, S, 3, H, Dh), 2, 0, 3, 1, 4)
        q, k, v = qkv[0], qkv[1], qkv[2]
        scale = Dh ** -0.5
        pos = torch.arange(S)
        off = torch.arange(W) * dil
        idx = pos[:, None] - off[None, :]
        mask = idx >= 0
        idx_c = torch.where(mask, idx, 0).reshape(-1)
        kg = k[:, :, idx_c, :].reshape(B, H, S, W, Dh)
        vg = v[:, :, idx_c, :].reshape(B, H, S, W, Dh)
        logits = torch.einsum("bhsd,bhswd->bhsw", q, kg) * scale
        logits = torch.where(mask[None, None, :, :], logits, -1e9)
        attn = _softmax(logits, axis=-1)
        o = torch.einsum("bhsw,bhswd->bhsd", attn, vg)
        return (lambda x, *d: x.permute(*d))(o, 0, 2, 1, 3).reshape(B, S, D) @ wo

    def _B_ref(x, W_gate, W_up, W_down):
        gate = torch.einsum("bsd,df->bsf", x, W_gate)
        up = torch.einsum("bsd,df->bsf", x, W_up)
        gate = gate * (lambda x, dt: x.to(dt))(gate > 0, gate.dtype)
        h = gate * up
        return torch.einsum("bsf,fd->bsd", h, W_down)

    x = A_x
    xn = _layernorm(x, axis=-1)
    s = _A_ref(xn, A_wqkv, A_wo)
    g = _silu(_B_ref(xn, B_W_gate, B_W_up, B_W_down))
    return x + s * g
```

```asm
; @launch grid=(256,1,1) block=(512,1,1) lds=163840
.amdgcn_target "amdgcn-amd-amdhsa--gfx950"
.text
.globl recurrent_scan__sliding_local_dilated__glu_gated_reglu__prompt_kernel
.p2align 8
.type recurrent_scan__sliding_local_dilated__glu_gated_reglu__prompt_kernel,@function
recurrent_scan__sliding_local_dilated__glu_gated_reglu__prompt_kernel:
s_cmp_ge_u32 s2, 256
s_cbranch_scc1 L_end
s_load_dwordx16 s[64:79], s[0:1], 0
s_load_dwordx4 s[80:83], s[0:1], 64
s_memrealtime s[98:99]
s_getpc_b64 s[48:49]
L_pc:
v_lshlrev_b32 v232, 7, v0
v_lshrrev_b32 v233, 6, v0
v_min_u32 v232, L_end-L_pc, v232
v_readfirstlane_b32 s40, v233
global_load_dword v225, v232, s[48:49]
v_and_b32 v167, 63, v0
v_bfe_u32 v232, v0, 3, 3
v_and_b32 v233, 7, v0
v_lshrrev_b32 v234, 1, v232
v_xor_b32 v234, v234, v233
v_lshlrev_b32 v234, 4, v234
v_lshl_add_u32 v222, v232, 10, v234
s_and_b32 s41, s40, 3
s_lshr_b32 s42, s40, 2
s_lshr_b32 s45, s2, 5
s_lshl_b32 s45, s45, 1
s_and_b32 s46, s2, 1
s_add_u32 s43, s45, s46
s_and_b32 s45, s2, 6
s_bfe_u32 s46, s2, 0x10003
s_add_u32 s44, s45, s46
s_lshl_b32 s45, s43, 17
s_lshl_b32 s46, s41, 14
s_add_u32 s52, s45, s46
s_lshl_b32 s56, s41, 11
s_lshl_b32 s55, s41, 10
s_mov_b32 s6, 0x200000
s_mov_b32 s7, 0x00020000
v_xor_b32 v223, 64, v222
v_add_u32 v223, 8192, v223
v_and_b32 v234, 6, v232
v_xor_b32 v233, v233, v234
v_and_b32 v234, 4, v232
v_add_u32 v232, v232, v234
v_lshlrev_b32 v233, 4, v233
v_lshl_add_u32 v168, v232, 10, v233
s_and_b32 s47, s41, 2
s_lshl_b32 s47, s47, 3
s_and_b32 s48, s41, 1
s_lshl_b32 s48, s48, 2
s_add_u32 s47, s47, s48
v_add_u32 v232, s47, v232
s_mov_b32 s11, 0x00020000
s_mov_b32 s10, 1835008
s_mov_b32 s15, 0x00020000
s_mov_b32 s14, 1835008
s_mov_b32 s19, 0x00020000
s_mov_b32 s18, 1835008
s_add_u32 s53, s52, 0x10000
s_bitcmp1_b32 s2, 4
s_cbranch_scc1 L_t2
s_cmp_lg_u32 s42, 0
s_cbranch_scc1 L_t1m1
s_lshr_b32 s46, s2, 5
s_mul_i32 s0, s46, 3072
s_lshl_b32 s46, s44, 7
s_add_u32 s0, s0, s46
s_add_u32 s0, s0, s55
s_add_u32 s0, s0, 196608
s_mov_b32 s1, 196608
s_mov_b32 s20, 0xff
s_mov_b32 s21, 1572864
v_mul_u32_u24 v247, 24576, v167
s_cmp_lt_u32 s41, 3
s_cbranch_scc1 L_pf10
s_bfe_u32 s46, s2, 0x20003
s_lshl_b32 s49, s43, 2
s_add_u32 s49, s49, s46
s_lshl_b32 s49, s49, 5
v_add_u32 v247, s49, v167
v_lshlrev_b32 v247, 10, v247
s_mov_b32 s0, 128
s_mov_b32 s1, 128
s_mov_b32 s20, 0x3fff
s_mov_b32 s21, 0x200000
L_pf10:
v_mul_u32_u24 v220, 3072, v232
v_add_u32 v220, v220, v233
s_lshl_b32 s50, s44, 7
s_mov_b32 s10, 1572864
v_bfe_u32 v234, v167, 3, 2
v_bfe_u32 v235, v167, 4, 1
s_lshl_b32 s46, s41, 1
v_add_u32 v235, s46, v235
v_and_b32 v236, 7, v167
v_xor_b32 v235, v235, v236
v_lshlrev_b32 v235, 4, v235
v_lshl_add_u32 v224, v234, 10, v235
s_max_u32 s45, s45, 0x4000
s_sub_u32 s45, s45, 0x4000
s_lshl_b32 s46, s41, 12
s_add_u32 s54, s45, s46
s_lshl_b32 s57, s41, 9
s_waitcnt lgkmcnt(0)
s_mov_b64 s[4:5], s[64:65]
s_mov_b64 s[8:9], s[66:67]
s_mov_b32 s70, s20
s_mov_b32 s71, 0
s_mov_b64 s[72:73], s[66:67]
s_cmp_lt_u32 s41, 3
s_cselect_b64 s[72:73], s[72:73], s[64:65]
s_mov_b32 s74, s21
s_mov_b32 s75, 0x00020000
s_mov_b64 exec, s[70:71]
buffer_load_dword v225, v247, s[72:75], s0 offen
s_mov_b64 exec, -1
s_add_u32 s0, s0, s1
s_add_u32 m0, s56, 118784
s_nop 0
buffer_load_dwordx4 v222, s[4:7], s52 offen offset:0 lds
s_add_u32 m0, s57, 153600
s_mov_b32 exec_hi, 0
buffer_load_dwordx4 v224, s[4:7], s54 offen offset:0 lds
s_mov_b32 exec_hi, -1
s_add_u32 m0, s55, 81920
s_nop 0
buffer_load_dwordx4 v220, s[8:11], s50 offen offset:0 lds
s_add_u32 m0, s55, 84992
s_nop 0
buffer_load_dwordx4 v220, s[8:11], s50 offen offset:1024 lds
s_add_u32 m0, s55, 88064
s_nop 0
buffer_load_dwordx4 v220, s[8:11], s50 offen offset:2048 lds
s_add_u32 s50, s50, 98304
s_add_u32 m0, s55, 0
s_nop 0
buffer_load_dwordx4 v220, s[8:11], s50 offen offset:0 lds
s_add_u32 m0, s55, 3072
s_nop 0
buffer_load_dwordx4 v220, s[8:11], s50 offen offset:1024 lds
s_add_u32 m0, s55, 6144
s_nop 0
buffer_load_dwordx4 v220, s[8:11], s50 offen offset:2048 lds
s_add_u32 s50, s50, 98304
s_mov_b64 exec, s[70:71]
buffer_load_dword v225, v247, s[72:75], s0 offen
s_mov_b64 exec, -1
s_add_u32 s0, s0, s1
s_add_u32 m0, s56, 135040
s_nop 0
buffer_load_dwordx4 v222, s[4:7], s52 offen offset:128 lds
s_add_u32 m0, s57, 155520
s_mov_b32 exec_hi, 0
buffer_load_dwordx4 v224, s[4:7], s54 offen offset:128 lds
s_mov_b32 exec_hi, -1
s_add_u32 m0, s55, 20480
s_nop 0
buffer_load_dwordx4 v220, s[8:11], s50 offen offset:0 lds
s_add_u32 m0, s55, 23552
s_nop 0
buffer_load_dwordx4 v220, s[8:11], s50 offen offset:1024 lds
s_add_u32 m0, s55, 26624
s_nop 0
buffer_load_dwordx4 v220, s[8:11], s50 offen offset:2048 lds
s_add_u32 s50, s50, 98304
s_mov_b64 exec, s[70:71]
buffer_load_dword v225, v247, s[72:75], s0 offen
s_mov_b64 exec, -1
s_add_u32 s0, s0, s1
s_mov_b64 s[20:21], s[82:83]
s_mov_b64 s[24:25], s[80:81]
s_mov_b64 s[28:29], s[68:69]
s_mov_b64 s[32:33], s[76:77]
s_mov_b64 s[36:37], s[78:79]
s_mov_b32 s23, 0x00020000
s_mov_b32 s27, 0x00020000
s_mov_b32 s31, 0x00020000
s_mov_b32 s35, 0x00020000
s_mov_b32 s39, 0x00020000
s_mov_b32 s22, 9601024
s_mov_b32 s26, 256
s_mov_b32 s30, 524288
s_mov_b32 s34, 1835008
s_mov_b32 s38, 0x200000
s_mov_b32 s58, 0xffff0000
s_mov_b32 s60, 0xfffefffe
s_mov_b32 s61, 0xfffefffe
s_and_b32 s45, s2, 6
s_lshr_b32 s46, s2, 7
s_add_u32 s45, s45, s46
s_lshl_b32 s45, s45, 1
s_and_b32 s46, s2, 1
s_add_u32 s45, s45, s46
s_lshl_b32 s45, s45, 1
s_bfe_u32 s46, s2, 0x10006
s_add_u32 s59, s45, s46
s_bfe_u32 s62, s2, 0x30003
s_lshl_b32 s63, s40, 12
s_add_u32 s101, s40, s62
s_and_b32 s101, s101, 7
s_lshl_b32 s45, s62, 7
s_lshl_b32 s100, s40, 15
s_add_u32 s100, s100, s45
s_mul_i32 s3, s101, 163840
s_add_u32 s3, s3, 524288
s_add_u32 s3, s3, s45
v_bfe_u32 v232, v167, 2, 3
v_lshrrev_b32 v233, 5, v167
v_lshlrev_b32 v234, 11, v233
v_lshl_add_u32 v234, v232, 7, v234
v_and_b32 v235, 3, v167
v_lshl_add_u32 v234, v235, 3, v234
v_lshrrev_b32 v236, 1, v232
s_and_b32 s45, s40, 1
s_lshl_b32 s45, s45, 1
v_xor_b32 v237, s45, v236
v_add_u32 v239, s63, v234
v_xor_b32 v238, 0, v237
v_lshl_add_u32 v169, v238, 5, v239
v_xor_b32 v238, 1, v237
v_lshl_add_u32 v170, v238, 5, v239
v_xor_b32 v238, 2, v237
v_lshl_add_u32 v171, v238, 5, v239
v_xor_b32 v238, 3, v237
v_lshl_add_u32 v172, v238, 5, v239
v_xor_b32 v236, s41, v236
v_lshl_add_u32 v208, v236, 5, v234
v_add_u32 v211, 61440, v208
v_and_b32 v232, 15, v167
v_lshrrev_b32 v233, 4, v167
v_lshrrev_b32 v234, 1, v232
v_xor_b32 v233, v233, v234
v_lshlrev_b32 v233, 4, v233
v_lshl_add_u32 v233, v232, 7, v233
v_add_u32 v214, 102400, v233
v_xor_b32 v215, 64, v214
v_add_u32 v216, s56, v214
v_add_u32 v217, s56, v215
v_mov_b32 v124, 0x3f803f80
v_mov_b32 v125, 0x3f803f80
v_mov_b32 v126, 0x3f803f80
v_mov_b32 v127, 0x3f803f80
v_mov_b32 v128, 0x3f803f80
v_mov_b32 v129, 0x3f803f80
v_mov_b32 v130, 0x3f803f80
v_mov_b32 v131, 0x3f803f80
v_mov_b32 v180, 0
v_mov_b32 v181, 0
v_mov_b32 v182, 0
v_mov_b32 v183, 0
v_mov_b32 v184, 0
v_mov_b32 v185, 0
s_or_b32 s45, s41, s2
s_cmp_lg_u32 s45, 0
s_cbranch_scc1 L_tk1
s_or_b32 s98, s98, 1
v_mov_b32 v176, s98
v_mov_b32 v177, s99
s_mov_b64 exec, 1
buffer_store_dwordx2 v[176:177], off, s[24:27], 0 sc0 sc1
s_mov_b64 exec, -1
L_tk1:
v_lshrrev_b32 v226, 3, v167
v_lshlrev_b32 v226, 15, v226
v_and_b32 v227, 7, v167
v_lshl_add_u32 v226, v227, 10, v226
s_lshr_b32 s45, s2, 6
s_lshl_b32 s45, s45, 13
v_add_u32 v226, s45, v226
v_and_b32 v227, 8, v167
v_mul_u32_u24 v227, 28672, v227
v_add3_u32 v227, v227, v226, s100
s_lshl_b32 s45, s101, 16
s_lshl_b32 s46, s62, 7
s_add_u32 s45, s45, s46
s_sub_u32 s45, s45, 163840
v_add_u32 v233, s45, v226
v_add_u32 v226, s3, v226
v_cmp_lt_u32 vcc, 39, v167
s_nop 1
v_cndmask_b32 v226, v226, v233, vcc
v_lshlrev_b32 v164, 4, v167
v_and_b32 v232, 0xf0, v164
v_bfe_u32 v233, v167, 4, 1
v_lshrrev_b32 v234, 5, v167
v_lshl_add_u32 v235, v233, 1, v234
v_lshlrev_b32 v165, 6, v232
v_lshl_add_u32 v165, v235, 4, v165
v_mov_b32 v174, 160512
v_lshrrev_b32 v244, 1, v232
v_add_u32 v244, 157696, v244
s_lshl_b32 s45, s41, 7
v_add_u32 v245, s45, v244
v_and_b32 v246, 0x30, v167
s_mul_i32 s45, s41, 320
s_add_u32 s45, s45, 159232
v_mul_u32_u24 v240, 73728, v233
v_lshl_add_u32 v240, v234, 8, v240
v_add_u32 v240, v240, v232
s_mul_i32 s46, s41, 4608
s_add_u32 s46, s46, 135168
v_lshrrev_b32 v241, 1, v246
v_lshl_add_u32 v241, v232, 1, v241
v_add_u32 v241, s46, v241
v_lshlrev_b32 v243, 3, v167
v_add_u32 v242, s46, v243
s_lshl_b32 s46, s41, 9
s_add_u32 s46, s46, 153600
v_add_u32 v243, s46, v243
v_add_u32 v246, s45, v246
s_waitcnt vmcnt(10)
s_waitcnt lgkmcnt(0)
s_barrier
ds_read_b128 v[92:95], v214 offset:16384
ds_read_b128 v[96:99], v214 offset:18432
ds_read_b128 v[100:103], v214 offset:20480
ds_read_b128 v[104:107], v214 offset:22528
ds_read_b64_tr_b16 v[132:133], v211 offset:20480
ds_read_b64_tr_b16 v[134:135], v211 offset:21504
s_mov_b64 exec, s[60:61]
ds_read_b128 v[124:127], v214 offset:51200
s_mov_b64 exec, -1
ds_read_b64_tr_b16 v[136:137], v211 offset:24576
ds_read_b64_tr_b16 v[138:139], v211 offset:25600
ds_read_b64_tr_b16 v[140:141], v211 offset:28672
ds_read_b64_tr_b16 v[142:143], v211 offset:29696
ds_read_b64_tr_b16 v[144:145], v211 offset:32768
ds_read_b64_tr_b16 v[146:147], v211 offset:33792
ds_read_b64_tr_b16 v[148:149], v211 offset:36864
ds_read_b64_tr_b16 v[150:151], v211 offset:37888
ds_read_b128 v[248:251], v216 offset:16384
s_waitcnt lgkmcnt(10)
v_mfma_f32_16x16x32_bf16 v[0:3], v[132:135], v[92:95], 0
v_mfma_f32_16x16x32_bf16 v[4:7], v[132:135], v[96:99], 0
v_mfma_f32_16x16x32_bf16 v[8:11], v[132:135], v[100:103], 0
v_mfma_f32_16x16x32_bf16 v[12:15], v[132:135], v[104:107], 0
s_waitcnt vmcnt(7)
s_waitcnt lgkmcnt(0)
s_barrier
ds_read_b64_tr_b16 v[132:133], v208 offset:0
ds_read_b64_tr_b16 v[134:135], v208 offset:1024
v_mfma_f32_16x16x32_bf16 v[16:19], v[136:139], v[92:95], 0
ds_read_b128 v[156:159], v217 offset:16384
ds_read_b128 v[108:111], v215 offset:16384
ds_read_b128 v[112:115], v215 offset:18432
s_add_u32 m0, s55, 40960
s_nop 0
buffer_load_dwordx4 v220, s[8:11], s50 offen offset:0 lds
v_lshlrev_b32 v192, 16, v248
v_and_b32 v193, s58, v248
v_lshlrev_b32 v194, 16, v249
v_mfma_f32_16x16x32_bf16 v[20:23], v[136:139], v[96:99], 0
ds_read_b128 v[116:119], v215 offset:20480
ds_read_b128 v[120:123], v215 offset:22528
s_mov_b64 exec, s[60:61]
ds_read_b128 v[128:131], v215 offset:51200
s_mov_b64 exec, -1
v_and_b32 v195, s58, v249
v_add_f32 v180, v180, v192
v_add_f32 v181, v181, v193
v_mfma_f32_16x16x32_bf16 v[24:27], v[136:139], v[100:103], 0
v_fmac_f32 v182, v192, v192
v_fmac_f32 v183, v193, v193
v_lshlrev_b32 v196, 16, v250
v_mfma_f32_16x16x32_bf16 v[28:31], v[136:139], v[104:107], 0
s_add_u32 m0, s55, 44032
s_nop 0
buffer_load_dwordx4 v220, s[8:11], s50 offen offset:1024 lds
v_and_b32 v197, s58, v250
v_add_f32 v180, v180, v194
v_add_f32 v181, v181, v195
s_waitcnt lgkmcnt(0)
v_mfma_f32_16x16x32_bf16 v[80:83], v[136:139], v[124:127], 0
ds_read_b64_tr_b16 v[136:137], v208 offset:4096
ds_read_b64_tr_b16 v[138:139], v208 offset:5120
v_fmac_f32 v182, v194, v194
v_fmac_f32 v183, v195, v195
v_lshlrev_b32 v198, 16, v251
v_mfma_f32_16x16x32_bf16 v[32:35], v[140:143], v[92:95], 0
v_and_b32 v199, s58, v251
v_add_f32 v180, v180, v196
v_add_f32 v181, v181, v197
v_mfma_f32_16x16x32_bf16 v[36:39], v[140:143], v[96:99], 0
s_add_u32 m0, s55, 47104
s_nop 0
buffer_load_dwordx4 v220, s[8:11], s50 offen offset:2048 lds
s_add_u32 s50, s50, 98304
v_fmac_f32 v182, v196, v196
v_fmac_f32 v183, v197, v197
v_mfma_f32_16x16x32_bf16 v[40:43], v[140:143], v[100:103], 0
v_add_f32 v180, v180, v198
v_add_f32 v181, v181, v199
v_mfma_f32_16x16x32_bf16 v[44:47], v[140:143], v[104:107], 0
v_fmac_f32 v182, v198, v198
v_fmac_f32 v183, v199, v199
v_mfma_f32_16x16x32_bf16 v[84:87], v[140:143], v[124:127], 0
ds_read_b64_tr_b16 v[140:141], v208 offset:8192
ds_read_b64_tr_b16 v[142:143], v208 offset:9216
s_add_u32 m0, s56, 102144
s_nop 0
buffer_load_dwordx4 v222, s[4:7], s52 offen offset:256 lds
v_lshlrev_b32 v192, 16, v156
v_and_b32 v193, s58, v156
v_lshlrev_b32 v194, 16, v157
v_mfma_f32_16x16x32_bf16 v[48:51], v[144:147], v[92:95], 0
v_and_b32 v195, s58, v157
v_add_f32 v180, v180, v192
v_add_f32 v181, v181, v193
v_mfma_f32_16x16x32_bf16 v[52:55], v[144:147], v[96:99], 0
v_fmac_f32 v182, v192, v192
v_fmac_f32 v183, v193, v193
v_lshlrev_b32 v196, 16, v158
v_mfma_f32_16x16x32_bf16 v[56:59], v[144:147], v[100:103], 0
s_add_u32 m0, s57, 151296
s_mov_b32 exec_hi, 0
buffer_load_dwordx4 v224, s[4:7], s54 offen offset:256 lds
s_mov_b32 exec_hi, -1
v_and_b32 v197, s58, v158
v_add_f32 v180, v180, v194
v_add_f32 v181, v181, v195
v_mfma_f32_16x16x32_bf16 v[60:63], v[144:147], v[104:107], 0
ds_read_b64_tr_b16 v[144:145], v208 offset:12288
ds_read_b64_tr_b16 v[146:147], v208 offset:13312
v_fmac_f32 v182, v194, v194
v_fmac_f32 v183, v195, v195
v_lshlrev_b32 v198, 16, v159
v_mfma_f32_16x16x32_bf16 v[64:67], v[148:151], v[92:95], 0
v_and_b32 v199, s58, v159
v_add_f32 v180, v180, v196
v_add_f32 v181, v181, v197
v_mfma_f32_16x16x32_bf16 v[68:71], v[148:151], v[96:99], 0
s_add_u32 m0, s55, 61440
s_nop 0
buffer_load_dwordx4 v220, s[8:11], s50 offen offset:0 lds
v_fmac_f32 v182, v196, v196
v_fmac_f32 v183, v197, v197
v_mfma_f32_16x16x32_bf16 v[72:75], v[148:151], v[100:103], 0
v_add_f32 v180, v180, v198
v_add_f32 v181, v181, v199
v_mfma_f32_16x16x32_bf16 v[76:79], v[148:151], v[104:107], 0
ds_read_b64_tr_b16 v[148:149], v208 offset:16384
ds_read_b64_tr_b16 v[150:151], v208 offset:17408
v_fmac_f32 v182, v198, v198
v_fmac_f32 v183, v199, v199
v_mfma_f32_16x16x32_bf16 v[0:3], v[132:135], v[108:111], v[0:3]
v_mfma_f32_16x16x32_bf16 v[4:7], v[132:135], v[112:115], v[4:7]
v_mfma_f32_16x16x32_bf16 v[8:11], v[132:135], v[116:119], v[8:11]
v_mfma_f32_16x16x32_bf16 v[12:15], v[132:135], v[120:123], v[12:15]
s_waitcnt vmcnt(7)
s_waitcnt lgkmcnt(0)
s_barrier
ds_read_b64_tr_b16 v[132:133], v208 offset:20480
ds_read_b64_tr_b16 v[134:135], v208 offset:21504
v_mfma_f32_16x16x32_bf16 v[16:19], v[136:139], v[108:111], v[16:19]
ds_read_b128 v[156:159], v216 offset:32768
ds_read_b128 v[92:95], v214 offset:32768
ds_read_b128 v[96:99], v214 offset:34816
s_add_u32 m0, s55, 64512
s_nop 0
buffer_load_dwordx4 v220, s[8:11], s50 offen offset:1024 lds
v_mfma_f32_16x16x32_bf16 v[20:23], v[136:139], v[112:115], v[20:23]
ds_read_b128 v[100:103], v214 offset:36864
ds_read_b128 v[104:107], v214 offset:38912
s_mov_b64 exec, s[60:61]
ds_read_b128 v[124:127], v214 offset:53248
s_mov_b64 exec, -1
v_mfma_f32_16x16x32_bf16 v[24:27], v[136:139], v[116:119], v[24:27]
v_mfma_f32_16x16x32_bf16 v[28:31], v[136:139], v[120:123], v[28:31]
s_add_u32 m0, s55, 67584
s_nop 0
buffer_load_dwordx4 v220, s[8:11], s50 offen offset:2048 lds
s_add_u32 s50, s50, 98304
s_waitcnt lgkmcnt(0)
v_mfma_f32_16x16x32_bf16 v[80:83], v[136:139], v[128:131], v[80:83]
ds_read_b64_tr_b16 v[136:137], v208 offset:24576
ds_read_b64_tr_b16 v[138:139], v208 offset:25600
v_mfma_f32_16x16x32_bf16 v[32:35], v[140:143], v[108:111], v[32:35]
v_lshlrev_b32 v192, 16, v156
v_and_b32 v193, s58, v156
v_mfma_f32_16x16x32_bf16 v[36:39], v[140:143], v[112:115], v[36:39]
s_add_u32 m0, s55, 81920
s_nop 0
buffer_load_dwordx4 v220, s[8:11], s50 offen offset:0 lds
v_lshlrev_b32 v194, 16, v157
v_and_b32 v195, s58, v157
v_mfma_f32_16x16x32_bf16 v[40:43], v[140:143], v[116:119], v[40:43]
v_add_f32 v180, v180, v192
v_add_f32 v181, v181, v193
v_mfma_f32_16x16x32_bf16 v[44:47], v[140:143], v[120:123], v[44:47]
v_fmac_f32 v182, v192, v192
v_fmac_f32 v183, v193, v193
v_mfma_f32_16x16x32_bf16 v[84:87], v[140:143], v[128:131], v[84:87]
ds_read_b64_tr_b16 v[140:141], v208 offset:28672
ds_read_b64_tr_b16 v[142:143], v208 offset:29696
s_add_u32 m0, s55, 84992
s_nop 0
buffer_load_dwordx4 v220, s[8:11], s50 offen offset:1024 lds
v_lshlrev_b32 v196, 16, v158
v_and_b32 v197, s58, v158
v_mfma_f32_16x16x32_bf16 v[48:51], v[144:147], v[108:111], v[48:51]
v_add_f32 v180, v180, v194
v_add_f32 v181, v181, v195
v_mfma_f32_16x16x32_bf16 v[52:55], v[144:147], v[112:115], v[52:55]
v_fmac_f32 v182, v194, v194
v_fmac_f32 v183, v195, v195
v_mfma_f32_16x16x32_bf16 v[56:59], v[144:147], v[116:119], v[56:59]
s_add_u32 m0, s55, 88064
s_nop 0
buffer_load_dwordx4 v220, s[8:11], s50 offen offset:2048 lds
s_add_u32 s50, s50, 98304
v_lshlrev_b32 v198, 16, v159
v_and_b32 v199, s58, v159
v_mfma_f32_16x16x32_bf16 v[60:63], v[144:147], v[120:123], v[60:63]
ds_read_b64_tr_b16 v[144:145], v208 offset:32768
ds_read_b64_tr_b16 v[146:147], v208 offset:33792
v_add_f32 v180, v180, v196
v_add_f32 v181, v181, v197
v_mfma_f32_16x16x32_bf16 v[64:67], v[148:151], v[108:111], v[64:67]
v_fmac_f32 v182, v196, v196
v_fmac_f32 v183, v197, v197
v_mfma_f32_16x16x32_bf16 v[68:71], v[148:151], v[112:115], v[68:71]
s_add_u32 m0, s55, 0
s_nop 0
buffer_load_dwordx4 v220, s[8:11], s50 offen offset:0 lds
v_add_f32 v180, v180, v198
v_add_f32 v181, v181, v199
v_mfma_f32_16x16x32_bf16 v[72:75], v[148:151], v[116:119], v[72:75]
v_fmac_f32 v182, v198, v198
v_mfma_f32_16x16x32_bf16 v[76:79], v[148:151], v[120:123], v[76:79]
ds_read_b64_tr_b16 v[148:149], v208 offset:36864
ds_read_b64_tr_b16 v[150:151], v208 offset:37888
v_fmac_f32 v183, v199, v199
s_mov_b64 exec, s[70:71]
buffer_load_dword v225, v247, s[72:75], s0 offen
s_mov_b64 exec, -1
s_add_u32 s0, s0, s1
v_mfma_f32_16x16x32_bf16 v[0:3], v[132:135], v[92:95], v[0:3]
v_mfma_f32_16x16x32_bf16 v[4:7], v[132:135], v[96:99], v[4:7]
v_mfma_f32_16x16x32_bf16 v[8:11], v[132:135], v[100:103], v[8:11]
v_mfma_f32_16x16x32_bf16 v[12:15], v[132:135], v[104:107], v[12:15]
s_waitcnt vmcnt(10)
s_waitcnt lgkmcnt(0)
s_barrier
ds_read_b64_tr_b16 v[132:133], v208 offset:40960
ds_read_b64_tr_b16 v[134:135], v208 offset:41984
v_mfma_f32_16x16x32_bf16 v[16:19], v[136:139], v[92:95], v[16:19]
ds_read_b128 v[156:159], v217 offset:32768
ds_read_b128 v[108:111], v215 offset:32768
ds_read_b128 v[112:115], v215 offset:34816
s_add_u32 m0, s55, 3072
s_nop 0
buffer_load_dwordx4 v220, s[8:11], s50 offen offset:1024 lds
v_mfma_f32_16x16x32_bf16 v[20:23], v[136:139], v[96:99], v[20:23]
ds_read_b128 v[116:119], v215 offset:36864
ds_read_b128 v[120:123], v215 offset:38912
s_mov_b64 exec, s[60:61]
ds_read_b128 v[128:131], v215 offset:53248
s_mov_b64 exec, -1
v_mfma_f32_16x16x32_bf16 v[24:27], v[136:139], v[100:103], v[24:27]
v_mfma_f32_16x16x32_bf16 v[28:31], v[136:139], v[104:107], v[28:31]
s_add_u32 m0, s55, 6144
s_nop 0
buffer_load_dwordx4 v220, s[8:11], s50 offen offset:2048 lds
s_add_u32 s50, s50, 98304
s_waitcnt lgkmcnt(0)
v_mfma_f32_16x16x32_bf16 v[80:83], v[136:139], v[124:127], v[80:83]
ds_read_b64_tr_b16 v[136:137], v208 offset:45056
ds_read_b64_tr_b16 v[138:139], v208 offset:46080
v_mfma_f32_16x16x32_bf16 v[32:35], v[140:143], v[92:95], v[32:35]
v_lshlrev_b32 v192, 16, v156
v_and_b32 v193, s58, v156
v_mfma_f32_16x16x32_bf16 v[36:39], v[140:143], v[96:99], v[36:39]
s_add_u32 m0, s57, 153216
s_mov_b32 exec_hi, 0
buffer_load_dwordx4 v224, s[4:7], s54 offen offset:384 lds
s_mov_b32 exec_hi, -1
v_lshlrev_b32 v194, 16, v157
v_and_b32 v195, s58, v157
v_mfma_f32_16x16x32_bf16 v[40:43], v[140:143], v[100:103], v[40:43]
v_add_f32 v180, v180, v192
v_add_f32 v181, v181, v193
v_mfma_f32_16x16x32_bf16 v[44:47], v[140:143], v[104:107], v[44:47]
v_fmac_f32 v182, v192, v192
v_fmac_f32 v183, v193, v193
v_mfma_f32_16x16x32_bf16 v[84:87], v[140:143], v[124:127], v[84:87]
ds_read_b64_tr_b16 v[140:141], v208 offset:49152
ds_read_b64_tr_b16 v[142:143], v208 offset:50176
s_add_u32 m0, s56, 118400
s_nop 0
buffer_load_dwordx4 v222, s[4:7], s52 offen offset:384 lds
v_lshlrev_b32 v196, 16, v158
v_and_b32 v197, s58, v158
v_mfma_f32_16x16x32_bf16 v[48:51], v[144:147], v[92:95], v[48:51]
v_add_f32 v180, v180, v194
v_add_f32 v181, v181, v195
v_mfma_f32_16x16x32_bf16 v[52:55], v[144:147], v[96:99], v[52:55]
v_fmac_f32 v182, v194, v194
v_fmac_f32 v183, v195, v195
v_mfma_f32_16x16x32_bf16 v[56:59], v[144:147], v[100:103], v[56:59]
s_add_u32 m0, s55, 20480
s_nop 0
buffer_load_dwordx4 v220, s[8:11], s50 offen offset:0 lds
v_lshlrev_b32 v198, 16, v159
v_and_b32 v199, s58, v159
v_mfma_f32_16x16x32_bf16 v[60:63], v[144:147], v[104:107], v[60:63]
ds_read_b64_tr_b16 v[144:145], v208 offset:53248
ds_read_b64_tr_b16 v[146:147], v208 offset:54272
v_add_f32 v180, v180, v196
v_add_f32 v181, v181, v197
v_mfma_f32_16x16x32_bf16 v[64:67], v[148:151], v[92:95], v[64:67]
v_fmac_f32 v182, v196, v196
v_fmac_f32 v183, v197, v197
v_mfma_f32_16x16x32_bf16 v[68:71], v[148:151], v[96:99], v[68:71]
s_add_u32 m0, s55, 23552
s_nop 0
buffer_load_dwordx4 v220, s[8:11], s50 offen offset:1024 lds
v_add_f32 v180, v180, v198
v_add_f32 v181, v181, v199
v_mfma_f32_16x16x32_bf16 v[72:75], v[148:151], v[100:103], v[72:75]
v_fmac_f32 v182, v198, v198
v_mfma_f32_16x16x32_bf16 v[76:79], v[148:151], v[104:107], v[76:79]
ds_read_b64_tr_b16 v[148:149], v208 offset:57344
ds_read_b64_tr_b16 v[150:151], v208 offset:58368
v_fmac_f32 v183, v199, v199
v_mfma_f32_16x16x32_bf16 v[0:3], v[132:135], v[108:111], v[0:3]
v_mfma_f32_16x16x32_bf16 v[4:7], v[132:135], v[112:115], v[4:7]
v_mfma_f32_16x16x32_bf16 v[8:11], v[132:135], v[116:119], v[8:11]
v_mfma_f32_16x16x32_bf16 v[12:15], v[132:135], v[120:123], v[12:15]
s_waitcnt vmcnt(11)
s_waitcnt lgkmcnt(0)
s_barrier
ds_read_b64_tr_b16 v[132:133], v211 offset:0
ds_read_b64_tr_b16 v[134:135], v211 offset:1024
v_mfma_f32_16x16x32_bf16 v[16:19], v[136:139], v[108:111], v[16:19]
ds_read_b128 v[156:159], v216 offset:0
ds_read_b128 v[92:95], v214 offset:0
ds_read_b128 v[96:99], v214 offset:2048
s_add_u32 m0, s55, 26624
s_nop 0
buffer_load_dwordx4 v220, s[8:11], s50 offen offset:2048 lds
s_add_u32 s50, s50, 98304
v_mfma_f32_16x16x32_bf16 v[20:23], v[136:139], v[112:115], v[20:23]
ds_read_b128 v[100:103], v214 offset:4096
ds_read_b128 v[104:107], v214 offset:6144
s_mov_b64 exec, s[60:61]
ds_read_b128 v[124:127], v214 offset:49152
s_mov_b64 exec, -1
v_mfma_f32_16x16x32_bf16 v[24:27], v[136:139], v[116:119], v[24:27]
v_mfma_f32_16x16x32_bf16 v[28:31], v[136:139], v[120:123], v[28:31]
s_add_u32 m0, s55, 40960
s_nop 0
buffer_load_dwordx4 v220, s[8:11], s50 offen offset:0 lds
s_waitcnt lgkmcnt(0)
v_mfma_f32_16x16x32_bf16 v[80:83], v[136:139], v[128:131], v[80:83]
ds_read_b64_tr_b16 v[136:137], v211 offset:4096
ds_read_b64_tr_b16 v[138:139], v211 offset:5120
v_mfma_f32_16x16x32_bf16 v[32:35], v[140:143], v[108:111], v[32:35]
v_lshlrev_b32 v192, 16, v156
v_and_b32 v193, s58, v156
v_mfma_f32_16x16x32_bf16 v[36:39], v[140:143], v[112:115], v[36:39]
s_add_u32 m0, s55, 44032
s_nop 0
buffer_load_dwordx4 v220, s[8:11], s50 offen offset:1024 lds
v_lshlrev_b32 v194, 16, v157
v_and_b32 v195, s58, v157
v_mfma_f32_16x16x32_bf16 v[40:43], v[140:143], v[116:119], v[40:43]
v_add_f32 v180, v180, v192
v_add_f32 v181, v181, v193
v_mfma_f32_16x16x32_bf16 v[44:47], v[140:143], v[120:123], v[44:47]
v_fmac_f32 v182, v192, v192
v_fmac_f32 v183, v193, v193
v_mfma_f32_16x16x32_bf16 v[84:87], v[140:143], v[128:131], v[84:87]
ds_read_b64_tr_b16 v[140:141], v211 offset:8192
ds_read_b64_tr_b16 v[142:143], v211 offset:9216
s_add_u32 m0, s55, 47104
s_nop 0
buffer_load_dwordx4 v220, s[8:11], s50 offen offset:2048 lds
s_add_u32 s50, s50, 98304
v_lshlrev_b32 v196, 16, v158
v_and_b32 v197, s58, v158
v_mfma_f32_16x16x32_bf16 v[48:51], v[144:147], v[108:111], v[48:51]
v_add_f32 v180, v180, v194
v_add_f32 v181, v181, v195
v_mfma_f32_16x16x32_bf16 v[52:55], v[144:147], v[112:115], v[52:55]
v_fmac_f32 v182, v194, v194
v_fmac_f32 v183, v195, v195
v_mfma_f32_16x16x32_bf16 v[56:59], v[144:147], v[116:119], v[56:59]
s_add_u32 m0, s57, 155136
s_mov_b32 exec_hi, 0
buffer_load_dwordx4 v224, s[4:7], s54 offen offset:512 lds
s_mov_b32 exec_hi, -1
v_lshlrev_b32 v198, 16, v159
v_and_b32 v199, s58, v159
v_mfma_f32_16x16x32_bf16 v[60:63], v[144:147], v[120:123], v[60:63]
ds_read_b64_tr_b16 v[144:145], v211 offset:12288
ds_read_b64_tr_b16 v[146:147], v211 offset:13312
v_add_f32 v180, v180, v196
v_add_f32 v181, v181, v197
v_mfma_f32_16x16x32_bf16 v[64:67], v[148:151], v[108:111], v[64:67]
v_fmac_f32 v182, v196, v196
v_fmac_f32 v183, v197, v197
v_mfma_f32_16x16x32_bf16 v[68:71], v[148:151], v[112:115], v[68:71]
v_add_f32 v180, v180, v198
v_add_f32 v181, v181, v199
v_mfma_f32_16x16x32_bf16 v[72:75], v[148:151], v[116:119], v[72:75]
v_fmac_f32 v182, v198, v198
v_mfma_f32_16x16x32_bf16 v[76:79], v[148:151], v[120:123], v[76:79]
ds_read_b64_tr_b16 v[148:149], v211 offset:16384
ds_read_b64_tr_b16 v[150:151], v211 offset:17408
v_fmac_f32 v183, v199, v199
s_mov_b64 exec, s[70:71]
buffer_load_dword v225, v247, s[72:75], s0 offen
s_mov_b64 exec, -1
s_add_u32 s0, s0, s1
v_mfma_f32_16x16x32_bf16 v[0:3], v[132:135], v[92:95], v[0:3]
v_mfma_f32_16x16x32_bf16 v[4:7], v[132:135], v[96:99], v[4:7]
v_mfma_f32_16x16x32_bf16 v[8:11], v[132:135], v[100:103], v[8:11]
v_mfma_f32_16x16x32_bf16 v[12:15], v[132:135], v[104:107], v[12:15]
s_waitcnt vmcnt(14)
s_waitcnt lgkmcnt(0)
s_barrier
ds_read_b64_tr_b16 v[132:133], v211 offset:20480
ds_read_b64_tr_b16 v[134:135], v211 offset:21504
v_mfma_f32_16x16x32_bf16 v[16:19], v[136:139], v[92:95], v[16:19]
ds_read_b128 v[156:159], v217 offset:0
ds_read_b128 v[108:111], v215 offset:0
ds_read_b128 v[112:115], v215 offset:2048
s_add_u32 m0, s56, 134656
s_nop 0
buffer_load_dwordx4 v222, s[4:7], s52 offen offset:512 lds
v_mfma_f32_16x16x32_bf16 v[20:23], v[136:139], v[96:99], v[20:23]
ds_read_b128 v[116:119], v215 offset:4096
ds_read_b128 v[120:123], v215 offset:6144
s_mov_b64 exec, s[60:61]
ds_read_b128 v[128:131], v215 offset:49152
s_mov_b64 exec, -1
v_mfma_f32_16x16x32_bf16 v[24:27], v[136:139], v[100:103], v[24:27]
v_mfma_f32_16x16x32_bf16 v[28:31], v[136:139], v[104:107], v[28:31]
s_add_u32 m0, s55, 61440
s_nop 0
buffer_load_dwordx4 v220, s[8:11], s50 offen offset:0 lds
s_waitcnt lgkmcnt(0)
v_mfma_f32_16x16x32_bf16 v[80:83], v[136:139], v[124:127], v[80:83]
ds_read_b64_tr_b16 v[136:137], v211 offset:24576
ds_read_b64_tr_b16 v[138:139], v211 offset:25600
v_mfma_f32_16x16x32_bf16 v[32:35], v[140:143], v[92:95], v[32:35]
v_lshlrev_b32 v192, 16, v156
v_and_b32 v193, s58, v156
v_mfma_f32_16x16x32_bf16 v[36:39], v[140:143], v[96:99], v[36:39]
s_add_u32 m0, s55, 64512
s_nop 0
buffer_load_dwordx4 v220, s[8:11], s50 offen offset:1024 lds
v_lshlrev_b32 v194, 16, v157
v_and_b32 v195, s58, v157
v_mfma_f32_16x16x32_bf16 v[40:43], v[140:143], v[100:103], v[40:43]
v_add_f32 v180, v180, v192
v_add_f32 v181, v181, v193
v_mfma_f32_16x16x32_bf16 v[44:47], v[140:143], v[104:107], v[44:47]
v_fmac_f32 v182, v192, v192
v_fmac_f32 v183, v193, v193
v_mfma_f32_16x16x32_bf16 v[84:87], v[140:143], v[124:127], v[84:87]
ds_read_b64_tr_b16 v[140:141], v211 offset:28672
ds_read_b64_tr_b16 v[142:143], v211 offset:29696
s_add_u32 m0, s55, 67584
s_nop 0
buffer_load_dwordx4 v220, s[8:11], s50 offen offset:2048 lds
s_add_u32 s50, s50, 98304
v_lshlrev_b32 v196, 16, v158
v_and_b32 v197, s58, v158
v_mfma_f32_16x16x32_bf16 v[48:51], v[144:147], v[92:95], v[48:51]
v_add_f32 v180, v180, v194
v_add_f32 v181, v181, v195
v_mfma_f32_16x16x32_bf16 v[52:55], v[144:147], v[96:99], v[52:55]
v_fmac_f32 v182, v194, v194
v_fmac_f32 v183, v195, v195
v_mfma_f32_16x16x32_bf16 v[56:59], v[144:147], v[100:103], v[56:59]
v_lshlrev_b32 v198, 16, v159
v_and_b32 v199, s58, v159
v_mfma_f32_16x16x32_bf16 v[60:63], v[144:147], v[104:107], v[60:63]
ds_read_b64_tr_b16 v[144:145], v211 offset:32768
ds_read_b64_tr_b16 v[146:147], v211 offset:33792
v_add_f32 v180, v180, v196
v_add_f32 v181, v181, v197
v_mfma_f32_16x16x32_bf16 v[64:67], v[148:151], v[92:95], v[64:67]
v_fmac_f32 v182, v196, v196
v_fmac_f32 v183, v197, v197
v_mfma_f32_16x16x32_bf16 v[68:71], v[148:151], v[96:99], v[68:71]
v_add_f32 v180, v180, v198
v_add_f32 v181, v181, v199
v_mfma_f32_16x16x32_bf16 v[72:75], v[148:151], v[100:103], v[72:75]
v_fmac_f32 v182, v198, v198
v_mfma_f32_16x16x32_bf16 v[76:79], v[148:151], v[104:107], v[76:79]
ds_read_b64_tr_b16 v[148:149], v211 offset:36864
ds_read_b64_tr_b16 v[150:151], v211 offset:37888
v_fmac_f32 v183, v199, v199
v_mfma_f32_16x16x32_bf16 v[0:3], v[132:135], v[108:111], v[0:3]
v_mfma_f32_16x16x32_bf16 v[4:7], v[132:135], v[112:115], v[4:7]
v_mfma_f32_16x16x32_bf16 v[8:11], v[132:135], v[116:119], v[8:11]
v_mfma_f32_16x16x32_bf16 v[12:15], v[132:135], v[120:123], v[12:15]
s_waitcnt vmcnt(12)
s_waitcnt lgkmcnt(0)
s_barrier
ds_read_b64_tr_b16 v[132:133], v208 offset:0
ds_read_b64_tr_b16 v[134:135], v208 offset:1024
v_mfma_f32_16x16x32_bf16 v[16:19], v[136:139], v[108:111], v[16:19]
ds_read_b128 v[156:159], v216 offset:16384
ds_read_b128 v[92:95], v214 offset:16384
ds_read_b128 v[96:99], v214 offset:18432
s_add_u32 m0, s55, 81920
s_nop 0
buffer_load_dwordx4 v220, s[8:11], s50 offen offset:0 lds
v_mfma_f32_16x16x32_bf16 v[20:23], v[136:139], v[112:115], v[20:23]
ds_read_b128 v[100:103], v214 offset:20480
ds_read_b128 v[104:107], v214 offset:22528
s_mov_b64 exec, s[60:61]
ds_read_b128 v[124:127], v214 offset:51200
s_mov_b64 exec, -1
v_mfma_f32_16x16x32_bf16 v[24:27], v[136:139], v[116:119], v[24:27]
v_mfma_f32_16x16x32_bf16 v[28:31], v[136:139], v[120:123], v[28:31]
s_add_u32 m0, s55, 84992
s_nop 0
buffer_load_dwordx4 v220, s[8:11], s50 offen offset:1024 lds
s_waitcnt lgkmcnt(0)
v_mfma_f32_16x16x32_bf16 v[80:83], v[136:139], v[128:131], v[80:83]
ds_read_b64_tr_b16 v[136:137], v208 offset:4096
ds_read_b64_tr_b16 v[138:139], v208 offset:5120
v_mfma_f32_16x16x32_bf16 v[32:35], v[140:143], v[108:111], v[32:35]
v_lshlrev_b32 v192, 16, v156
v_and_b32 v193, s58, v156
v_mfma_f32_16x16x32_bf16 v[36:39], v[140:143], v[112:115], v[36:39]
s_add_u32 m0, s55, 88064
s_nop 0
buffer_load_dwordx4 v220, s[8:11], s50 offen offset:2048 lds
s_add_u32 s50, s50, 98304
v_lshlrev_b32 v194, 16, v157
v_and_b32 v195, s58, v157
v_mfma_f32_16x16x32_bf16 v[40:43], v[140:143], v[116:119], v[40:43]
v_add_f32 v180, v180, v192
v_add_f32 v181, v181, v193
v_mfma_f32_16x16x32_bf16 v[44:47], v[140:143], v[120:123], v[44:47]
v_fmac_f32 v182, v192, v192
v_fmac_f32 v183, v193, v193
v_mfma_f32_16x16x32_bf16 v[84:87], v[140:143], v[128:131], v[84:87]
ds_read_b64_tr_b16 v[140:141], v208 offset:8192
ds_read_b64_tr_b16 v[142:143], v208 offset:9216
s_add_u32 m0, s57, 150912
s_mov_b32 exec_hi, 0
buffer_load_dwordx4 v224, s[4:7], s54 offen offset:640 lds
s_mov_b32 exec_hi, -1
v_lshlrev_b32 v196, 16, v158
v_and_b32 v197, s58, v158
v_mfma_f32_16x16x32_bf16 v[48:51], v[144:147], v[108:111], v[48:51]
v_add_f32 v180, v180, v194
v_add_f32 v181, v181, v195
v_mfma_f32_16x16x32_bf16 v[52:55], v[144:147], v[112:115], v[52:55]
v_fmac_f32 v182, v194, v194
v_fmac_f32 v183, v195, v195
v_mfma_f32_16x16x32_bf16 v[56:59], v[144:147], v[116:119], v[56:59]
v_lshlrev_b32 v198, 16, v159
v_and_b32 v199, s58, v159
v_mfma_f32_16x16x32_bf16 v[60:63], v[144:147], v[120:123], v[60:63]
ds_read_b64_tr_b16 v[144:145], v208 offset:12288
ds_read_b64_tr_b16 v[146:147], v208 offset:13312
v_add_f32 v180, v180, v196
v_add_f32 v181, v181, v197
v_mfma_f32_16x16x32_bf16 v[64:67], v[148:151], v[108:111], v[64:67]
v_fmac_f32 v182, v196, v196
v_fmac_f32 v183, v197, v197
v_mfma_f32_16x16x32_bf16 v[68:71], v[148:151], v[112:115], v[68:71]
v_add_f32 v180, v180, v198
v_add_f32 v181, v181, v199
v_mfma_f32_16x16x32_bf16 v[72:75], v[148:151], v[116:119], v[72:75]
v_fmac_f32 v182, v198, v198
v_mfma_f32_16x16x32_bf16 v[76:79], v[148:151], v[120:123], v[76:79]
ds_read_b64_tr_b16 v[148:149], v208 offset:16384
ds_read_b64_tr_b16 v[150:151], v208 offset:17408
v_fmac_f32 v183, v199, v199
s_mov_b64 exec, s[70:71]
buffer_load_dword v225, v247, s[72:75], s0 offen
s_mov_b64 exec, -1
s_add_u32 s0, s0, s1
s_cmp_lg_u32 s41, 0
s_cbranch_scc1 L_tl1
v_mov_b32 v176, 0
v_mov_b32 v177, 0
v_mov_b32 v178, 0
v_mov_b32 v179, 0
s_mov_b64 exec, 1
buffer_load_dwordx2 v[176:177], off, s[24:27], 0 sc0 sc1
s_mov_b64 exec, -1
L_tl1:
v_mfma_f32_16x16x32_bf16 v[0:3], v[132:135], v[92:95], v[0:3]
v_mfma_f32_16x16x32_bf16 v[4:7], v[132:135], v[96:99], v[4:7]
v_mfma_f32_16x16x32_bf16 v[8:11], v[132:135], v[100:103], v[8:11]
v_mfma_f32_16x16x32_bf16 v[12:15], v[132:135], v[104:107], v[12:15]
s_waitcnt vmcnt(14)
s_waitcnt lgkmcnt(0)
s_barrier
ds_read_b64_tr_b16 v[132:133], v208 offset:20480
ds_read_b64_tr_b16 v[134:135], v208 offset:21504
v_mfma_f32_16x16x32_bf16 v[16:19], v[136:139], v[92:95], v[16:19]
ds_read_b128 v[156:159], v217 offset:16384
ds_read_b128 v[108:111], v215 offset:16384
ds_read_b128 v[112:115], v215 offset:18432
s_add_u32 m0, s56, 101760
s_nop 0
buffer_load_dwordx4 v222, s[4:7], s52 offen offset:640 lds
v_mfma_f32_16x16x32_bf16 v[20:23], v[136:139], v[96:99], v[20:23]
ds_read_b128 v[116:119], v215 offset:20480
ds_read_b128 v[120:123], v215 offset:22528
s_mov_b64 exec, s[60:61]
ds_read_b128 v[128:131], v215 offset:51200
s_mov_b64 exec, -1
v_mfma_f32_16x16x32_bf16 v[24:27], v[136:139], v[100:103], v[24:27]
v_mfma_f32_16x16x32_bf16 v[28:31], v[136:139], v[104:107], v[28:31]
s_add_u32 m0, s55, 0
s_nop 0
buffer_load_dwordx4 v220, s[8:11], s50 offen offset:0 lds
s_waitcnt lgkmcnt(0)
v_mfma_f32_16x16x32_bf16 v[80:83], v[136:139], v[124:127], v[80:83]
ds_read_b64_tr_b16 v[136:137], v208 offset:24576
ds_read_b64_tr_b16 v[138:139], v208 offset:25600
v_mfma_f32_16x16x32_bf16 v[32:35], v[140:143], v[92:95], v[32:35]
v_lshlrev_b32 v192, 16, v156
v_and_b32 v193, s58, v156
v_mfma_f32_16x16x32_bf16 v[36:39], v[140:143], v[96:99], v[36:39]
s_add_u32 m0, s55, 3072
s_nop 0
buffer_load_dwordx4 v220, s[8:11], s50 offen offset:1024 lds
v_lshlrev_b32 v194, 16, v157
v_and_b32 v195, s58, v157
v_mfma_f32_16x16x32_bf16 v[40:43], v[140:143], v[100:103], v[40:43]
v_add_f32 v180, v180, v192
v_add_f32 v181, v181, v193
v_mfma_f32_16x16x32_bf16 v[44:47], v[140:143], v[104:107], v[44:47]
v_fmac_f32 v182, v192, v192
v_fmac_f32 v183, v193, v193
v_mfma_f32_16x16x32_bf16 v[84:87], v[140:143], v[124:127], v[84:87]
ds_read_b64_tr_b16 v[140:141], v208 offset:28672
ds_read_b64_tr_b16 v[142:143], v208 offset:29696
s_add_u32 m0, s55, 6144
s_nop 0
buffer_load_dwordx4 v220, s[8:11], s50 offen offset:2048 lds
s_add_u32 s50, s50, 98304
v_lshlrev_b32 v196, 16, v158
v_and_b32 v197, s58, v158
v_mfma_f32_16x16x32_bf16 v[48:51], v[144:147], v[92:95], v[48:51]
v_add_f32 v180, v180, v194
v_add_f32 v181, v181, v195
v_mfma_f32_16x16x32_bf16 v[52:55], v[144:147], v[96:99], v[52:55]
v_fmac_f32 v182, v194, v194
v_fmac_f32 v183, v195, v195
v_mfma_f32_16x16x32_bf16 v[56:59], v[144:147], v[100:103], v[56:59]
v_lshlrev_b32 v198, 16, v159
v_and_b32 v199, s58, v159
v_mfma_f32_16x16x32_bf16 v[60:63], v[144:147], v[104:107], v[60:63]
ds_read_b64_tr_b16 v[144:145], v208 offset:32768
ds_read_b64_tr_b16 v[146:147], v208 offset:33792
v_add_f32 v180, v180, v196
v_add_f32 v181, v181, v197
v_mfma_f32_16x16x32_bf16 v[64:67], v[148:151], v[92:95], v[64:67]
v_fmac_f32 v182, v196, v196
v_fmac_f32 v183, v197, v197
v_mfma_f32_16x16x32_bf16 v[68:71], v[148:151], v[96:99], v[68:71]
v_add_f32 v180, v180, v198
v_add_f32 v181, v181, v199
v_mfma_f32_16x16x32_bf16 v[72:75], v[148:151], v[100:103], v[72:75]
v_fmac_f32 v182, v198, v198
v_mfma_f32_16x16x32_bf16 v[76:79], v[148:151], v[104:107], v[76:79]
ds_read_b64_tr_b16 v[148:149], v208 offset:36864
ds_read_b64_tr_b16 v[150:151], v208 offset:37888
v_fmac_f32 v183, v199, v199
v_mfma_f32_16x16x32_bf16 v[0:3], v[132:135], v[108:111], v[0:3]
v_mfma_f32_16x16x32_bf16 v[4:7], v[132:135], v[112:115], v[4:7]
v_mfma_f32_16x16x32_bf16 v[8:11], v[132:135], v[116:119], v[8:11]
v_mfma_f32_16x16x32_bf16 v[12:15], v[132:135], v[120:123], v[12:15]
s_waitcnt vmcnt(12)
s_waitcnt lgkmcnt(0)
s_barrier
ds_read_b64_tr_b16 v[132:133], v208 offset:40960
ds_read_b64_tr_b16 v[134:135], v208 offset:41984
v_mfma_f32_16x16x32_bf16 v[16:19], v[136:139], v[108:111], v[16:19]
ds_read_b128 v[156:159], v216 offset:32768
ds_read_b128 v[92:95], v214 offset:32768
ds_read_b128 v[96:99], v214 offset:34816
s_add_u32 m0, s55, 20480
s_nop 0
buffer_load_dwordx4 v220, s[8:11], s50 offen offset:0 lds
v_mfma_f32_16x16x32_bf16 v[20:23], v[136:139], v[112:115], v[20:23]
ds_read_b128 v[100:103], v214 offset:36864
ds_read_b128 v[104:107], v214 offset:38912
s_mov_b64 exec, s[60:61]
ds_read_b128 v[124:127], v214 offset:53248
s_mov_b64 exec, -1
v_mfma_f32_16x16x32_bf16 v[24:27], v[136:139], v[116:119], v[24:27]
v_mfma_f32_16x16x32_bf16 v[28:31], v[136:139], v[120:123], v[28:31]
s_add_u32 m0, s55, 23552
s_nop 0
buffer_load_dwordx4 v220, s[8:11], s50 offen offset:1024 lds
s_waitcnt lgkmcnt(0)
v_mfma_f32_16x16x32_bf16 v[80:83], v[136:139], v[128:131], v[80:83]
ds_read_b64_tr_b16 v[136:137], v208 offset:45056
ds_read_b64_tr_b16 v[138:139], v208 offset:46080
v_mfma_f32_16x16x32_bf16 v[32:35], v[140:143], v[108:111], v[32:35]
v_lshlrev_b32 v192, 16, v156
v_and_b32 v193, s58, v156
v_mfma_f32_16x16x32_bf16 v[36:39], v[140:143], v[112:115], v[36:39]
s_add_u32 m0, s55, 26624
s_nop 0
buffer_load_dwordx4 v220, s[8:11], s50 offen offset:2048 lds
s_add_u32 s50, s50, 98304
v_lshlrev_b32 v194, 16, v157
v_and_b32 v195, s58, v157
v_mfma_f32_16x16x32_bf16 v[40:43], v[140:143], v[116:119], v[40:43]
v_add_f32 v180, v180, v192
v_add_f32 v181, v181, v193
v_mfma_f32_16x16x32_bf16 v[44:47], v[140:143], v[120:123], v[44:47]
v_fmac_f32 v182, v192, v192
v_fmac_f32 v183, v193, v193
v_mfma_f32_16x16x32_bf16 v[84:87], v[140:143], v[128:131], v[84:87]
ds_read_b64_tr_b16 v[140:141], v208 offset:49152
ds_read_b64_tr_b16 v[142:143], v208 offset:50176
s_add_u32 m0, s57, 152832
s_mov_b32 exec_hi, 0
buffer_load_dwordx4 v224, s[4:7], s54 offen offset:768 lds
s_mov_b32 exec_hi, -1
v_lshlrev_b32 v196, 16, v158
v_and_b32 v197, s58, v158
v_mfma_f32_16x16x32_bf16 v[48:51], v[144:147], v[108:111], v[48:51]
v_add_f32 v180, v180, v194
v_add_f32 v181, v181, v195
v_mfma_f32_16x16x32_bf16 v[52:55], v[144:147], v[112:115], v[52:55]
v_fmac_f32 v182, v194, v194
v_fmac_f32 v183, v195, v195
v_mfma_f32_16x16x32_bf16 v[56:59], v[144:147], v[116:119], v[56:59]
v_lshlrev_b32 v198, 16, v159
v_and_b32 v199, s58, v159
v_mfma_f32_16x16x32_bf16 v[60:63], v[144:147], v[120:123], v[60:63]
ds_read_b64_tr_b16 v[144:145], v208 offset:53248
ds_read_b64_tr_b16 v[146:147], v208 offset:54272
v_add_f32 v180, v180, v196
v_add_f32 v181, v181, v197
v_mfma_f32_16x16x32_bf16 v[64:67], v[148:151], v[108:111], v[64:67]
v_fmac_f32 v182, v196, v196
v_fmac_f32 v183, v197, v197
v_mfma_f32_16x16x32_bf16 v[68:71], v[148:151], v[112:115], v[68:71]
v_add_f32 v180, v180, v198
v_add_f32 v181, v181, v199
v_mfma_f32_16x16x32_bf16 v[72:75], v[148:151], v[116:119], v[72:75]
v_fmac_f32 v182, v198, v198
v_mfma_f32_16x16x32_bf16 v[76:79], v[148:151], v[120:123], v[76:79]
ds_read_b64_tr_b16 v[148:149], v208 offset:57344
ds_read_b64_tr_b16 v[150:151], v208 offset:58368
v_fmac_f32 v183, v199, v199
s_mov_b64 exec, s[70:71]
buffer_load_dword v225, v247, s[72:75], s0 offen
s_mov_b64 exec, -1
s_add_u32 s0, s0, s1
v_mfma_f32_16x16x32_bf16 v[0:3], v[132:135], v[92:95], v[0:3]
v_mfma_f32_16x16x32_bf16 v[4:7], v[132:135], v[96:99], v[4:7]
v_mfma_f32_16x16x32_bf16 v[8:11], v[132:135], v[100:103], v[8:11]
v_mfma_f32_16x16x32_bf16 v[12:15], v[132:135], v[104:107], v[12:15]
s_waitcnt vmcnt(14)
s_waitcnt lgkmcnt(0)
s_barrier
ds_read_b64_tr_b16 v[132:133], v211 offset:0
ds_read_b64_tr_b16 v[134:135], v211 offset:1024
v_mfma_f32_16x16x32_bf16 v[16:19], v[136:139], v[92:95], v[16:19]
ds_read_b128 v[156:159], v217 offset:32768
ds_read_b128 v[108:111], v215 offset:32768
ds_read_b128 v[112:115], v215 offset:34816
s_add_u32 m0, s56, 118016
s_nop 0
buffer_load_dwordx4 v222, s[4:7], s52 offen offset:768 lds
v_mfma_f32_16x16x32_bf16 v[20:23], v[136:139], v[96:99], v[20:23]
ds_read_b128 v[116:119], v215 offset:36864
ds_read_b128 v[120:123], v215 offset:38912
s_mov_b64 exec, s[60:61]
ds_read_b128 v[128:131], v215 offset:53248
s_mov_b64 exec, -1
v_mfma_f32_16x16x32_bf16 v[24:27], v[136:139], v[100:103], v[24:27]
v_mfma_f32_16x16x32_bf16 v[28:31], v[136:139], v[104:107], v[28:31]
s_add_u32 m0, s55, 40960
s_nop 0
buffer_load_dwordx4 v220, s[8:11], s50 offen offset:0 lds
s_waitcnt lgkmcnt(0)
v_mfma_f32_16x16x32_bf16 v[80:83], v[136:139], v[124:127], v[80:83]
ds_read_b64_tr_b16 v[136:137], v211 offset:4096
ds_read_b64_tr_b16 v[138:139], v211 offset:5120
v_mfma_f32_16x16x32_bf16 v[32:35], v[140:143], v[92:95], v[32:35]
v_lshlrev_b32 v192, 16, v156
v_and_b32 v193, s58, v156
v_mfma_f32_16x16x32_bf16 v[36:39], v[140:143], v[96:99], v[36:39]
s_add_u32 m0, s55, 44032
s_nop 0
buffer_load_dwordx4 v220, s[8:11], s50 offen offset:1024 lds
v_lshlrev_b32 v194, 16, v157
v_and_b32 v195, s58, v157
v_mfma_f32_16x16x32_bf16 v[40:43], v[140:143], v[100:103], v[40:43]
v_add_f32 v180, v180, v192
v_add_f32 v181, v181, v193
v_mfma_f32_16x16x32_bf16 v[44:47], v[140:143], v[104:107], v[44:47]
v_fmac_f32 v182, v192, v192
v_fmac_f32 v183, v193, v193
v_mfma_f32_16x16x32_bf16 v[84:87], v[140:143], v[124:127], v[84:87]
ds_read_b64_tr_b16 v[140:141], v211 offset:8192
ds_read_b64_tr_b16 v[142:143], v211 offset:9216
s_add_u32 m0, s55, 47104
s_nop 0
buffer_load_dwordx4 v220, s[8:11], s50 offen offset:2048 lds
s_add_u32 s50, s50, 98304
v_lshlrev_b32 v196, 16, v158
v_and_b32 v197, s58, v158
v_mfma_f32_16x16x32_bf16 v[48:51], v[144:147], v[92:95], v[48:51]
v_add_f32 v180, v180, v194
v_add_f32 v181, v181, v195
v_mfma_f32_16x16x32_bf16 v[52:55], v[144:147], v[96:99], v[52:55]
v_fmac_f32 v182, v194, v194
v_fmac_f32 v183, v195, v195
v_mfma_f32_16x16x32_bf16 v[56:59], v[144:147], v[100:103], v[56:59]
v_lshlrev_b32 v198, 16, v159
v_and_b32 v199, s58, v159
v_mfma_f32_16x16x32_bf16 v[60:63], v[144:147], v[104:107], v[60:63]
ds_read_b64_tr_b16 v[144:145], v211 offset:12288
ds_read_b64_tr_b16 v[146:147], v211 offset:13312
v_add_f32 v180, v180, v196
v_add_f32 v181, v181, v197
v_mfma_f32_16x16x32_bf16 v[64:67], v[148:151], v[92:95], v[64:67]
v_fmac_f32 v182, v196, v196
v_fmac_f32 v183, v197, v197
v_mfma_f32_16x16x32_bf16 v[68:71], v[148:151], v[96:99], v[68:71]
v_add_f32 v180, v180, v198
v_add_f32 v181, v181, v199
v_mfma_f32_16x16x32_bf16 v[72:75], v[148:151], v[100:103], v[72:75]
v_fmac_f32 v182, v198, v198
v_mfma_f32_16x16x32_bf16 v[76:79], v[148:151], v[104:107], v[76:79]
ds_read_b64_tr_b16 v[148:149], v211 offset:16384
ds_read_b64_tr_b16 v[150:151], v211 offset:17408
v_fmac_f32 v183, v199, v199
v_mfma_f32_16x16x32_bf16 v[0:3], v[132:135], v[108:111], v[0:3]
v_mfma_f32_16x16x32_bf16 v[4:7], v[132:135], v[112:115], v[4:7]
v_mfma_f32_16x16x32_bf16 v[8:11], v[132:135], v[116:119], v[8:11]
v_mfma_f32_16x16x32_bf16 v[12:15], v[132:135], v[120:123], v[12:15]
s_waitcnt vmcnt(12)
s_waitcnt lgkmcnt(0)
s_barrier
ds_read_b64_tr_b16 v[132:133], v211 offset:20480
ds_read_b64_tr_b16 v[134:135], v211 offset:21504
v_mfma_f32_16x16x32_bf16 v[16:19], v[136:139], v[108:111], v[16:19]
ds_read_b128 v[156:159], v216 offset:0
ds_read_b128 v[92:95], v214 offset:0
ds_read_b128 v[96:99], v214 offset:2048
s_add_u32 m0, s55, 61440
s_nop 0
buffer_load_dwordx4 v220, s[8:11], s50 offen offset:0 lds
v_mfma_f32_16x16x32_bf16 v[20:23], v[136:139], v[112:115], v[20:23]
ds_read_b128 v[100:103], v214 offset:4096
ds_read_b128 v[104:107], v214 offset:6144
s_mov_b64 exec, s[60:61]
ds_read_b128 v[124:127], v214 offset:49152
s_mov_b64 exec, -1
v_mfma_f32_16x16x32_bf16 v[24:27], v[136:139], v[116:119], v[24:27]
v_mfma_f32_16x16x32_bf16 v[28:31], v[136:139], v[120:123], v[28:31]
s_add_u32 m0, s55, 64512
s_nop 0
buffer_load_dwordx4 v220, s[8:11], s50 offen offset:1024 lds
s_waitcnt lgkmcnt(0)
v_mfma_f32_16x16x32_bf16 v[80:83], v[136:139], v[128:131], v[80:83]
ds_read_b64_tr_b16 v[136:137], v211 offset:24576
ds_read_b64_tr_b16 v[138:139], v211 offset:25600
v_mfma_f32_16x16x32_bf16 v[32:35], v[140:143], v[108:111], v[32:35]
v_lshlrev_b32 v192, 16, v156
v_and_b32 v193, s58, v156
v_mfma_f32_16x16x32_bf16 v[36:39], v[140:143], v[112:115], v[36:39]
s_add_u32 m0, s55, 67584
s_nop 0
buffer_load_dwordx4 v220, s[8:11], s50 offen offset:2048 lds
s_add_u32 s50, s50, 98304
v_lshlrev_b32 v194, 16, v157
v_and_b32 v195, s58, v157
v_mfma_f32_16x16x32_bf16 v[40:43], v[140:143], v[116:119], v[40:43]
v_add_f32 v180, v180, v192
v_add_f32 v181, v181, v193
v_mfma_f32_16x16x32_bf16 v[44:47], v[140:143], v[120:123], v[44:47]
v_fmac_f32 v182, v192, v192
v_fmac_f32 v183, v193, v193
v_mfma_f32_16x16x32_bf16 v[84:87], v[140:143], v[128:131], v[84:87]
ds_read_b64_tr_b16 v[140:141], v211 offset:28672
ds_read_b64_tr_b16 v[142:143], v211 offset:29696
s_add_u32 m0, s57, 154752
s_mov_b32 exec_hi, 0
buffer_load_dwordx4 v224, s[4:7], s54 offen offset:896 lds
s_mov_b32 exec_hi, -1
v_lshlrev_b32 v196, 16, v158
v_and_b32 v197, s58, v158
v_mfma_f32_16x16x32_bf16 v[48:51], v[144:147], v[108:111], v[48:51]
v_add_f32 v180, v180, v194
v_add_f32 v181, v181, v195
v_mfma_f32_16x16x32_bf16 v[52:55], v[144:147], v[112:115], v[52:55]
v_fmac_f32 v182, v194, v194
v_fmac_f32 v183, v195, v195
v_mfma_f32_16x16x32_bf16 v[56:59], v[144:147], v[116:119], v[56:59]
v_lshlrev_b32 v198, 16, v159
v_and_b32 v199, s58, v159
v_mfma_f32_16x16x32_bf16 v[60:63], v[144:147], v[120:123], v[60:63]
ds_read_b64_tr_b16 v[144:145], v211 offset:32768
ds_read_b64_tr_b16 v[146:147], v211 offset:33792
v_add_f32 v180, v180, v196
v_add_f32 v181, v181, v197
v_mfma_f32_16x16x32_bf16 v[64:67], v[148:151], v[108:111], v[64:67]
v_fmac_f32 v182, v196, v196
v_fmac_f32 v183, v197, v197
v_mfma_f32_16x16x32_bf16 v[68:71], v[148:151], v[112:115], v[68:71]
v_add_f32 v180, v180, v198
v_add_f32 v181, v181, v199
v_mfma_f32_16x16x32_bf16 v[72:75], v[148:151], v[116:119], v[72:75]
v_fmac_f32 v182, v198, v198
v_mfma_f32_16x16x32_bf16 v[76:79], v[148:151], v[120:123], v[76:79]
ds_read_b64_tr_b16 v[148:149], v211 offset:36864
ds_read_b64_tr_b16 v[150:151], v211 offset:37888
v_fmac_f32 v183, v199, v199
s_mov_b32 exec_lo, 0xffff
s_mov_b32 exec_hi, 0x0
buffer_load_dword v225, v226, s[32:35], 0 offen
s_mov_b64 exec, -1
s_mov_b64 exec, 0xffff
buffer_load_dword v225, v227, s[28:31], 0 offen
s_mov_b64 exec, -1
v_mfma_f32_16x16x32_bf16 v[0:3], v[132:135], v[92:95], v[0:3]
v_mfma_f32_16x16x32_bf16 v[4:7], v[132:135], v[96:99], v[4:7]
v_mfma_f32_16x16x32_bf16 v[8:11], v[132:135], v[100:103], v[8:11]
v_mfma_f32_16x16x32_bf16 v[12:15], v[132:135], v[104:107], v[12:15]
s_waitcnt vmcnt(15)
s_waitcnt lgkmcnt(0)
s_barrier
ds_read_b64_tr_b16 v[132:133], v208 offset:0
ds_read_b64_tr_b16 v[134:135], v208 offset:1024
v_mfma_f32_16x16x32_bf16 v[16:19], v[136:139], v[92:95], v[16:19]
ds_read_b128 v[156:159], v217 offset:0
ds_read_b128 v[108:111], v215 offset:0
ds_read_b128 v[112:115], v215 offset:2048
s_add_u32 m0, s56, 134272
s_nop 0
buffer_load_dwordx4 v222, s[4:7], s52 offen offset:896 lds
v_mfma_f32_16x16x32_bf16 v[20:23], v[136:139], v[96:99], v[20:23]
ds_read_b128 v[116:119], v215 offset:4096
ds_read_b128 v[120:123], v215 offset:6144
s_mov_b64 exec, s[60:61]
ds_read_b128 v[128:131], v215 offset:49152
s_mov_b64 exec, -1
v_mfma_f32_16x16x32_bf16 v[24:27], v[136:139], v[100:103], v[24:27]
v_mfma_f32_16x16x32_bf16 v[28:31], v[136:139], v[104:107], v[28:31]
s_add_u32 m0, s55, 81920
s_nop 0
buffer_load_dwordx4 v220, s[8:11], s50 offen offset:0 lds
s_waitcnt lgkmcnt(0)
v_mfma_f32_16x16x32_bf16 v[80:83], v[136:139], v[124:127], v[80:83]
ds_read_b64_tr_b16 v[136:137], v208 offset:4096
ds_read_b64_tr_b16 v[138:139], v208 offset:5120
v_mfma_f32_16x16x32_bf16 v[32:35], v[140:143], v[92:95], v[32:35]
v_lshlrev_b32 v192, 16, v156
v_and_b32 v193, s58, v156
v_mfma_f32_16x16x32_bf16 v[36:39], v[140:143], v[96:99], v[36:39]
s_add_u32 m0, s55, 84992
s_nop 0
buffer_load_dwordx4 v220, s[8:11], s50 offen offset:1024 lds
v_lshlrev_b32 v194, 16, v157
v_and_b32 v195, s58, v157
v_mfma_f32_16x16x32_bf16 v[40:43], v[140:143], v[100:103], v[40:43]
v_add_f32 v180, v180, v192
v_add_f32 v181, v181, v193
v_mfma_f32_16x16x32_bf16 v[44:47], v[140:143], v[104:107], v[44:47]
v_fmac_f32 v182, v192, v192
v_fmac_f32 v183, v193, v193
v_mfma_f32_16x16x32_bf16 v[84:87], v[140:143], v[124:127], v[84:87]
ds_read_b64_tr_b16 v[140:141], v208 offset:8192
ds_read_b64_tr_b16 v[142:143], v208 offset:9216
s_add_u32 m0, s55, 88064
s_nop 0
buffer_load_dwordx4 v220, s[8:11], s50 offen offset:2048 lds
s_add_u32 s50, s50, 98304
v_lshlrev_b32 v196, 16, v158
v_and_b32 v197, s58, v158
v_mfma_f32_16x16x32_bf16 v[48:51], v[144:147], v[92:95], v[48:51]
v_add_f32 v180, v180, v194
v_add_f32 v181, v181, v195
v_mfma_f32_16x16x32_bf16 v[52:55], v[144:147], v[96:99], v[52:55]
v_fmac_f32 v182, v194, v194
v_fmac_f32 v183, v195, v195
v_mfma_f32_16x16x32_bf16 v[56:59], v[144:147], v[100:103], v[56:59]
v_lshlrev_b32 v198, 16, v159
v_and_b32 v199, s58, v159
v_mfma_f32_16x16x32_bf16 v[60:63], v[144:147], v[104:107], v[60:63]
ds_read_b64_tr_b16 v[144:145], v208 offset:12288
ds_read_b64_tr_b16 v[146:147], v208 offset:13312
v_add_f32 v180, v180, v196
v_add_f32 v181, v181, v197
v_mfma_f32_16x16x32_bf16 v[64:67], v[148:151], v[92:95], v[64:67]
v_fmac_f32 v182, v196, v196
v_fmac_f32 v183, v197, v197
v_mfma_f32_16x16x32_bf16 v[68:71], v[148:151], v[96:99], v[68:71]
v_add_f32 v180, v180, v198
v_add_f32 v181, v181, v199
v_mfma_f32_16x16x32_bf16 v[72:75], v[148:151], v[100:103], v[72:75]
v_fmac_f32 v182, v198, v198
v_mfma_f32_16x16x32_bf16 v[76:79], v[148:151], v[104:107], v[76:79]
ds_read_b64_tr_b16 v[148:149], v208 offset:16384
ds_read_b64_tr_b16 v[150:151], v208 offset:17408
v_fmac_f32 v183, v199, v199
s_cmp_lg_u32 s41, 0
s_cbranch_scc1 L_tw1
s_mov_b64 exec, 1
s_mov_b32 s46, 200000
s_waitcnt vmcnt(12)
L_ts1:
v_readfirstlane_b32 s45, v176
s_sub_u32 s46, s46, 1
s_cmp_lt_i32 s46, 0
s_cselect_b32 s45, 1, s45
s_cmp_lg_u32 s45, 0
s_cbranch_scc1 L_tx1
buffer_load_dwordx2 v[176:177], off, s[24:27], 0 sc0 sc1
s_waitcnt vmcnt(0)
s_branch L_ts1
L_tx1:
ds_write_b128 v174, v[176:179]
s_mov_b64 exec, -1
L_tw1:
v_mfma_f32_16x16x32_bf16 v[0:3], v[132:135], v[108:111], v[0:3]
v_add_u32 v248, 102400, v169
v_mfma_f32_16x16x32_bf16 v[4:7], v[132:135], v[112:115], v[4:7]
v_add_u32 v249, 102400, v170
v_mfma_f32_16x16x32_bf16 v[8:11], v[132:135], v[116:119], v[8:11]
v_add_u32 v250, 102400, v171
v_mfma_f32_16x16x32_bf16 v[12:15], v[132:135], v[120:123], v[12:15]
s_waitcnt vmcnt(13)
s_waitcnt lgkmcnt(0)
s_barrier
ds_read_b64_tr_b16 v[132:133], v208 offset:20480
ds_read_b64_tr_b16 v[134:135], v208 offset:21504
v_add_u32 v251, 102400, v172
v_mfma_f32_16x16x32_bf16 v[16:19], v[136:139], v[108:111], v[16:19]
ds_read_b128 v[156:159], v216 offset:16384
ds_read_b128 v[92:95], v214 offset:16384
ds_read_b128 v[96:99], v214 offset:18432
s_lshr_b32 s46, s40, 1
v_mfma_f32_16x16x32_bf16 v[20:23], v[136:139], v[112:115], v[20:23]
ds_read_b128 v[100:103], v214 offset:20480
ds_read_b128 v[104:107], v214 offset:22528
s_mov_b64 exec, s[60:61]
ds_read_b128 v[124:127], v214 offset:51200
s_mov_b64 exec, -1
s_lshl_b32 s67, s59, 16
v_mfma_f32_16x16x32_bf16 v[24:27], v[136:139], v[116:119], v[24:27]
s_lshl_b32 s45, s46, 14
v_mfma_f32_16x16x32_bf16 v[28:31], v[136:139], v[120:123], v[28:31]
s_add_u32 s67, s67, s45
s_waitcnt lgkmcnt(0)
v_mfma_f32_16x16x32_bf16 v[80:83], v[136:139], v[128:131], v[80:83]
ds_read_b64_tr_b16 v[136:137], v208 offset:24576
ds_read_b64_tr_b16 v[138:139], v208 offset:25600
s_lshl_b32 s45, s62, 7
v_mfma_f32_16x16x32_bf16 v[32:35], v[140:143], v[108:111], v[32:35]
v_lshlrev_b32 v192, 16, v156
v_and_b32 v193, s58, v156
s_add_u32 s67, s67, s45
v_mfma_f32_16x16x32_bf16 v[36:39], v[140:143], v[112:115], v[36:39]
v_lshlrev_b32 v194, 16, v157
v_and_b32 v195, s58, v157
s_and_b32 s45, s40, 1
v_mfma_f32_16x16x32_bf16 v[40:43], v[140:143], v[116:119], v[40:43]
v_add_f32 v180, v180, v192
v_add_f32 v181, v181, v193
s_lshl_b32 s45, s45, 6
v_mfma_f32_16x16x32_bf16 v[44:47], v[140:143], v[120:123], v[44:47]
v_fmac_f32 v182, v192, v192
v_fmac_f32 v183, v193, v193
s_add_u32 s67, s67, s45
v_mfma_f32_16x16x32_bf16 v[84:87], v[140:143], v[128:131], v[84:87]
ds_read_b64_tr_b16 v[140:141], v208 offset:28672
ds_read_b64_tr_b16 v[142:143], v208 offset:29696
v_lshlrev_b32 v196, 16, v158
v_and_b32 v197, s58, v158
s_lshl_b32 s45, s59, 11
v_mfma_f32_16x16x32_bf16 v[48:51], v[144:147], v[108:111], v[48:51]
v_add_f32 v180, v180, v194
v_add_f32 v181, v181, v195
s_lshl_b32 s82, s46, 6
v_mfma_f32_16x16x32_bf16 v[52:55], v[144:147], v[112:115], v[52:55]
v_fmac_f32 v182, v194, v194
v_fmac_f32 v183, v195, v195
s_add_u32 s82, s82, s45
v_mfma_f32_16x16x32_bf16 v[56:59], v[144:147], v[116:119], v[56:59]
v_lshlrev_b32 v198, 16, v159
v_and_b32 v199, s58, v159
s_lshl_b32 s45, s101, 8
v_mfma_f32_16x16x32_bf16 v[60:63], v[144:147], v[120:123], v[60:63]
ds_read_b64_tr_b16 v[144:145], v208 offset:32768
ds_read_b64_tr_b16 v[146:147], v208 offset:33792
v_add_f32 v180, v180, v196
v_add_f32 v181, v181, v197
s_add_u32 s82, s82, s45
v_mfma_f32_16x16x32_bf16 v[64:67], v[148:151], v[108:111], v[64:67]
v_fmac_f32 v182, v196, v196
v_fmac_f32 v183, v197, v197
s_add_u32 s82, s82, 9535488
v_mfma_f32_16x16x32_bf16 v[68:71], v[148:151], v[112:115], v[68:71]
v_add_f32 v180, v180, v198
v_add_f32 v181, v181, v199
s_lshl_b32 s79, s43, 1
v_mfma_f32_16x16x32_bf16 v[72:75], v[148:151], v[116:119], v[72:75]
v_fmac_f32 v182, v198, v198
s_add_u32 s79, s79, s42
v_mfma_f32_16x16x32_bf16 v[76:79], v[148:151], v[120:123], v[76:79]
ds_read_b64_tr_b16 v[148:149], v208 offset:36864
ds_read_b64_tr_b16 v[150:151], v208 offset:37888
v_fmac_f32 v183, v199, v199
s_mul_i32 s45, s79, 294912
s_mov_b32 exec_lo, 0xffff0000
s_mov_b32 exec_hi, 0xffffff
buffer_load_dword v225, v226, s[32:35], 0 offen
s_mov_b64 exec, -1
v_mfma_f32_16x16x32_bf16 v[0:3], v[132:135], v[92:95], v[0:3]
s_lshl_b32 s47, s44, 11
v_mfma_f32_16x16x32_bf16 v[4:7], v[132:135], v[96:99], v[4:7]
s_lshl_b32 s48, s41, 9
v_mfma_f32_16x16x32_bf16 v[8:11], v[132:135], v[100:103], v[8:11]
s_add_u32 s45, s45, s47
v_mfma_f32_16x16x32_bf16 v[12:15], v[132:135], v[104:107], v[12:15]
s_waitcnt vmcnt(11)
s_waitcnt lgkmcnt(0)
s_barrier
ds_read_b64_tr_b16 v[132:133], v208 offset:40960
ds_read_b64_tr_b16 v[134:135], v208 offset:41984
s_add_u32 s50, s45, s48
v_mfma_f32_16x16x32_bf16 v[16:19], v[136:139], v[92:95], v[16:19]
ds_read_b128 v[156:159], v217 offset:16384
ds_read_b128 v[108:111], v215 offset:16384
ds_read_b128 v[112:115], v215 offset:18432
s_add_u32 m0, s63, 0
s_add_u32 s49, s3, 0
buffer_load_dwordx4 v168, s[32:35], s49 offen lds
s_add_u32 s51, s50, 147456
v_mfma_f32_16x16x32_bf16 v[20:23], v[136:139], v[96:99], v[20:23]
ds_read_b128 v[116:119], v215 offset:20480
ds_read_b128 v[120:123], v215 offset:22528
s_mov_b64 exec, s[60:61]
ds_read_b128 v[128:131], v215 offset:51200
s_mov_b64 exec, -1
s_add_u32 s52, s50, 16384
v_mfma_f32_16x16x32_bf16 v[24:27], v[136:139], v[100:103], v[24:27]
s_add_u32 s53, s50, 163840
v_mfma_f32_16x16x32_bf16 v[28:31], v[136:139], v[104:107], v[28:31]
s_add_u32 m0, s63, 1024
s_add_u32 s49, s3, 4096
buffer_load_dwordx4 v168, s[32:35], s49 offen lds
s_lshl_b32 s55, s79, 10
s_waitcnt lgkmcnt(0)
v_mfma_f32_16x16x32_bf16 v[80:83], v[136:139], v[124:127], v[80:83]
ds_read_b64_tr_b16 v[136:137], v208 offset:45056
ds_read_b64_tr_b16 v[138:139], v208 offset:46080
s_lshl_b32 s48, s44, 7
v_mfma_f32_16x16x32_bf16 v[32:35], v[140:143], v[92:95], v[32:35]
v_lshlrev_b32 v192, 16, v156
v_and_b32 v193, s58, v156
s_add_u32 s55, s55, s48
v_mfma_f32_16x16x32_bf16 v[36:39], v[140:143], v[96:99], v[36:39]
s_add_u32 m0, s63, 2048
s_add_u32 s49, s3, 16384
buffer_load_dwordx4 v168, s[32:35], s49 offen lds
v_lshlrev_b32 v194, 16, v157
v_and_b32 v195, s58, v157
s_lshl_b32 s48, s41, 4
v_mfma_f32_16x16x32_bf16 v[40:43], v[140:143], v[100:103], v[40:43]
v_add_f32 v180, v180, v192
v_add_f32 v181, v181, v193
s_lshr_b32 s56, s55, 1
v_mfma_f32_16x16x32_bf16 v[44:47], v[140:143], v[104:107], v[44:47]
v_fmac_f32 v182, v192, v192
v_fmac_f32 v183, v193, v193
s_add_u32 s56, s56, s48
v_mfma_f32_16x16x32_bf16 v[84:87], v[140:143], v[124:127], v[84:87]
ds_read_b64_tr_b16 v[140:141], v208 offset:49152
ds_read_b64_tr_b16 v[142:143], v208 offset:50176
s_add_u32 m0, s63, 3072
s_add_u32 s49, s3, 20480
buffer_load_dwordx4 v168, s[32:35], s49 offen lds
v_lshlrev_b32 v196, 16, v158
v_and_b32 v197, s58, v158
s_add_u32 s56, s56, 9469952
v_mfma_f32_16x16x32_bf16 v[48:51], v[144:147], v[92:95], v[48:51]
v_add_f32 v180, v180, v194
v_add_f32 v181, v181, v195
s_add_u32 s55, s55, s48
v_mfma_f32_16x16x32_bf16 v[52:55], v[144:147], v[96:99], v[52:55]
v_fmac_f32 v182, v194, v194
v_fmac_f32 v183, v195, v195
s_add_u32 s55, s55, 9437248
v_mfma_f32_16x16x32_bf16 v[56:59], v[144:147], v[100:103], v[56:59]
v_lshlrev_b32 v198, 16, v159
v_and_b32 v199, s58, v159
s_lshl_b32 s57, s59, 10
v_mfma_f32_16x16x32_bf16 v[60:63], v[144:147], v[104:107], v[60:63]
ds_read_b64_tr_b16 v[144:145], v208 offset:53248
ds_read_b64_tr_b16 v[146:147], v208 offset:54272
v_add_f32 v180, v180, v196
v_add_f32 v181, v181, v197
s_lshl_b32 s48, s101, 7
v_mfma_f32_16x16x32_bf16 v[64:67], v[148:151], v[92:95], v[64:67]
v_fmac_f32 v182, v196, v196
v_fmac_f32 v183, v197, v197
s_add_u32 s57, s57, s48
v_mfma_f32_16x16x32_bf16 v[68:71], v[148:151], v[96:99], v[68:71]
v_add_f32 v180, v180, v198
v_add_f32 v181, v181, v199
s_add_u32 s57, s57, 9437184
v_mfma_f32_16x16x32_bf16 v[72:75], v[148:151], v[100:103], v[72:75]
v_fmac_f32 v182, v198, v198
s_lshl_b32 s66, s59, 9
v_mfma_f32_16x16x32_bf16 v[76:79], v[148:151], v[104:107], v[76:79]
ds_read_b64_tr_b16 v[148:149], v208 offset:57344
ds_read_b64_tr_b16 v[150:151], v208 offset:58368
v_fmac_f32 v183, v199, v199
s_lshl_b32 s48, s41, 7
v_mfma_f32_16x16x32_bf16 v[0:3], v[132:135], v[108:111], v[0:3]
s_add_u32 s66, s66, s48
v_mfma_f32_16x16x32_bf16 v[4:7], v[132:135], v[112:115], v[4:7]
s_add_u32 s66, s66, 9469952
v_mfma_f32_16x16x32_bf16 v[8:11], v[132:135], v[116:119], v[8:11]
s_lshl_b32 s48, s101, 16
v_mfma_f32_16x16x32_bf16 v[12:15], v[132:135], v[120:123], v[12:15]
s_waitcnt vmcnt(8)
s_waitcnt lgkmcnt(0)
s_barrier
ds_read_b64_tr_b16 v[132:133], v211 offset:0
ds_read_b64_tr_b16 v[134:135], v211 offset:1024
s_lshl_b32 s68, s62, 7
v_mfma_f32_16x16x32_bf16 v[16:19], v[136:139], v[108:111], v[16:19]
ds_read_b128 v[156:159], v216 offset:32768
ds_read_b128 v[92:95], v214 offset:32768
ds_read_b128 v[96:99], v214 offset:34816
s_add_u32 m0, s63, 102400
s_add_u32 s49, s3, 32768
buffer_load_dwordx4 v168, s[32:35], s49 offen lds
s_add_u32 s68, s68, s48
v_mfma_f32_16x16x32_bf16 v[20:23], v[136:139], v[112:115], v[20:23]
ds_read_b128 v[100:103], v214 offset:36864
ds_read_b128 v[104:107], v214 offset:38912
s_mov_b64 exec, s[60:61]
ds_read_b128 v[124:127], v214 offset:53248
s_mov_b64 exec, -1
s_lshl_b32 s69, s41, 14
v_mfma_f32_16x16x32_bf16 v[24:27], v[136:139], v[116:119], v[24:27]
s_add_u32 s69, s69, 32768
v_mfma_f32_16x16x32_bf16 v[28:31], v[136:139], v[120:123], v[28:31]
s_add_u32 m0, s63, 103424
s_add_u32 s49, s3, 36864
buffer_load_dwordx4 v168, s[32:35], s49 offen lds
s_sub_u32 s69, s69, s63
s_waitcnt lgkmcnt(0)
v_mfma_f32_16x16x32_bf16 v[80:83], v[136:139], v[128:131], v[80:83]
ds_read_b64_tr_b16 v[136:137], v211 offset:4096
ds_read_b64_tr_b16 v[138:139], v211 offset:5120
s_mov_b32 s74, 200000
v_mfma_f32_16x16x32_bf16 v[32:35], v[140:143], v[108:111], v[32:35]
v_lshlrev_b32 v192, 16, v156
v_and_b32 v193, s58, v156
s_lshl_b32 s75, s59, 2
v_mfma_f32_16x16x32_bf16 v[36:39], v[140:143], v[112:115], v[36:39]
s_add_u32 m0, s63, 104448
s_add_u32 s49, s3, 49152
buffer_load_dwordx4 v168, s[32:35], s49 offen lds
v_lshlrev_b32 v194, 16, v157
v_and_b32 v195, s58, v157
s_mul_i32 s76, s101, 5120
v_mfma_f32_16x16x32_bf16 v[40:43], v[140:143], v[116:119], v[40:43]
v_add_f32 v180, v180, v192
v_add_f32 v181, v181, v193
s_add_u32 s76, s76, 32768
v_mfma_f32_16x16x32_bf16 v[44:47], v[140:143], v[120:123], v[44:47]
v_fmac_f32 v182, v192, v192
v_fmac_f32 v183, v193, v193
s_lshl_b32 s77, s101, 11
v_mfma_f32_16x16x32_bf16 v[84:87], v[140:143], v[128:131], v[84:87]
ds_read_b64_tr_b16 v[140:141], v211 offset:8192
ds_read_b64_tr_b16 v[142:143], v211 offset:9216
s_add_u32 m0, s63, 105472
s_add_u32 s49, s3, 53248
buffer_load_dwordx4 v168, s[32:35], s49 offen lds
v_lshlrev_b32 v196, 16, v158
v_and_b32 v197, s58, v158
s_add_u32 s77, s77, 16384
v_mfma_f32_16x16x32_bf16 v[48:51], v[144:147], v[108:111], v[48:51]
v_add_f32 v180, v180, v194
v_add_f32 v181, v181, v195
s_lshl_b32 s78, s41, 12
v_mfma_f32_16x16x32_bf16 v[52:55], v[144:147], v[112:115], v[52:55]
v_fmac_f32 v182, v194, v194
v_fmac_f32 v183, v195, v195
s_xor_b32 s48, s46, 0
v_mfma_f32_16x16x32_bf16 v[56:59], v[144:147], v[116:119], v[56:59]
v_lshlrev_b32 v198, 16, v159
v_and_b32 v199, s58, v159
s_add_u32 s48, s48, s75
v_mfma_f32_16x16x32_bf16 v[60:63], v[144:147], v[120:123], v[60:63]
ds_read_b64_tr_b16 v[144:145], v211 offset:12288
ds_read_b64_tr_b16 v[146:147], v211 offset:13312
v_add_f32 v180, v180, v196
v_add_f32 v181, v181, v197
s_mul_i32 s48, s48, 73728
v_mfma_f32_16x16x32_bf16 v[64:67], v[148:151], v[108:111], v[64:67]
v_fmac_f32 v182, v196, v196
v_fmac_f32 v183, v197, v197
s_add_u32 s8, s48, s76
v_mfma_f32_16x16x32_bf16 v[68:71], v[148:151], v[112:115], v[68:71]
v_add_f32 v180, v180, v198
v_add_f32 v181, v181, v199
s_add_u32 s12, s8, 4096
v_mfma_f32_16x16x32_bf16 v[72:75], v[148:151], v[116:119], v[72:75]
v_fmac_f32 v182, v198, v198
s_add_u32 s16, s48, s77
v_mfma_f32_16x16x32_bf16 v[76:79], v[148:151], v[120:123], v[76:79]
ds_read_b64_tr_b16 v[148:149], v211 offset:16384
ds_read_b64_tr_b16 v[150:151], v211 offset:17408
v_fmac_f32 v183, v199, v199
s_add_u32 s70, s48, s78
v_mfma_f32_16x16x32_bf16 v[0:3], v[132:135], v[92:95], v[0:3]
s_xor_b32 s48, s46, 1
v_mfma_f32_16x16x32_bf16 v[4:7], v[132:135], v[96:99], v[4:7]
s_add_u32 s48, s48, s75
v_mfma_f32_16x16x32_bf16 v[8:11], v[132:135], v[100:103], v[8:11]
s_mul_i32 s48, s48, 73728
v_mfma_f32_16x16x32_bf16 v[12:15], v[132:135], v[104:107], v[12:15]
s_waitcnt vmcnt(9)
s_waitcnt lgkmcnt(0)
s_barrier
ds_read_b64_tr_b16 v[132:133], v211 offset:20480
ds_read_b64_tr_b16 v[134:135], v211 offset:21504
s_add_u32 s9, s48, s76
v_mfma_f32_16x16x32_bf16 v[16:19], v[136:139], v[92:95], v[16:19]
ds_read_b128 v[156:159], v217 offset:32768
ds_read_b128 v[108:111], v215 offset:32768
ds_read_b128 v[112:115], v215 offset:34816
s_add_u32 m0, s63, 32768
s_add_u32 s49, s100, 0
buffer_load_dwordx4 v168, s[28:31], s49 offen lds
s_add_u32 s13, s9, 4096
v_mfma_f32_16x16x32_bf16 v[20:23], v[136:139], v[96:99], v[20:23]
ds_read_b128 v[116:119], v215 offset:36864
ds_read_b128 v[120:123], v215 offset:38912
s_mov_b64 exec, s[60:61]
ds_read_b128 v[128:131], v215 offset:53248
s_mov_b64 exec, -1
s_add_u32 s17, s48, s77
v_mfma_f32_16x16x32_bf16 v[24:27], v[136:139], v[100:103], v[24:27]
s_add_u32 s71, s48, s78
v_mfma_f32_16x16x32_bf16 v[28:31], v[136:139], v[104:107], v[28:31]
s_add_u32 m0, s63, 33792
s_add_u32 s49, s100, 4096
buffer_load_dwordx4 v168, s[28:31], s49 offen lds
s_xor_b32 s48, s46, 2
s_waitcnt lgkmcnt(0)
v_mfma_f32_16x16x32_bf16 v[80:83], v[136:139], v[124:127], v[80:83]
ds_read_b64_tr_b16 v[136:137], v211 offset:24576
ds_read_b64_tr_b16 v[138:139], v211 offset:25600
s_add_u32 s48, s48, s75
v_mfma_f32_16x16x32_bf16 v[32:35], v[140:143], v[92:95], v[32:35]
v_lshlrev_b32 v192, 16, v156
v_and_b32 v193, s58, v156
s_mul_i32 s48, s48, 73728
v_mfma_f32_16x16x32_bf16 v[36:39], v[140:143], v[96:99], v[36:39]
s_add_u32 m0, s63, 34816
s_add_u32 s49, s100, 16384
buffer_load_dwordx4 v168, s[28:31], s49 offen lds
v_lshlrev_b32 v194, 16, v157
v_and_b32 v195, s58, v157
s_add_u32 s10, s48, s76
v_mfma_f32_16x16x32_bf16 v[40:43], v[140:143], v[100:103], v[40:43]
v_add_f32 v180, v180, v192
v_add_f32 v181, v181, v193
s_add_u32 s14, s10, 4096
v_mfma_f32_16x16x32_bf16 v[44:47], v[140:143], v[104:107], v[44:47]
v_fmac_f32 v182, v192, v192
v_fmac_f32 v183, v193, v193
s_add_u32 s18, s48, s77
v_mfma_f32_16x16x32_bf16 v[84:87], v[140:143], v[124:127], v[84:87]
ds_read_b64_tr_b16 v[140:141], v211 offset:28672
ds_read_b64_tr_b16 v[142:143], v211 offset:29696
s_add_u32 m0, s63, 35840
s_add_u32 s49, s100, 20480
buffer_load_dwordx4 v168, s[28:31], s49 offen lds
v_lshlrev_b32 v196, 16, v158
v_and_b32 v197, s58, v158
s_add_u32 s72, s48, s78
v_mfma_f32_16x16x32_bf16 v[48:51], v[144:147], v[92:95], v[48:51]
v_add_f32 v180, v180, v194
v_add_f32 v181, v181, v195
s_xor_b32 s48, s46, 3
v_mfma_f32_16x16x32_bf16 v[52:55], v[144:147], v[96:99], v[52:55]
v_fmac_f32 v182, v194, v194
v_fmac_f32 v183, v195, v195
s_add_u32 s48, s48, s75
v_mfma_f32_16x16x32_bf16 v[56:59], v[144:147], v[100:103], v[56:59]
v_lshlrev_b32 v198, 16, v159
v_and_b32 v199, s58, v159
s_mul_i32 s48, s48, 73728
v_mfma_f32_16x16x32_bf16 v[60:63], v[144:147], v[104:107], v[60:63]
ds_read_b64_tr_b16 v[144:145], v211 offset:32768
ds_read_b64_tr_b16 v[146:147], v211 offset:33792
v_add_f32 v180, v180, v196
v_add_f32 v181, v181, v197
s_add_u32 s11, s48, s76
v_mfma_f32_16x16x32_bf16 v[64:67], v[148:151], v[92:95], v[64:67]
v_fmac_f32 v182, v196, v196
v_fmac_f32 v183, v197, v197
s_add_u32 s15, s11, 4096
v_mfma_f32_16x16x32_bf16 v[68:71], v[148:151], v[96:99], v[68:71]
v_add_f32 v180, v180, v198
v_add_f32 v181, v181, v199
s_add_u32 s19, s48, s77
v_mfma_f32_16x16x32_bf16 v[72:75], v[148:151], v[100:103], v[72:75]
v_fmac_f32 v182, v198, v198
s_add_u32 s73, s48, s78
v_mfma_f32_16x16x32_bf16 v[76:79], v[148:151], v[104:107], v[76:79]
ds_read_b64_tr_b16 v[148:149], v211 offset:36864
ds_read_b64_tr_b16 v[150:151], v211 offset:37888
v_fmac_f32 v183, v199, v199
v_mfma_f32_16x16x32_bf16 v[0:3], v[132:135], v[108:111], v[0:3]
v_add_f32 v180, v180, v181
v_add_f32 v181, v182, v183
v_mov_b32 v192, v180
v_mfma_f32_16x16x32_bf16 v[4:7], v[132:135], v[112:115], v[4:7]
v_mov_b32 v193, v181
v_permlane32_swap_b32 v180, v192
s_nop 0
v_permlane32_swap_b32 v181, v193
v_mfma_f32_16x16x32_bf16 v[8:11], v[132:135], v[116:119], v[8:11]
v_add_f32 v180, v180, v192
v_add_f32 v181, v181, v193
v_mov_b32 v192, v180
v_mfma_f32_16x16x32_bf16 v[12:15], v[132:135], v[120:123], v[12:15]
v_mov_b32 v193, v181
v_permlane16_swap_b32 v180, v192
s_nop 0
v_permlane16_swap_b32 v181, v193
s_waitcnt lgkmcnt(6)
v_mfma_f32_16x16x32_bf16 v[16:19], v[136:139], v[108:111], v[16:19]
v_add_f32 v180, v180, v192
v_add_f32 v181, v181, v193
v_mul_f32 v180, 0x3b000000, v180
v_mfma_f32_16x16x32_bf16 v[20:23], v[136:139], v[112:115], v[20:23]
v_mul_f32 v181, 0x3b000000, v181
v_fma_f32 v181, -v180, v180, v181
v_max_f32 v181, 0, v181
v_mfma_f32_16x16x32_bf16 v[24:27], v[136:139], v[116:119], v[24:27]
v_cvt_pk_bf16_f32 v192, v180, v181
v_lshlrev_b32 v180, 16, v192
v_and_b32 v181, 0xffff0000, v192
v_mfma_f32_16x16x32_bf16 v[28:31], v[136:139], v[120:123], v[28:31]
v_add_f32 v181, 0x3727c5ac, v181
v_cvt_pk_bf16_f32 v181, v181, v181
v_lshlrev_b32 v181, 16, v181
v_mfma_f32_16x16x32_bf16 v[80:83], v[136:139], v[128:131], v[80:83]
v_sqrt_f32 v181, v181
s_nop 0
v_cvt_pk_bf16_f32 v181, v181, v181
v_lshlrev_b32 v181, 16, v181
s_waitcnt lgkmcnt(4)
v_mfma_f32_16x16x32_bf16 v[84:87], v[140:143], v[128:131], v[84:87]
v_rcp_f32 v192, v181
v_xor_b32 v182, 0x80000000, v180
s_waitcnt lgkmcnt(2)
v_mfma_f32_16x16x32_bf16 v[48:51], v[144:147], v[108:111], v[48:51]
v_fma_f32 v181, -v181, v192, 1.0
v_fma_f32 v183, v181, v192, v192
v_mfma_f32_16x16x32_bf16 v[52:55], v[144:147], v[112:115], v[52:55]
s_not_b64 exec, s[60:61]
ds_write_b128 v246, v[80:83] offset:64
ds_write_b128 v246, v[84:87] offset:128
s_mov_b64 exec, 0xffff
ds_write_b64 v245, v[182:183]
s_mov_b64 exec, -1
v_mfma_f32_16x16x32_bf16 v[56:59], v[144:147], v[116:119], v[56:59]
v_mfma_f32_16x16x32_bf16 v[60:63], v[144:147], v[120:123], v[60:63]
s_waitcnt lgkmcnt(0)
v_mfma_f32_16x16x32_bf16 v[64:67], v[148:151], v[108:111], v[64:67]
s_waitcnt lgkmcnt(0)
s_barrier
ds_read_b64 v[228:229], v244 offset:0
ds_read_b64 v[230:231], v244 offset:128
ds_read_b64 v[232:233], v244 offset:256
ds_read_b64 v[234:235], v244 offset:384
ds_read_b128 v[220:223], v246 offset:192
ds_read_b128 v[224:227], v246 offset:256
ds_read_b128 v[216:219], v246 offset:128
ds_read_b128 v[212:215], v246 offset:64
ds_read_b128 v[208:211], v246 offset:0
v_mfma_f32_16x16x32_bf16 v[68:71], v[148:151], v[112:115], v[68:71]
ds_read_b64 v[174:175], v174
ds_read_b64 v[92:93], v244 offset:1024
ds_read_b64 v[94:95], v244 offset:1152
ds_read_b64 v[96:97], v244 offset:1280
ds_read_b64 v[98:99], v244 offset:1408
v_mfma_f32_16x16x32_bf16 v[72:75], v[148:151], v[116:119], v[72:75]
s_add_u32 m0, s63, 65536
s_add_u32 s49, s100, 262144
buffer_load_dwordx4 v168, s[28:31], s49 offen lds
v_mfma_f32_16x16x32_bf16 v[76:79], v[148:151], v[120:123], v[76:79]
s_add_u32 m0, s63, 66560
s_add_u32 s49, s100, 266240
buffer_load_dwordx4 v168, s[28:31], s49 offen lds
v_mfma_f32_16x16x32_bf16 v[32:35], v[140:143], v[108:111], v[32:35]
s_add_u32 m0, s63, 67584
s_add_u32 s49, s100, 278528
buffer_load_dwordx4 v168, s[28:31], s49 offen lds
v_mfma_f32_16x16x32_bf16 v[36:39], v[140:143], v[112:115], v[36:39]
s_add_u32 m0, s63, 68608
s_add_u32 s49, s100, 282624
buffer_load_dwordx4 v168, s[28:31], s49 offen lds
v_mfma_f32_16x16x32_bf16 v[40:43], v[140:143], v[116:119], v[40:43]
v_mfma_f32_16x16x32_bf16 v[44:47], v[140:143], v[120:123], v[44:47]
s_branch L_epi1
L_t1m1:
s_lshr_b32 s46, s2, 5
s_mul_i32 s0, s46, 3584
s_lshl_b32 s46, s44, 7
s_add_u32 s0, s0, s46
s_add_u32 s0, s0, 229376
s_mov_b32 s1, 229376
s_mov_b32 s20, 0xff
s_mov_b32 s21, 1835008
v_mul_u32_u24 v247, 28672, v167
s_cmp_lt_u32 s41, 2
s_cbranch_scc1 L_pf11
s_mul_i32 s46, s41, 14
s_sub_u32 s46, s46, 14
v_add_u32 v247, s46, v167
v_min_u32 v247, 39, v247
s_bfe_u32 s46, s2, 0x20003
s_lshl_b32 s49, s43, 2
s_add_u32 s49, s49, s46
s_lshl_b32 s49, s49, 5
s_mul_i32 s46, s46, 24
s_add_u32 s46, s46, 48
v_cmp_lt_u32 vcc, 31, v247
v_add_u32 v247, s49, v247
v_subrev_u32 v240, s46, v247
v_max_i32 v240, 0, v240
v_cndmask_b32 v247, v247, v240, vcc
v_lshlrev_b32 v247, 10, v247
s_mov_b32 s0, 128
s_mov_b32 s1, 128
s_mov_b32 s20, 0x3fff
s_mov_b32 s21, 0x200000
L_pf11:
v_mul_u32_u24 v220, 3584, v232
v_add_u32 v220, v220, v233
s_lshl_b32 s50, s44, 7
s_waitcnt lgkmcnt(0)
s_mov_b64 s[4:5], s[64:65]
s_mov_b64 s[8:9], s[72:73]
s_mov_b64 s[12:13], s[74:75]
s_mov_b32 s70, s20
s_mov_b32 s71, 0
s_cmp_eq_u32 s41, 0
s_cselect_b64 s[72:73], s[72:73], s[74:75]
s_cmp_lt_u32 s41, 2
s_cselect_b64 s[72:73], s[72:73], s[64:65]
s_mov_b32 s74, s21
s_mov_b32 s75, 0x00020000
s_mov_b64 exec, s[70:71]
buffer_load_dword v225, v247, s[72:75], s0 offen
s_mov_b64 exec, -1
s_add_u32 s0, s0, s1
s_add_u32 m0, s56, 128000
s_nop 0
buffer_load_dwordx4 v223, s[4:7], s53 offen offset:0 lds
s_add_u32 m0, s56, 119808
s_nop 0
buffer_load_dwordx4 v223, s[4:7], s52 offen offset:0 lds
s_add_u32 m0, s56, 126976
s_nop 0
buffer_load_dwordx4 v222, s[4:7], s53 offen offset:0 lds
s_add_u32 m0, s55, 94208
s_nop 0
buffer_load_dwordx4 v220, s[8:11], s50 offen offset:0 lds
s_add_u32 m0, s55, 98304
s_nop 0
buffer_load_dwordx4 v220, s[12:15], s50 offen offset:0 lds
s_add_u32 s50, s50, 114688
s_add_u32 m0, s55, 12288
s_nop 0
buffer_load_dwordx4 v220, s[8:11], s50 offen offset:0 lds
s_add_u32 m0, s55, 16384
s_nop 0
buffer_load_dwordx4 v220, s[12:15], s50 offen offset:0 lds
s_add_u32 s50, s50, 114688
s_mov_b64 exec, s[70:71]
buffer_load_dword v225, v247, s[72:75], s0 offen
s_mov_b64 exec, -1
s_add_u32 s0, s0, s1
s_add_u32 m0, s56, 144256
s_nop 0
buffer_load_dwordx4 v223, s[4:7], s53 offen offset:128 lds
s_add_u32 m0, s56, 136064
s_nop 0
buffer_load_dwordx4 v223, s[4:7], s52 offen offset:128 lds
s_add_u32 m0, s56, 143232
s_nop 0
buffer_load_dwordx4 v222, s[4:7], s53 offen offset:128 lds
s_add_u32 m0, s55, 32768
s_nop 0
buffer_load_dwordx4 v220, s[8:11], s50 offen offset:0 lds
s_add_u32 m0, s55, 36864
s_nop 0
buffer_load_dwordx4 v220, s[12:15], s50 offen offset:0 lds
s_add_u32 s50, s50, 114688
s_mov_b64 exec, s[70:71]
buffer_load_dword v225, v247, s[72:75], s0 offen
s_mov_b64 exec, -1
s_add_u32 s0, s0, s1
s_mov_b64 s[20:21], s[82:83]
s_mov_b64 s[24:25], s[80:81]
s_mov_b64 s[28:29], s[68:69]
s_mov_b64 s[32:33], s[76:77]
s_mov_b64 s[36:37], s[78:79]
s_mov_b32 s23, 0x00020000
s_mov_b32 s27, 0x00020000
s_mov_b32 s31, 0x00020000
s_mov_b32 s35, 0x00020000
s_mov_b32 s39, 0x00020000
s_mov_b32 s22, 9601024
s_mov_b32 s26, 256
s_mov_b32 s30, 524288
s_mov_b32 s34, 1835008
s_mov_b32 s38, 0x200000
s_mov_b32 s58, 0xffff0000
s_mov_b32 s60, 0xfffefffe
s_mov_b32 s61, 0xfffefffe
s_and_b32 s45, s2, 6
s_lshr_b32 s46, s2, 7
s_add_u32 s45, s45, s46
s_lshl_b32 s45, s45, 1
s_and_b32 s46, s2, 1
s_add_u32 s45, s45, s46
s_lshl_b32 s45, s45, 1
s_bfe_u32 s46, s2, 0x10006
s_add_u32 s59, s45, s46
s_bfe_u32 s62, s2, 0x30003
s_lshl_b32 s63, s40, 12
s_add_u32 s101, s40, s62
s_and_b32 s101, s101, 7
s_lshl_b32 s45, s62, 7
s_lshl_b32 s100, s40, 15
s_add_u32 s100, s100, s45
s_mul_i32 s3, s101, 163840
s_add_u32 s3, s3, 524288
s_add_u32 s3, s3, s45
v_bfe_u32 v232, v167, 2, 3
v_lshrrev_b32 v233, 5, v167
v_lshlrev_b32 v234, 11, v233
v_lshl_add_u32 v234, v232, 7, v234
v_and_b32 v235, 3, v167
v_lshl_add_u32 v234, v235, 3, v234
v_lshrrev_b32 v236, 1, v232
s_and_b32 s45, s40, 1
s_lshl_b32 s45, s45, 1
v_xor_b32 v237, s45, v236
v_add_u32 v239, s63, v234
v_xor_b32 v238, 0, v237
v_lshl_add_u32 v169, v238, 5, v239
v_xor_b32 v238, 1, v237
v_lshl_add_u32 v170, v238, 5, v239
v_xor_b32 v238, 2, v237
v_lshl_add_u32 v171, v238, 5, v239
v_xor_b32 v238, 3, v237
v_lshl_add_u32 v172, v238, 5, v239
v_xor_b32 v236, s41, v236
v_lshl_add_u32 v208, v236, 5, v234
v_add_u32 v211, 61440, v208
v_and_b32 v232, 15, v167
v_lshrrev_b32 v233, 4, v167
v_lshrrev_b32 v234, 1, v232
v_xor_b32 v233, v233, v234
v_lshlrev_b32 v233, 4, v233
v_lshl_add_u32 v233, v232, 7, v233
v_add_u32 v214, 110592, v233
v_xor_b32 v215, 64, v214
v_add_u32 v216, s56, v214
v_add_u32 v217, s56, v215
s_lshl_b32 s45, s41, 2
s_sub_u32 s45, s45, 8192
v_add_u32 v218, s45, v214
v_add_u32 v219, s45, v215
v_mov_b32 v152, 0x3f803f80
v_mov_b32 v153, 0x3f803f80
v_mov_b32 v154, 0x3f803f80
v_mov_b32 v155, 0x3f803f80
v_mov_b32 v180, 0
v_mov_b32 v181, 0
v_mov_b32 v182, 0
v_mov_b32 v183, 0
v_mov_b32 v184, 0
v_mov_b32 v185, 0
v_lshrrev_b32 v226, 3, v167
v_lshlrev_b32 v226, 15, v226
v_and_b32 v227, 7, v167
v_lshl_add_u32 v226, v227, 10, v226
s_lshr_b32 s45, s2, 6
s_lshl_b32 s45, s45, 13
v_add_u32 v226, s45, v226
v_and_b32 v227, 8, v167
v_mul_u32_u24 v227, 28672, v227
v_add3_u32 v227, v227, v226, s100
s_lshl_b32 s45, s101, 16
s_lshl_b32 s46, s62, 7
s_add_u32 s45, s45, s46
s_sub_u32 s45, s45, 163840
v_add_u32 v233, s45, v226
v_add_u32 v226, s3, v226
v_cmp_lt_u32 vcc, 39, v167
s_nop 1
v_cndmask_b32 v226, v226, v233, vcc
v_lshlrev_b32 v164, 4, v167
v_and_b32 v232, 0xf0, v164
v_bfe_u32 v233, v167, 4, 1
v_lshrrev_b32 v234, 5, v167
v_lshl_add_u32 v235, v233, 1, v234
v_lshlrev_b32 v165, 6, v232
v_lshl_add_u32 v165, v235, 4, v165
v_mov_b32 v174, 160512
v_lshrrev_b32 v244, 1, v232
v_add_u32 v244, 158208, v244
s_lshl_b32 s45, s41, 7
v_add_u32 v245, s45, v244
v_and_b32 v246, 0x30, v167
s_mul_i32 s45, s41, 320
s_add_u32 s45, s45, 159232
v_mul_u32_u24 v240, 73728, v233
v_lshl_add_u32 v240, v234, 8, v240
v_add_u32 v240, v240, v232
s_mul_i32 s46, s41, 4608
s_add_u32 s46, s46, 137216
v_lshrrev_b32 v241, 1, v246
v_lshl_add_u32 v241, v232, 1, v241
v_add_u32 v241, s46, v241
v_lshlrev_b32 v243, 3, v167
v_add_u32 v242, s46, v243
s_lshl_b32 s46, s41, 9
s_add_u32 s46, s46, 153600
v_add_u32 v243, s46, v243
v_add_u32 v246, s45, v246
s_waitcnt vmcnt(9)
s_waitcnt lgkmcnt(0)
s_barrier
ds_read_b128 v[92:95], v214 offset:16384
ds_read_b128 v[96:99], v214 offset:18432
ds_read_b128 v[100:103], v214 offset:20480
ds_read_b128 v[104:107], v214 offset:22528
ds_read_b64_tr_b16 v[132:133], v211 offset:20480
ds_read_b64_tr_b16 v[134:135], v211 offset:21504
ds_read_b64_tr_b16 v[136:137], v211 offset:24576
ds_read_b64_tr_b16 v[138:139], v211 offset:25600
ds_read_b64_tr_b16 v[140:141], v211 offset:28672
ds_read_b64_tr_b16 v[142:143], v211 offset:29696
ds_read_b64_tr_b16 v[144:145], v211 offset:32768
ds_read_b64_tr_b16 v[146:147], v211 offset:33792
ds_read_b64_tr_b16 v[148:149], v211 offset:36864
ds_read_b64_tr_b16 v[150:151], v211 offset:37888
ds_read_b128 v[248:251], v216 offset:16384
ds_read_b32 v252, v218 offset:51200
s_waitcnt lgkmcnt(10)
v_mfma_f32_16x16x32_bf16 v[0:3], v[132:135], v[92:95], 0
v_mfma_f32_16x16x32_bf16 v[4:7], v[132:135], v[96:99], 0
v_mfma_f32_16x16x32_bf16 v[8:11], v[132:135], v[100:103], 0
v_mfma_f32_16x16x32_bf16 v[12:15], v[132:135], v[104:107], 0
v_mfma_f32_16x16x32_bf16 v[80:83], v[132:135], v[152:155], 0
s_waitcnt vmcnt(7)
s_waitcnt lgkmcnt(0)
s_barrier
ds_read_b64_tr_b16 v[132:133], v208 offset:0
ds_read_b64_tr_b16 v[134:135], v208 offset:1024
v_mfma_f32_16x16x32_bf16 v[16:19], v[136:139], v[92:95], 0
ds_read_b128 v[156:159], v217 offset:16384
ds_read_b32 v166, v219 offset:51200
ds_read_b128 v[108:111], v215 offset:16384
ds_read_b128 v[112:115], v215 offset:18432
s_add_u32 m0, s55, 53248
s_nop 0
buffer_load_dwordx4 v220, s[8:11], s50 offen offset:0 lds
v_lshlrev_b32 v192, 16, v248
v_and_b32 v193, s58, v248
v_lshlrev_b32 v194, 16, v249
v_and_b32 v195, s58, v249
v_mfma_f32_16x16x32_bf16 v[20:23], v[136:139], v[96:99], 0
ds_read_b128 v[116:119], v215 offset:20480
ds_read_b128 v[120:123], v215 offset:22528
v_add_f32 v180, v180, v192
v_add_f32 v181, v181, v193
v_fmac_f32 v182, v192, v192
v_fmac_f32 v183, v193, v193
v_mfma_f32_16x16x32_bf16 v[24:27], v[136:139], v[100:103], 0
v_lshlrev_b32 v196, 16, v250
v_and_b32 v197, s58, v250
v_add_f32 v180, v180, v194
v_add_f32 v181, v181, v195
v_mfma_f32_16x16x32_bf16 v[28:31], v[136:139], v[104:107], 0
ds_read_b64_tr_b16 v[136:137], v208 offset:4096
ds_read_b64_tr_b16 v[138:139], v208 offset:5120
s_add_u32 m0, s55, 57344
s_nop 0
buffer_load_dwordx4 v220, s[12:15], s50 offen offset:0 lds
s_add_u32 s50, s50, 114688
v_fmac_f32 v182, v194, v194
v_fmac_f32 v183, v195, v195
v_lshlrev_b32 v198, 16, v251
v_and_b32 v199, s58, v251
v_mfma_f32_16x16x32_bf16 v[32:35], v[140:143], v[92:95], 0
v_add_f32 v180, v180, v196
v_add_f32 v181, v181, v197
v_fmac_f32 v182, v196, v196
v_fmac_f32 v183, v197, v197
v_mfma_f32_16x16x32_bf16 v[36:39], v[140:143], v[96:99], 0
v_add_f32 v180, v180, v198
v_add_f32 v181, v181, v199
v_fmac_f32 v182, v198, v198
v_fmac_f32 v183, v199, v199
v_mfma_f32_16x16x32_bf16 v[40:43], v[140:143], v[100:103], 0
s_add_u32 m0, s56, 111360
s_nop 0
buffer_load_dwordx4 v223, s[4:7], s53 offen offset:256 lds
v_lshlrev_b32 v200, 16, v252
v_and_b32 v201, s58, v252
v_add_f32 v184, v184, v200
v_mfma_f32_16x16x32_bf16 v[44:47], v[140:143], v[104:107], 0
ds_read_b64_tr_b16 v[140:141], v208 offset:8192
ds_read_b64_tr_b16 v[142:143], v208 offset:9216
v_fmac_f32 v185, v200, v200
v_add_f32 v184, v184, v201
v_fmac_f32 v185, v201, v201
v_mfma_f32_16x16x32_bf16 v[48:51], v[144:147], v[92:95], 0
s_waitcnt lgkmcnt(8)
v_lshlrev_b32 v192, 16, v156
v_and_b32 v193, s58, v156
v_lshlrev_b32 v194, 16, v157
v_mfma_f32_16x16x32_bf16 v[52:55], v[144:147], v[96:99], 0
s_add_u32 m0, s56, 103168
s_nop 0
buffer_load_dwordx4 v223, s[4:7], s52 offen offset:256 lds
v_and_b32 v195, s58, v157
v_add_f32 v180, v180, v192
v_add_f32 v181, v181, v193
v_mfma_f32_16x16x32_bf16 v[56:59], v[144:147], v[100:103], 0
v_fmac_f32 v182, v192, v192
v_fmac_f32 v183, v193, v193
v_lshlrev_b32 v196, 16, v158
v_mfma_f32_16x16x32_bf16 v[60:63], v[144:147], v[104:107], 0
v_and_b32 v197, s58, v158
v_add_f32 v180, v180, v194
v_add_f32 v181, v181, v195
v_mfma_f32_16x16x32_bf16 v[84:87], v[144:147], v[152:155], 0
ds_read_b64_tr_b16 v[144:145], v208 offset:12288
ds_read_b64_tr_b16 v[146:147], v208 offset:13312
s_add_u32 m0, s56, 110336
s_nop 0
buffer_load_dwordx4 v222, s[4:7], s53 offen offset:256 lds
v_fmac_f32 v182, v194, v194
v_fmac_f32 v183, v195, v195
v_lshlrev_b32 v198, 16, v159
v_mfma_f32_16x16x32_bf16 v[64:67], v[148:151], v[92:95], 0
v_and_b32 v199, s58, v159
v_add_f32 v180, v180, v196
v_add_f32 v181, v181, v197
v_mfma_f32_16x16x32_bf16 v[68:71], v[148:151], v[96:99], 0
v_fmac_f32 v182, v196, v196
v_fmac_f32 v183, v197, v197
v_add_f32 v180, v180, v198
v_mfma_f32_16x16x32_bf16 v[72:75], v[148:151], v[100:103], 0
s_add_u32 m0, s55, 73728
s_nop 0
buffer_load_dwordx4 v220, s[8:11], s50 offen offset:0 lds
v_add_f32 v181, v181, v199
v_fmac_f32 v182, v198, v198
v_fmac_f32 v183, v199, v199
v_mfma_f32_16x16x32_bf16 v[76:79], v[148:151], v[104:107], 0
v_lshlrev_b32 v200, 16, v166
v_and_b32 v201, s58, v166
v_add_f32 v184, v184, v200
v_mfma_f32_16x16x32_bf16 v[88:91], v[148:151], v[152:155], 0
ds_read_b64_tr_b16 v[148:149], v208 offset:16384
ds_read_b64_tr_b16 v[150:151], v208 offset:17408
v_fmac_f32 v185, v200, v200
v_add_f32 v184, v184, v201
v_fmac_f32 v185, v201, v201
s_waitcnt lgkmcnt(8)
v_mfma_f32_16x16x32_bf16 v[0:3], v[132:135], v[108:111], v[0:3]
v_mfma_f32_16x16x32_bf16 v[4:7], v[132:135], v[112:115], v[4:7]
v_mfma_f32_16x16x32_bf16 v[8:11], v[132:135], v[116:119], v[8:11]
v_mfma_f32_16x16x32_bf16 v[12:15], v[132:135], v[120:123], v[12:15]
v_mfma_f32_16x16x32_bf16 v[80:83], v[132:135], v[152:155], v[80:83]
s_waitcnt vmcnt(7)
s_waitcnt lgkmcnt(0)
s_barrier
ds_read_b64_tr_b16 v[132:133], v208 offset:20480
ds_read_b64_tr_b16 v[134:135], v208 offset:21504
v_mfma_f32_16x16x32_bf16 v[16:19], v[136:139], v[108:111], v[16:19]
ds_read_b128 v[156:159], v216 offset:32768
ds_read_b32 v166, v218 offset:53248
ds_read_b128 v[92:95], v214 offset:32768
ds_read_b128 v[96:99], v214 offset:34816
s_add_u32 m0, s55, 77824
s_nop 0
buffer_load_dwordx4 v220, s[12:15], s50 offen offset:0 lds
s_add_u32 s50, s50, 114688
v_mfma_f32_16x16x32_bf16 v[20:23], v[136:139], v[112:115], v[20:23]
ds_read_b128 v[100:103], v214 offset:36864
ds_read_b128 v[104:107], v214 offset:38912
v_mfma_f32_16x16x32_bf16 v[24:27], v[136:139], v[116:119], v[24:27]
v_mfma_f32_16x16x32_bf16 v[28:31], v[136:139], v[120:123], v[28:31]
ds_read_b64_tr_b16 v[136:137], v208 offset:24576
ds_read_b64_tr_b16 v[138:139], v208 offset:25600
s_add_u32 m0, s55, 94208
s_nop 0
buffer_load_dwordx4 v220, s[8:11], s50 offen offset:0 lds
v_mfma_f32_16x16x32_bf16 v[32:35], v[140:143], v[108:111], v[32:35]
s_waitcnt lgkmcnt(6)
v_lshlrev_b32 v192, 16, v156
v_and_b32 v193, s58, v156
v_lshlrev_b32 v194, 16, v157
v_mfma_f32_16x16x32_bf16 v[36:39], v[140:143], v[112:115], v[36:39]
v_and_b32 v195, s58, v157
v_add_f32 v180, v180, v192
v_add_f32 v181, v181, v193
v_mfma_f32_16x16x32_bf16 v[40:43], v[140:143], v[116:119], v[40:43]
s_add_u32 m0, s55, 98304
s_nop 0
buffer_load_dwordx4 v220, s[12:15], s50 offen offset:0 lds
s_add_u32 s50, s50, 114688
v_fmac_f32 v182, v192, v192
v_fmac_f32 v183, v193, v193
v_mfma_f32_16x16x32_bf16 v[44:47], v[140:143], v[120:123], v[44:47]
ds_read_b64_tr_b16 v[140:141], v208 offset:28672
ds_read_b64_tr_b16 v[142:143], v208 offset:29696
v_lshlrev_b32 v196, 16, v158
v_and_b32 v197, s58, v158
v_mfma_f32_16x16x32_bf16 v[48:51], v[144:147], v[108:111], v[48:51]
v_add_f32 v180, v180, v194
v_add_f32 v181, v181, v195
v_mfma_f32_16x16x32_bf16 v[52:55], v[144:147], v[112:115], v[52:55]
s_add_u32 m0, s55, 12288
s_nop 0
buffer_load_dwordx4 v220, s[8:11], s50 offen offset:0 lds
v_fmac_f32 v182, v194, v194
v_fmac_f32 v183, v195, v195
v_mfma_f32_16x16x32_bf16 v[56:59], v[144:147], v[116:119], v[56:59]
v_lshlrev_b32 v198, 16, v159
v_and_b32 v199, s58, v159
v_mfma_f32_16x16x32_bf16 v[60:63], v[144:147], v[120:123], v[60:63]
v_add_f32 v180, v180, v196
v_add_f32 v181, v181, v197
v_mfma_f32_16x16x32_bf16 v[84:87], v[144:147], v[152:155], v[84:87]
ds_read_b64_tr_b16 v[144:145], v208 offset:32768
ds_read_b64_tr_b16 v[146:147], v208 offset:33792
s_add_u32 m0, s55, 16384
s_nop 0
buffer_load_dwordx4 v220, s[12:15], s50 offen offset:0 lds
s_add_u32 s50, s50, 114688
v_fmac_f32 v182, v196, v196
v_fmac_f32 v183, v197, v197
v_mfma_f32_16x16x32_bf16 v[64:67], v[148:151], v[108:111], v[64:67]
v_add_f32 v180, v180, v198
v_add_f32 v181, v181, v199
v_mfma_f32_16x16x32_bf16 v[68:71], v[148:151], v[112:115], v[68:71]
v_fmac_f32 v182, v198, v198
v_fmac_f32 v183, v199, v199
v_mfma_f32_16x16x32_bf16 v[72:75], v[148:151], v[116:119], v[72:75]
s_add_u32 m0, s56, 119424
s_nop 0
buffer_load_dwordx4 v223, s[4:7], s52 offen offset:384 lds
v_lshlrev_b32 v200, 16, v166
v_and_b32 v201, s58, v166
v_mfma_f32_16x16x32_bf16 v[76:79], v[148:151], v[120:123], v[76:79]
v_add_f32 v184, v184, v200
v_fmac_f32 v185, v200, v200
v_mfma_f32_16x16x32_bf16 v[88:91], v[148:151], v[152:155], v[88:91]
ds_read_b64_tr_b16 v[148:149], v208 offset:36864
ds_read_b64_tr_b16 v[150:151], v208 offset:37888
v_add_f32 v184, v184, v201
v_fmac_f32 v185, v201, v201
s_mov_b64 exec, s[70:71]
buffer_load_dword v225, v247, s[72:75], s0 offen
s_mov_b64 exec, -1
s_add_u32 s0, s0, s1
s_waitcnt lgkmcnt(8)
v_mfma_f32_16x16x32_bf16 v[0:3], v[132:135], v[92:95], v[0:3]
v_mfma_f32_16x16x32_bf16 v[4:7], v[132:135], v[96:99], v[4:7]
v_mfma_f32_16x16x32_bf16 v[8:11], v[132:135], v[100:103], v[8:11]
v_mfma_f32_16x16x32_bf16 v[12:15], v[132:135], v[104:107], v[12:15]
v_mfma_f32_16x16x32_bf16 v[80:83], v[132:135], v[152:155], v[80:83]
s_waitcnt vmcnt(11)
s_waitcnt lgkmcnt(0)
s_barrier
ds_read_b64_tr_b16 v[132:133], v208 offset:40960
ds_read_b64_tr_b16 v[134:135], v208 offset:41984
v_mfma_f32_16x16x32_bf16 v[16:19], v[136:139], v[92:95], v[16:19]
ds_read_b128 v[156:159], v217 offset:32768
ds_read_b32 v166, v219 offset:53248
ds_read_b128 v[108:111], v215 offset:32768
ds_read_b128 v[112:115], v215 offset:34816
s_add_u32 m0, s56, 126592
s_nop 0
buffer_load_dwordx4 v222, s[4:7], s53 offen offset:384 lds
v_mfma_f32_16x16x32_bf16 v[20:23], v[136:139], v[96:99], v[20:23]
ds_read_b128 v[116:119], v215 offset:36864
ds_read_b128 v[120:123], v215 offset:38912
v_mfma_f32_16x16x32_bf16 v[24:27], v[136:139], v[100:103], v[24:27]
v_mfma_f32_16x16x32_bf16 v[28:31], v[136:139], v[104:107], v[28:31]
ds_read_b64_tr_b16 v[136:137], v208 offset:45056
ds_read_b64_tr_b16 v[138:139], v208 offset:46080
s_add_u32 m0, s56, 127616
s_nop 0
buffer_load_dwordx4 v223, s[4:7], s53 offen offset:384 lds
v_mfma_f32_16x16x32_bf16 v[32:35], v[140:143], v[92:95], v[32:35]
s_waitcnt lgkmcnt(6)
v_lshlrev_b32 v192, 16, v156
v_and_b32 v193, s58, v156
v_lshlrev_b32 v194, 16, v157
v_mfma_f32_16x16x32_bf16 v[36:39], v[140:143], v[96:99], v[36:39]
v_and_b32 v195, s58, v157
v_add_f32 v180, v180, v192
v_add_f32 v181, v181, v193
v_mfma_f32_16x16x32_bf16 v[40:43], v[140:143], v[100:103], v[40:43]
s_add_u32 m0, s55, 32768
s_nop 0
buffer_load_dwordx4 v220, s[8:11], s50 offen offset:0 lds
v_fmac_f32 v182, v192, v192
v_fmac_f32 v183, v193, v193
v_mfma_f32_16x16x32_bf16 v[44:47], v[140:143], v[104:107], v[44:47]
ds_read_b64_tr_b16 v[140:141], v208 offset:49152
ds_read_b64_tr_b16 v[142:143], v208 offset:50176
v_lshlrev_b32 v196, 16, v158
v_and_b32 v197, s58, v158
v_mfma_f32_16x16x32_bf16 v[48:51], v[144:147], v[92:95], v[48:51]
v_add_f32 v180, v180, v194
v_add_f32 v181, v181, v195
v_mfma_f32_16x16x32_bf16 v[52:55], v[144:147], v[96:99], v[52:55]
s_add_u32 m0, s55, 36864
s_nop 0
buffer_load_dwordx4 v220, s[12:15], s50 offen offset:0 lds
s_add_u32 s50, s50, 114688
v_fmac_f32 v182, v194, v194
v_fmac_f32 v183, v195, v195
v_mfma_f32_16x16x32_bf16 v[56:59], v[144:147], v[100:103], v[56:59]
v_lshlrev_b32 v198, 16, v159
v_and_b32 v199, s58, v159
v_mfma_f32_16x16x32_bf16 v[60:63], v[144:147], v[104:107], v[60:63]
v_add_f32 v180, v180, v196
v_add_f32 v181, v181, v197
v_mfma_f32_16x16x32_bf16 v[84:87], v[144:147], v[152:155], v[84:87]
ds_read_b64_tr_b16 v[144:145], v208 offset:53248
ds_read_b64_tr_b16 v[146:147], v208 offset:54272
v_fmac_f32 v182, v196, v196
v_fmac_f32 v183, v197, v197
v_mfma_f32_16x16x32_bf16 v[64:67], v[148:151], v[92:95], v[64:67]
v_add_f32 v180, v180, v198
v_add_f32 v181, v181, v199
v_mfma_f32_16x16x32_bf16 v[68:71], v[148:151], v[96:99], v[68:71]
v_fmac_f32 v182, v198, v198
v_fmac_f32 v183, v199, v199
v_mfma_f32_16x16x32_bf16 v[72:75], v[148:151], v[100:103], v[72:75]
v_lshlrev_b32 v200, 16, v166
v_and_b32 v201, s58, v166
v_mfma_f32_16x16x32_bf16 v[76:79], v[148:151], v[104:107], v[76:79]
v_add_f32 v184, v184, v200
v_fmac_f32 v185, v200, v200
v_mfma_f32_16x16x32_bf16 v[88:91], v[148:151], v[152:155], v[88:91]
ds_read_b64_tr_b16 v[148:149], v208 offset:57344
ds_read_b64_tr_b16 v[150:151], v208 offset:58368
v_add_f32 v184, v184, v201
v_fmac_f32 v185, v201, v201
s_waitcnt lgkmcnt(8)
v_mfma_f32_16x16x32_bf16 v[0:3], v[132:135], v[108:111], v[0:3]
v_mfma_f32_16x16x32_bf16 v[4:7], v[132:135], v[112:115], v[4:7]
v_mfma_f32_16x16x32_bf16 v[8:11], v[132:135], v[116:119], v[8:11]
v_mfma_f32_16x16x32_bf16 v[12:15], v[132:135], v[120:123], v[12:15]
v_mfma_f32_16x16x32_bf16 v[80:83], v[132:135], v[152:155], v[80:83]
s_waitcnt vmcnt(10)
s_waitcnt lgkmcnt(0)
s_barrier
ds_read_b64_tr_b16 v[132:133], v211 offset:0
ds_read_b64_tr_b16 v[134:135], v211 offset:1024
v_mfma_f32_16x16x32_bf16 v[16:19], v[136:139], v[108:111], v[16:19]
ds_read_b128 v[156:159], v216 offset:0
ds_read_b32 v166, v218 offset:49152
ds_read_b128 v[92:95], v214 offset:0
ds_read_b128 v[96:99], v214 offset:2048
s_add_u32 m0, s55, 53248
s_nop 0
buffer_load_dwordx4 v220, s[8:11], s50 offen offset:0 lds
v_mfma_f32_16x16x32_bf16 v[20:23], v[136:139], v[112:115], v[20:23]
ds_read_b128 v[100:103], v214 offset:4096
ds_read_b128 v[104:107], v214 offset:6144
v_mfma_f32_16x16x32_bf16 v[24:27], v[136:139], v[116:119], v[24:27]
v_mfma_f32_16x16x32_bf16 v[28:31], v[136:139], v[120:123], v[28:31]
ds_read_b64_tr_b16 v[136:137], v211 offset:4096
ds_read_b64_tr_b16 v[138:139], v211 offset:5120
s_add_u32 m0, s55, 57344
s_nop 0
buffer_load_dwordx4 v220, s[12:15], s50 offen offset:0 lds
s_add_u32 s50, s50, 114688
v_mfma_f32_16x16x32_bf16 v[32:35], v[140:143], v[108:111], v[32:35]
s_waitcnt lgkmcnt(6)
v_lshlrev_b32 v192, 16, v156
v_and_b32 v193, s58, v156
v_lshlrev_b32 v194, 16, v157
v_mfma_f32_16x16x32_bf16 v[36:39], v[140:143], v[112:115], v[36:39]
v_and_b32 v195, s58, v157
v_add_f32 v180, v180, v192
v_add_f32 v181, v181, v193
v_mfma_f32_16x16x32_bf16 v[40:43], v[140:143], v[116:119], v[40:43]
s_add_u32 m0, s56, 135680
s_nop 0
buffer_load_dwordx4 v223, s[4:7], s52 offen offset:512 lds
v_fmac_f32 v182, v192, v192
v_fmac_f32 v183, v193, v193
v_mfma_f32_16x16x32_bf16 v[44:47], v[140:143], v[120:123], v[44:47]
ds_read_b64_tr_b16 v[140:141], v211 offset:8192
ds_read_b64_tr_b16 v[142:143], v211 offset:9216
v_lshlrev_b32 v196, 16, v158
v_and_b32 v197, s58, v158
v_mfma_f32_16x16x32_bf16 v[48:51], v[144:147], v[108:111], v[48:51]
v_add_f32 v180, v180, v194
v_add_f32 v181, v181, v195
v_mfma_f32_16x16x32_bf16 v[52:55], v[144:147], v[112:115], v[52:55]
s_add_u32 m0, s56, 142848
s_nop 0
buffer_load_dwordx4 v222, s[4:7], s53 offen offset:512 lds
v_fmac_f32 v182, v194, v194
v_fmac_f32 v183, v195, v195
v_mfma_f32_16x16x32_bf16 v[56:59], v[144:147], v[116:119], v[56:59]
v_lshlrev_b32 v198, 16, v159
v_and_b32 v199, s58, v159
v_mfma_f32_16x16x32_bf16 v[60:63], v[144:147], v[120:123], v[60:63]
v_add_f32 v180, v180, v196
v_add_f32 v181, v181, v197
v_mfma_f32_16x16x32_bf16 v[84:87], v[144:147], v[152:155], v[84:87]
ds_read_b64_tr_b16 v[144:145], v211 offset:12288
ds_read_b64_tr_b16 v[146:147], v211 offset:13312
v_fmac_f32 v182, v196, v196
v_fmac_f32 v183, v197, v197
v_mfma_f32_16x16x32_bf16 v[64:67], v[148:151], v[108:111], v[64:67]
v_add_f32 v180, v180, v198
v_add_f32 v181, v181, v199
v_mfma_f32_16x16x32_bf16 v[68:71], v[148:151], v[112:115], v[68:71]
v_fmac_f32 v182, v198, v198
v_fmac_f32 v183, v199, v199
v_mfma_f32_16x16x32_bf16 v[72:75], v[148:151], v[116:119], v[72:75]
v_lshlrev_b32 v200, 16, v166
v_and_b32 v201, s58, v166
v_mfma_f32_16x16x32_bf16 v[76:79], v[148:151], v[120:123], v[76:79]
v_add_f32 v184, v184, v200
v_fmac_f32 v185, v200, v200
v_mfma_f32_16x16x32_bf16 v[88:91], v[148:151], v[152:155], v[88:91]
ds_read_b64_tr_b16 v[148:149], v211 offset:16384
ds_read_b64_tr_b16 v[150:151], v211 offset:17408
v_add_f32 v184, v184, v201
v_fmac_f32 v185, v201, v201
s_mov_b64 exec, s[70:71]
buffer_load_dword v225, v247, s[72:75], s0 offen
s_mov_b64 exec, -1
s_add_u32 s0, s0, s1
s_waitcnt lgkmcnt(8)
v_mfma_f32_16x16x32_bf16 v[0:3], v[132:135], v[92:95], v[0:3]
v_mfma_f32_16x16x32_bf16 v[4:7], v[132:135], v[96:99], v[4:7]
v_mfma_f32_16x16x32_bf16 v[8:11], v[132:135], v[100:103], v[8:11]
v_mfma_f32_16x16x32_bf16 v[12:15], v[132:135], v[104:107], v[12:15]
v_mfma_f32_16x16x32_bf16 v[80:83], v[132:135], v[152:155], v[80:83]
s_waitcnt vmcnt(13)
s_waitcnt lgkmcnt(0)
s_barrier
ds_read_b64_tr_b16 v[132:133], v211 offset:20480
ds_read_b64_tr_b16 v[134:135], v211 offset:21504
v_mfma_f32_16x16x32_bf16 v[16:19], v[136:139], v[92:95], v[16:19]
ds_read_b128 v[156:159], v217 offset:0
ds_read_b32 v166, v219 offset:49152
ds_read_b128 v[108:111], v215 offset:0
ds_read_b128 v[112:115], v215 offset:2048
s_add_u32 m0, s56, 143872
s_nop 0
buffer_load_dwordx4 v223, s[4:7], s53 offen offset:512 lds
v_mfma_f32_16x16x32_bf16 v[20:23], v[136:139], v[96:99], v[20:23]
ds_read_b128 v[116:119], v215 offset:4096
ds_read_b128 v[120:123], v215 offset:6144
v_mfma_f32_16x16x32_bf16 v[24:27], v[136:139], v[100:103], v[24:27]
v_mfma_f32_16x16x32_bf16 v[28:31], v[136:139], v[104:107], v[28:31]
ds_read_b64_tr_b16 v[136:137], v211 offset:24576
ds_read_b64_tr_b16 v[138:139], v211 offset:25600
s_add_u32 m0, s55, 73728
s_nop 0
buffer_load_dwordx4 v220, s[8:11], s50 offen offset:0 lds
v_mfma_f32_16x16x32_bf16 v[32:35], v[140:143], v[92:95], v[32:35]
s_waitcnt lgkmcnt(6)
v_lshlrev_b32 v192, 16, v156
v_and_b32 v193, s58, v156
v_lshlrev_b32 v194, 16, v157
v_mfma_f32_16x16x32_bf16 v[36:39], v[140:143], v[96:99], v[36:39]
v_and_b32 v195, s58, v157
v_add_f32 v180, v180, v192
v_add_f32 v181, v181, v193
v_mfma_f32_16x16x32_bf16 v[40:43], v[140:143], v[100:103], v[40:43]
s_add_u32 m0, s55, 77824
s_nop 0
buffer_load_dwordx4 v220, s[12:15], s50 offen offset:0 lds
s_add_u32 s50, s50, 114688
v_fmac_f32 v182, v192, v192
v_fmac_f32 v183, v193, v193
v_mfma_f32_16x16x32_bf16 v[44:47], v[140:143], v[104:107], v[44:47]
ds_read_b64_tr_b16 v[140:141], v211 offset:28672
ds_read_b64_tr_b16 v[142:143], v211 offset:29696
v_lshlrev_b32 v196, 16, v158
v_and_b32 v197, s58, v158
v_mfma_f32_16x16x32_bf16 v[48:51], v[144:147], v[92:95], v[48:51]
v_add_f32 v180, v180, v194
v_add_f32 v181, v181, v195
v_mfma_f32_16x16x32_bf16 v[52:55], v[144:147], v[96:99], v[52:55]
v_fmac_f32 v182, v194, v194
v_fmac_f32 v183, v195, v195
v_mfma_f32_16x16x32_bf16 v[56:59], v[144:147], v[100:103], v[56:59]
v_lshlrev_b32 v198, 16, v159
v_and_b32 v199, s58, v159
v_mfma_f32_16x16x32_bf16 v[60:63], v[144:147], v[104:107], v[60:63]
v_add_f32 v180, v180, v196
v_add_f32 v181, v181, v197
v_mfma_f32_16x16x32_bf16 v[84:87], v[144:147], v[152:155], v[84:87]
ds_read_b64_tr_b16 v[144:145], v211 offset:32768
ds_read_b64_tr_b16 v[146:147], v211 offset:33792
v_fmac_f32 v182, v196, v196
v_fmac_f32 v183, v197, v197
v_mfma_f32_16x16x32_bf16 v[64:67], v[148:151], v[92:95], v[64:67]
v_add_f32 v180, v180, v198
v_add_f32 v181, v181, v199
v_mfma_f32_16x16x32_bf16 v[68:71], v[148:151], v[96:99], v[68:71]
v_fmac_f32 v182, v198, v198
v_fmac_f32 v183, v199, v199
v_mfma_f32_16x16x32_bf16 v[72:75], v[148:151], v[100:103], v[72:75]
v_lshlrev_b32 v200, 16, v166
v_and_b32 v201, s58, v166
v_mfma_f32_16x16x32_bf16 v[76:79], v[148:151], v[104:107], v[76:79]
v_add_f32 v184, v184, v200
v_fmac_f32 v185, v200, v200
v_mfma_f32_16x16x32_bf16 v[88:91], v[148:151], v[152:155], v[88:91]
ds_read_b64_tr_b16 v[148:149], v211 offset:36864
ds_read_b64_tr_b16 v[150:151], v211 offset:37888
v_add_f32 v184, v184, v201
v_fmac_f32 v185, v201, v201
s_waitcnt lgkmcnt(8)
v_mfma_f32_16x16x32_bf16 v[0:3], v[132:135], v[108:111], v[0:3]
v_mfma_f32_16x16x32_bf16 v[4:7], v[132:135], v[112:115], v[4:7]
v_mfma_f32_16x16x32_bf16 v[8:11], v[132:135], v[116:119], v[8:11]
v_mfma_f32_16x16x32_bf16 v[12:15], v[132:135], v[120:123], v[12:15]
v_mfma_f32_16x16x32_bf16 v[80:83], v[132:135], v[152:155], v[80:83]
s_waitcnt vmcnt(10)
s_waitcnt lgkmcnt(0)
s_barrier
ds_read_b64_tr_b16 v[132:133], v208 offset:0
ds_read_b64_tr_b16 v[134:135], v208 offset:1024
v_mfma_f32_16x16x32_bf16 v[16:19], v[136:139], v[108:111], v[16:19]
ds_read_b128 v[156:159], v216 offset:16384
ds_read_b32 v166, v218 offset:51200
ds_read_b128 v[92:95], v214 offset:16384
ds_read_b128 v[96:99], v214 offset:18432
s_add_u32 m0, s55, 94208
s_nop 0
buffer_load_dwordx4 v220, s[8:11], s50 offen offset:0 lds
v_mfma_f32_16x16x32_bf16 v[20:23], v[136:139], v[112:115], v[20:23]
ds_read_b128 v[100:103], v214 offset:20480
ds_read_b128 v[104:107], v214 offset:22528
v_mfma_f32_16x16x32_bf16 v[24:27], v[136:139], v[116:119], v[24:27]
v_mfma_f32_16x16x32_bf16 v[28:31], v[136:139], v[120:123], v[28:31]
ds_read_b64_tr_b16 v[136:137], v208 offset:4096
ds_read_b64_tr_b16 v[138:139], v208 offset:5120
s_add_u32 m0, s55, 98304
s_nop 0
buffer_load_dwordx4 v220, s[12:15], s50 offen offset:0 lds
s_add_u32 s50, s50, 114688
v_mfma_f32_16x16x32_bf16 v[32:35], v[140:143], v[108:111], v[32:35]
s_waitcnt lgkmcnt(6)
v_lshlrev_b32 v192, 16, v156
v_and_b32 v193, s58, v156
v_lshlrev_b32 v194, 16, v157
v_mfma_f32_16x16x32_bf16 v[36:39], v[140:143], v[112:115], v[36:39]
v_and_b32 v195, s58, v157
v_add_f32 v180, v180, v192
v_add_f32 v181, v181, v193
v_mfma_f32_16x16x32_bf16 v[40:43], v[140:143], v[116:119], v[40:43]
s_add_u32 m0, s56, 102784
s_nop 0
buffer_load_dwordx4 v223, s[4:7], s52 offen offset:640 lds
v_fmac_f32 v182, v192, v192
v_fmac_f32 v183, v193, v193
v_mfma_f32_16x16x32_bf16 v[44:47], v[140:143], v[120:123], v[44:47]
ds_read_b64_tr_b16 v[140:141], v208 offset:8192
ds_read_b64_tr_b16 v[142:143], v208 offset:9216
v_lshlrev_b32 v196, 16, v158
v_and_b32 v197, s58, v158
v_mfma_f32_16x16x32_bf16 v[48:51], v[144:147], v[108:111], v[48:51]
v_add_f32 v180, v180, v194
v_add_f32 v181, v181, v195
v_mfma_f32_16x16x32_bf16 v[52:55], v[144:147], v[112:115], v[52:55]
s_add_u32 m0, s56, 109952
s_nop 0
buffer_load_dwordx4 v222, s[4:7], s53 offen offset:640 lds
v_fmac_f32 v182, v194, v194
v_fmac_f32 v183, v195, v195
v_mfma_f32_16x16x32_bf16 v[56:59], v[144:147], v[116:119], v[56:59]
v_lshlrev_b32 v198, 16, v159
v_and_b32 v199, s58, v159
v_mfma_f32_16x16x32_bf16 v[60:63], v[144:147], v[120:123], v[60:63]
v_add_f32 v180, v180, v196
v_add_f32 v181, v181, v197
v_mfma_f32_16x16x32_bf16 v[84:87], v[144:147], v[152:155], v[84:87]
ds_read_b64_tr_b16 v[144:145], v208 offset:12288
ds_read_b64_tr_b16 v[146:147], v208 offset:13312
v_fmac_f32 v182, v196, v196
v_fmac_f32 v183, v197, v197
v_mfma_f32_16x16x32_bf16 v[64:67], v[148:151], v[108:111], v[64:67]
v_add_f32 v180, v180, v198
v_add_f32 v181, v181, v199
v_mfma_f32_16x16x32_bf16 v[68:71], v[148:151], v[112:115], v[68:71]
v_fmac_f32 v182, v198, v198
v_fmac_f32 v183, v199, v199
v_mfma_f32_16x16x32_bf16 v[72:75], v[148:151], v[116:119], v[72:75]
v_lshlrev_b32 v200, 16, v166
v_and_b32 v201, s58, v166
v_mfma_f32_16x16x32_bf16 v[76:79], v[148:151], v[120:123], v[76:79]
v_add_f32 v184, v184, v200
v_fmac_f32 v185, v200, v200
v_mfma_f32_16x16x32_bf16 v[88:91], v[148:151], v[152:155], v[88:91]
ds_read_b64_tr_b16 v[148:149], v208 offset:16384
ds_read_b64_tr_b16 v[150:151], v208 offset:17408
v_add_f32 v184, v184, v201
v_fmac_f32 v185, v201, v201
s_mov_b64 exec, s[70:71]
buffer_load_dword v225, v247, s[72:75], s0 offen
s_mov_b64 exec, -1
s_add_u32 s0, s0, s1
s_waitcnt lgkmcnt(8)
v_mfma_f32_16x16x32_bf16 v[0:3], v[132:135], v[92:95], v[0:3]
v_mfma_f32_16x16x32_bf16 v[4:7], v[132:135], v[96:99], v[4:7]
v_mfma_f32_16x16x32_bf16 v[8:11], v[132:135], v[100:103], v[8:11]
v_mfma_f32_16x16x32_bf16 v[12:15], v[132:135], v[104:107], v[12:15]
v_mfma_f32_16x16x32_bf16 v[80:83], v[132:135], v[152:155], v[80:83]
s_waitcnt vmcnt(13)
s_waitcnt lgkmcnt(0)
s_barrier
ds_read_b64_tr_b16 v[132:133], v208 offset:20480
ds_read_b64_tr_b16 v[134:135], v208 offset:21504
v_mfma_f32_16x16x32_bf16 v[16:19], v[136:139], v[92:95], v[16:19]
ds_read_b128 v[156:159], v217 offset:16384
ds_read_b32 v166, v219 offset:51200
ds_read_b128 v[108:111], v215 offset:16384
ds_read_b128 v[112:115], v215 offset:18432
s_add_u32 m0, s56, 110976
s_nop 0
buffer_load_dwordx4 v223, s[4:7], s53 offen offset:640 lds
v_mfma_f32_16x16x32_bf16 v[20:23], v[136:139], v[96:99], v[20:23]
ds_read_b128 v[116:119], v215 offset:20480
ds_read_b128 v[120:123], v215 offset:22528
v_mfma_f32_16x16x32_bf16 v[24:27], v[136:139], v[100:103], v[24:27]
v_mfma_f32_16x16x32_bf16 v[28:31], v[136:139], v[104:107], v[28:31]
ds_read_b64_tr_b16 v[136:137], v208 offset:24576
ds_read_b64_tr_b16 v[138:139], v208 offset:25600
s_add_u32 m0, s55, 12288
s_nop 0
buffer_load_dwordx4 v220, s[8:11], s50 offen offset:0 lds
v_mfma_f32_16x16x32_bf16 v[32:35], v[140:143], v[92:95], v[32:35]
s_waitcnt lgkmcnt(6)
v_lshlrev_b32 v192, 16, v156
v_and_b32 v193, s58, v156
v_lshlrev_b32 v194, 16, v157
v_mfma_f32_16x16x32_bf16 v[36:39], v[140:143], v[96:99], v[36:39]
v_and_b32 v195, s58, v157
v_add_f32 v180, v180, v192
v_add_f32 v181, v181, v193
v_mfma_f32_16x16x32_bf16 v[40:43], v[140:143], v[100:103], v[40:43]
s_add_u32 m0, s55, 16384
s_nop 0
buffer_load_dwordx4 v220, s[12:15], s50 offen offset:0 lds
s_add_u32 s50, s50, 114688
v_fmac_f32 v182, v192, v192
v_fmac_f32 v183, v193, v193
v_mfma_f32_16x16x32_bf16 v[44:47], v[140:143], v[104:107], v[44:47]
ds_read_b64_tr_b16 v[140:141], v208 offset:28672
ds_read_b64_tr_b16 v[142:143], v208 offset:29696
v_lshlrev_b32 v196, 16, v158
v_and_b32 v197, s58, v158
v_mfma_f32_16x16x32_bf16 v[48:51], v[144:147], v[92:95], v[48:51]
v_add_f32 v180, v180, v194
v_add_f32 v181, v181, v195
v_mfma_f32_16x16x32_bf16 v[52:55], v[144:147], v[96:99], v[52:55]
v_fmac_f32 v182, v194, v194
v_fmac_f32 v183, v195, v195
v_mfma_f32_16x16x32_bf16 v[56:59], v[144:147], v[100:103], v[56:59]
v_lshlrev_b32 v198, 16, v159
v_and_b32 v199, s58, v159
v_mfma_f32_16x16x32_bf16 v[60:63], v[144:147], v[104:107], v[60:63]
v_add_f32 v180, v180, v196
v_add_f32 v181, v181, v197
v_mfma_f32_16x16x32_bf16 v[84:87], v[144:147], v[152:155], v[84:87]
ds_read_b64_tr_b16 v[144:145], v208 offset:32768
ds_read_b64_tr_b16 v[146:147], v208 offset:33792
v_fmac_f32 v182, v196, v196
v_fmac_f32 v183, v197, v197
v_mfma_f32_16x16x32_bf16 v[64:67], v[148:151], v[92:95], v[64:67]
v_add_f32 v180, v180, v198
v_add_f32 v181, v181, v199
v_mfma_f32_16x16x32_bf16 v[68:71], v[148:151], v[96:99], v[68:71]
v_fmac_f32 v182, v198, v198
v_fmac_f32 v183, v199, v199
v_mfma_f32_16x16x32_bf16 v[72:75], v[148:151], v[100:103], v[72:75]
v_lshlrev_b32 v200, 16, v166
v_and_b32 v201, s58, v166
v_mfma_f32_16x16x32_bf16 v[76:79], v[148:151], v[104:107], v[76:79]
v_add_f32 v184, v184, v200
v_fmac_f32 v185, v200, v200
v_mfma_f32_16x16x32_bf16 v[88:91], v[148:151], v[152:155], v[88:91]
ds_read_b64_tr_b16 v[148:149], v208 offset:36864
ds_read_b64_tr_b16 v[150:151], v208 offset:37888
v_add_f32 v184, v184, v201
v_fmac_f32 v185, v201, v201
s_waitcnt lgkmcnt(8)
v_mfma_f32_16x16x32_bf16 v[0:3], v[132:135], v[108:111], v[0:3]
v_mfma_f32_16x16x32_bf16 v[4:7], v[132:135], v[112:115], v[4:7]
v_mfma_f32_16x16x32_bf16 v[8:11], v[132:135], v[116:119], v[8:11]
v_mfma_f32_16x16x32_bf16 v[12:15], v[132:135], v[120:123], v[12:15]
v_mfma_f32_16x16x32_bf16 v[80:83], v[132:135], v[152:155], v[80:83]
s_waitcnt vmcnt(10)
s_waitcnt lgkmcnt(0)
s_barrier
ds_read_b64_tr_b16 v[132:133], v208 offset:40960
ds_read_b64_tr_b16 v[134:135], v208 offset:41984
v_mfma_f32_16x16x32_bf16 v[16:19], v[136:139], v[108:111], v[16:19]
ds_read_b128 v[156:159], v216 offset:32768
ds_read_b32 v166, v218 offset:53248
ds_read_b128 v[92:95], v214 offset:32768
ds_read_b128 v[96:99], v214 offset:34816
s_add_u32 m0, s55, 32768
s_nop 0
buffer_load_dwordx4 v220, s[8:11], s50 offen offset:0 lds
v_mfma_f32_16x16x32_bf16 v[20:23], v[136:139], v[112:115], v[20:23]
ds_read_b128 v[100:103], v214 offset:36864
ds_read_b128 v[104:107], v214 offset:38912
v_mfma_f32_16x16x32_bf16 v[24:27], v[136:139], v[116:119], v[24:27]
v_mfma_f32_16x16x32_bf16 v[28:31], v[136:139], v[120:123], v[28:31]
ds_read_b64_tr_b16 v[136:137], v208 offset:45056
ds_read_b64_tr_b16 v[138:139], v208 offset:46080
s_add_u32 m0, s55, 36864
s_nop 0
buffer_load_dwordx4 v220, s[12:15], s50 offen offset:0 lds
s_add_u32 s50, s50, 114688
v_mfma_f32_16x16x32_bf16 v[32:35], v[140:143], v[108:111], v[32:35]
s_waitcnt lgkmcnt(6)
v_lshlrev_b32 v192, 16, v156
v_and_b32 v193, s58, v156
v_lshlrev_b32 v194, 16, v157
v_mfma_f32_16x16x32_bf16 v[36:39], v[140:143], v[112:115], v[36:39]
v_and_b32 v195, s58, v157
v_add_f32 v180, v180, v192
v_add_f32 v181, v181, v193
v_mfma_f32_16x16x32_bf16 v[40:43], v[140:143], v[116:119], v[40:43]
s_add_u32 m0, s56, 119040
s_nop 0
buffer_load_dwordx4 v223, s[4:7], s52 offen offset:768 lds
v_fmac_f32 v182, v192, v192
v_fmac_f32 v183, v193, v193
v_mfma_f32_16x16x32_bf16 v[44:47], v[140:143], v[120:123], v[44:47]
ds_read_b64_tr_b16 v[140:141], v208 offset:49152
ds_read_b64_tr_b16 v[142:143], v208 offset:50176
v_lshlrev_b32 v196, 16, v158
v_and_b32 v197, s58, v158
v_mfma_f32_16x16x32_bf16 v[48:51], v[144:147], v[108:111], v[48:51]
v_add_f32 v180, v180, v194
v_add_f32 v181, v181, v195
v_mfma_f32_16x16x32_bf16 v[52:55], v[144:147], v[112:115], v[52:55]
s_add_u32 m0, s56, 126208
s_nop 0
buffer_load_dwordx4 v222, s[4:7], s53 offen offset:768 lds
v_fmac_f32 v182, v194, v194
v_fmac_f32 v183, v195, v195
v_mfma_f32_16x16x32_bf16 v[56:59], v[144:147], v[116:119], v[56:59]
v_lshlrev_b32 v198, 16, v159
v_and_b32 v199, s58, v159
v_mfma_f32_16x16x32_bf16 v[60:63], v[144:147], v[120:123], v[60:63]
v_add_f32 v180, v180, v196
v_add_f32 v181, v181, v197
v_mfma_f32_16x16x32_bf16 v[84:87], v[144:147], v[152:155], v[84:87]
ds_read_b64_tr_b16 v[144:145], v208 offset:53248
ds_read_b64_tr_b16 v[146:147], v208 offset:54272
v_fmac_f32 v182, v196, v196
v_fmac_f32 v183, v197, v197
v_mfma_f32_16x16x32_bf16 v[64:67], v[148:151], v[108:111], v[64:67]
v_add_f32 v180, v180, v198
v_add_f32 v181, v181, v199
v_mfma_f32_16x16x32_bf16 v[68:71], v[148:151], v[112:115], v[68:71]
v_fmac_f32 v182, v198, v198
v_fmac_f32 v183, v199, v199
v_mfma_f32_16x16x32_bf16 v[72:75], v[148:151], v[116:119], v[72:75]
v_lshlrev_b32 v200, 16, v166
v_and_b32 v201, s58, v166
v_mfma_f32_16x16x32_bf16 v[76:79], v[148:151], v[120:123], v[76:79]
v_add_f32 v184, v184, v200
v_fmac_f32 v185, v200, v200
v_mfma_f32_16x16x32_bf16 v[88:91], v[148:151], v[152:155], v[88:91]
ds_read_b64_tr_b16 v[148:149], v208 offset:57344
ds_read_b64_tr_b16 v[150:151], v208 offset:58368
v_add_f32 v184, v184, v201
v_fmac_f32 v185, v201, v201
s_mov_b64 exec, s[70:71]
buffer_load_dword v225, v247, s[72:75], s0 offen
s_mov_b64 exec, -1
s_add_u32 s0, s0, s1
s_waitcnt lgkmcnt(8)
v_mfma_f32_16x16x32_bf16 v[0:3], v[132:135], v[92:95], v[0:3]
v_mfma_f32_16x16x32_bf16 v[4:7], v[132:135], v[96:99], v[4:7]
v_mfma_f32_16x16x32_bf16 v[8:11], v[132:135], v[100:103], v[8:11]
v_mfma_f32_16x16x32_bf16 v[12:15], v[132:135], v[104:107], v[12:15]
v_mfma_f32_16x16x32_bf16 v[80:83], v[132:135], v[152:155], v[80:83]
s_waitcnt vmcnt(13)
s_waitcnt lgkmcnt(0)
s_barrier
ds_read_b64_tr_b16 v[132:133], v211 offset:0
ds_read_b64_tr_b16 v[134:135], v211 offset:1024
v_mfma_f32_16x16x32_bf16 v[16:19], v[136:139], v[92:95], v[16:19]
ds_read_b128 v[156:159], v217 offset:32768
ds_read_b32 v166, v219 offset:53248
ds_read_b128 v[108:111], v215 offset:32768
ds_read_b128 v[112:115], v215 offset:34816
s_add_u32 m0, s56, 127232
s_nop 0
buffer_load_dwordx4 v223, s[4:7], s53 offen offset:768 lds
v_mfma_f32_16x16x32_bf16 v[20:23], v[136:139], v[96:99], v[20:23]
ds_read_b128 v[116:119], v215 offset:36864
ds_read_b128 v[120:123], v215 offset:38912
v_mfma_f32_16x16x32_bf16 v[24:27], v[136:139], v[100:103], v[24:27]
v_mfma_f32_16x16x32_bf16 v[28:31], v[136:139], v[104:107], v[28:31]
ds_read_b64_tr_b16 v[136:137], v211 offset:4096
ds_read_b64_tr_b16 v[138:139], v211 offset:5120
s_add_u32 m0, s55, 53248
s_nop 0
buffer_load_dwordx4 v220, s[8:11], s50 offen offset:0 lds
v_mfma_f32_16x16x32_bf16 v[32:35], v[140:143], v[92:95], v[32:35]
s_waitcnt lgkmcnt(6)
v_lshlrev_b32 v192, 16, v156
v_and_b32 v193, s58, v156
v_lshlrev_b32 v194, 16, v157
v_mfma_f32_16x16x32_bf16 v[36:39], v[140:143], v[96:99], v[36:39]
v_and_b32 v195, s58, v157
v_add_f32 v180, v180, v192
v_add_f32 v181, v181, v193
v_mfma_f32_16x16x32_bf16 v[40:43], v[140:143], v[100:103], v[40:43]
s_add_u32 m0, s55, 57344
s_nop 0
buffer_load_dwordx4 v220, s[12:15], s50 offen offset:0 lds
s_add_u32 s50, s50, 114688
v_fmac_f32 v182, v192, v192
v_fmac_f32 v183, v193, v193
v_mfma_f32_16x16x32_bf16 v[44:47], v[140:143], v[104:107], v[44:47]
ds_read_b64_tr_b16 v[140:141], v211 offset:8192
ds_read_b64_tr_b16 v[142:143], v211 offset:9216
v_lshlrev_b32 v196, 16, v158
v_and_b32 v197, s58, v158
v_mfma_f32_16x16x32_bf16 v[48:51], v[144:147], v[92:95], v[48:51]
v_add_f32 v180, v180, v194
v_add_f32 v181, v181, v195
v_mfma_f32_16x16x32_bf16 v[52:55], v[144:147], v[96:99], v[52:55]
v_fmac_f32 v182, v194, v194
v_fmac_f32 v183, v195, v195
v_mfma_f32_16x16x32_bf16 v[56:59], v[144:147], v[100:103], v[56:59]
v_lshlrev_b32 v198, 16, v159
v_and_b32 v199, s58, v159
v_mfma_f32_16x16x32_bf16 v[60:63], v[144:147], v[104:107], v[60:63]
v_add_f32 v180, v180, v196
v_add_f32 v181, v181, v197
v_mfma_f32_16x16x32_bf16 v[84:87], v[144:147], v[152:155], v[84:87]
ds_read_b64_tr_b16 v[144:145], v211 offset:12288
ds_read_b64_tr_b16 v[146:147], v211 offset:13312
v_fmac_f32 v182, v196, v196
v_fmac_f32 v183, v197, v197
v_mfma_f32_16x16x32_bf16 v[64:67], v[148:151], v[92:95], v[64:67]
v_add_f32 v180, v180, v198
v_add_f32 v181, v181, v199
v_mfma_f32_16x16x32_bf16 v[68:71], v[148:151], v[96:99], v[68:71]
v_fmac_f32 v182, v198, v198
v_fmac_f32 v183, v199, v199
v_mfma_f32_16x16x32_bf16 v[72:75], v[148:151], v[100:103], v[72:75]
v_lshlrev_b32 v200, 16, v166
v_and_b32 v201, s58, v166
v_mfma_f32_16x16x32_bf16 v[76:79], v[148:151], v[104:107], v[76:79]
v_add_f32 v184, v184, v200
v_fmac_f32 v185, v200, v200
v_mfma_f32_16x16x32_bf16 v[88:91], v[148:151], v[152:155], v[88:91]
ds_read_b64_tr_b16 v[148:149], v211 offset:16384
ds_read_b64_tr_b16 v[150:151], v211 offset:17408
v_add_f32 v184, v184, v201
v_fmac_f32 v185, v201, v201
s_waitcnt lgkmcnt(8)
v_mfma_f32_16x16x32_bf16 v[0:3], v[132:135], v[108:111], v[0:3]
v_mfma_f32_16x16x32_bf16 v[4:7], v[132:135], v[112:115], v[4:7]
v_mfma_f32_16x16x32_bf16 v[8:11], v[132:135], v[116:119], v[8:11]
v_mfma_f32_16x16x32_bf16 v[12:15], v[132:135], v[120:123], v[12:15]
v_mfma_f32_16x16x32_bf16 v[80:83], v[132:135], v[152:155], v[80:83]
s_waitcnt vmcnt(10)
s_waitcnt lgkmcnt(0)
s_barrier
ds_read_b64_tr_b16 v[132:133], v211 offset:20480
ds_read_b64_tr_b16 v[134:135], v211 offset:21504
v_mfma_f32_16x16x32_bf16 v[16:19], v[136:139], v[108:111], v[16:19]
ds_read_b128 v[156:159], v216 offset:0
ds_read_b32 v166, v218 offset:49152
ds_read_b128 v[92:95], v214 offset:0
ds_read_b128 v[96:99], v214 offset:2048
s_add_u32 m0, s55, 73728
s_nop 0
buffer_load_dwordx4 v220, s[8:11], s50 offen offset:0 lds
v_mfma_f32_16x16x32_bf16 v[20:23], v[136:139], v[112:115], v[20:23]
ds_read_b128 v[100:103], v214 offset:4096
ds_read_b128 v[104:107], v214 offset:6144
v_mfma_f32_16x16x32_bf16 v[24:27], v[136:139], v[116:119], v[24:27]
v_mfma_f32_16x16x32_bf16 v[28:31], v[136:139], v[120:123], v[28:31]
ds_read_b64_tr_b16 v[136:137], v211 offset:24576
ds_read_b64_tr_b16 v[138:139], v211 offset:25600
s_add_u32 m0, s55, 77824
s_nop 0
buffer_load_dwordx4 v220, s[12:15], s50 offen offset:0 lds
s_add_u32 s50, s50, 114688
v_mfma_f32_16x16x32_bf16 v[32:35], v[140:143], v[108:111], v[32:35]
s_waitcnt lgkmcnt(6)
v_lshlrev_b32 v192, 16, v156
v_and_b32 v193, s58, v156
v_lshlrev_b32 v194, 16, v157
v_mfma_f32_16x16x32_bf16 v[36:39], v[140:143], v[112:115], v[36:39]
v_and_b32 v195, s58, v157
v_add_f32 v180, v180, v192
v_add_f32 v181, v181, v193
v_mfma_f32_16x16x32_bf16 v[40:43], v[140:143], v[116:119], v[40:43]
s_add_u32 m0, s56, 135296
s_nop 0
buffer_load_dwordx4 v223, s[4:7], s52 offen offset:896 lds
v_fmac_f32 v182, v192, v192
v_fmac_f32 v183, v193, v193
v_mfma_f32_16x16x32_bf16 v[44:47], v[140:143], v[120:123], v[44:47]
ds_read_b64_tr_b16 v[140:141], v211 offset:28672
ds_read_b64_tr_b16 v[142:143], v211 offset:29696
v_lshlrev_b32 v196, 16, v158
v_and_b32 v197, s58, v158
v_mfma_f32_16x16x32_bf16 v[48:51], v[144:147], v[108:111], v[48:51]
v_add_f32 v180, v180, v194
v_add_f32 v181, v181, v195
v_mfma_f32_16x16x32_bf16 v[52:55], v[144:147], v[112:115], v[52:55]
s_add_u32 m0, s56, 142464
s_nop 0
buffer_load_dwordx4 v222, s[4:7], s53 offen offset:896 lds
v_fmac_f32 v182, v194, v194
v_fmac_f32 v183, v195, v195
v_mfma_f32_16x16x32_bf16 v[56:59], v[144:147], v[116:119], v[56:59]
v_lshlrev_b32 v198, 16, v159
v_and_b32 v199, s58, v159
v_mfma_f32_16x16x32_bf16 v[60:63], v[144:147], v[120:123], v[60:63]
v_add_f32 v180, v180, v196
v_add_f32 v181, v181, v197
v_mfma_f32_16x16x32_bf16 v[84:87], v[144:147], v[152:155], v[84:87]
ds_read_b64_tr_b16 v[144:145], v211 offset:32768
ds_read_b64_tr_b16 v[146:147], v211 offset:33792
v_fmac_f32 v182, v196, v196
v_fmac_f32 v183, v197, v197
v_mfma_f32_16x16x32_bf16 v[64:67], v[148:151], v[108:111], v[64:67]
v_add_f32 v180, v180, v198
v_add_f32 v181, v181, v199
v_mfma_f32_16x16x32_bf16 v[68:71], v[148:151], v[112:115], v[68:71]
v_fmac_f32 v182, v198, v198
v_fmac_f32 v183, v199, v199
v_mfma_f32_16x16x32_bf16 v[72:75], v[148:151], v[116:119], v[72:75]
v_lshlrev_b32 v200, 16, v166
v_and_b32 v201, s58, v166
v_mfma_f32_16x16x32_bf16 v[76:79], v[148:151], v[120:123], v[76:79]
v_add_f32 v184, v184, v200
v_fmac_f32 v185, v200, v200
v_mfma_f32_16x16x32_bf16 v[88:91], v[148:151], v[152:155], v[88:91]
ds_read_b64_tr_b16 v[148:149], v211 offset:36864
ds_read_b64_tr_b16 v[150:151], v211 offset:37888
v_add_f32 v184, v184, v201
v_fmac_f32 v185, v201, v201
s_mov_b32 exec_lo, 0xffff
s_mov_b32 exec_hi, 0x0
buffer_load_dword v225, v226, s[32:35], 0 offen
s_mov_b64 exec, -1
s_mov_b64 exec, 0xffff
buffer_load_dword v225, v227, s[28:31], 0 offen
s_mov_b64 exec, -1
s_waitcnt lgkmcnt(8)
v_mfma_f32_16x16x32_bf16 v[0:3], v[132:135], v[92:95], v[0:3]
v_mfma_f32_16x16x32_bf16 v[4:7], v[132:135], v[96:99], v[4:7]
v_mfma_f32_16x16x32_bf16 v[8:11], v[132:135], v[100:103], v[8:11]
v_mfma_f32_16x16x32_bf16 v[12:15], v[132:135], v[104:107], v[12:15]
v_mfma_f32_16x16x32_bf16 v[80:83], v[132:135], v[152:155], v[80:83]
s_waitcnt vmcnt(14)
s_waitcnt lgkmcnt(0)
s_barrier
ds_read_b64_tr_b16 v[132:133], v208 offset:0
ds_read_b64_tr_b16 v[134:135], v208 offset:1024
v_mfma_f32_16x16x32_bf16 v[16:19], v[136:139], v[92:95], v[16:19]
ds_read_b128 v[156:159], v217 offset:0
ds_read_b32 v166, v219 offset:49152
ds_read_b128 v[108:111], v215 offset:0
ds_read_b128 v[112:115], v215 offset:2048
s_add_u32 m0, s56, 143488
s_nop 0
buffer_load_dwordx4 v223, s[4:7], s53 offen offset:896 lds
v_mfma_f32_16x16x32_bf16 v[20:23], v[136:139], v[96:99], v[20:23]
ds_read_b128 v[116:119], v215 offset:4096
ds_read_b128 v[120:123], v215 offset:6144
v_mfma_f32_16x16x32_bf16 v[24:27], v[136:139], v[100:103], v[24:27]
v_mfma_f32_16x16x32_bf16 v[28:31], v[136:139], v[104:107], v[28:31]
ds_read_b64_tr_b16 v[136:137], v208 offset:4096
ds_read_b64_tr_b16 v[138:139], v208 offset:5120
s_add_u32 m0, s55, 94208
s_nop 0
buffer_load_dwordx4 v220, s[8:11], s50 offen offset:0 lds
v_mfma_f32_16x16x32_bf16 v[32:35], v[140:143], v[92:95], v[32:35]
s_waitcnt lgkmcnt(6)
v_lshlrev_b32 v192, 16, v156
v_and_b32 v193, s58, v156
v_lshlrev_b32 v194, 16, v157
v_mfma_f32_16x16x32_bf16 v[36:39], v[140:143], v[96:99], v[36:39]
v_and_b32 v195, s58, v157
v_add_f32 v180, v180, v192
v_add_f32 v181, v181, v193
v_mfma_f32_16x16x32_bf16 v[40:43], v[140:143], v[100:103], v[40:43]
s_add_u32 m0, s55, 98304
s_nop 0
buffer_load_dwordx4 v220, s[12:15], s50 offen offset:0 lds
s_add_u32 s50, s50, 114688
v_fmac_f32 v182, v192, v192
v_fmac_f32 v183, v193, v193
v_mfma_f32_16x16x32_bf16 v[44:47], v[140:143], v[104:107], v[44:47]
ds_read_b64_tr_b16 v[140:141], v208 offset:8192
ds_read_b64_tr_b16 v[142:143], v208 offset:9216
v_lshlrev_b32 v196, 16, v158
v_and_b32 v197, s58, v158
v_mfma_f32_16x16x32_bf16 v[48:51], v[144:147], v[92:95], v[48:51]
v_add_f32 v180, v180, v194
v_add_f32 v181, v181, v195
v_mfma_f32_16x16x32_bf16 v[52:55], v[144:147], v[96:99], v[52:55]
v_fmac_f32 v182, v194, v194
v_fmac_f32 v183, v195, v195
v_mfma_f32_16x16x32_bf16 v[56:59], v[144:147], v[100:103], v[56:59]
v_lshlrev_b32 v198, 16, v159
v_and_b32 v199, s58, v159
v_mfma_f32_16x16x32_bf16 v[60:63], v[144:147], v[104:107], v[60:63]
v_add_f32 v180, v180, v196
v_add_f32 v181, v181, v197
v_mfma_f32_16x16x32_bf16 v[84:87], v[144:147], v[152:155], v[84:87]
ds_read_b64_tr_b16 v[144:145], v208 offset:12288
ds_read_b64_tr_b16 v[146:147], v208 offset:13312
v_fmac_f32 v182, v196, v196
v_fmac_f32 v183, v197, v197
v_mfma_f32_16x16x32_bf16 v[64:67], v[148:151], v[92:95], v[64:67]
v_add_f32 v180, v180, v198
v_add_f32 v181, v181, v199
v_mfma_f32_16x16x32_bf16 v[68:71], v[148:151], v[96:99], v[68:71]
v_fmac_f32 v182, v198, v198
v_fmac_f32 v183, v199, v199
v_mfma_f32_16x16x32_bf16 v[72:75], v[148:151], v[100:103], v[72:75]
v_lshlrev_b32 v200, 16, v166
v_and_b32 v201, s58, v166
v_mfma_f32_16x16x32_bf16 v[76:79], v[148:151], v[104:107], v[76:79]
v_add_f32 v184, v184, v200
v_fmac_f32 v185, v200, v200
v_mfma_f32_16x16x32_bf16 v[88:91], v[148:151], v[152:155], v[88:91]
ds_read_b64_tr_b16 v[148:149], v208 offset:16384
ds_read_b64_tr_b16 v[150:151], v208 offset:17408
v_add_f32 v184, v184, v201
v_fmac_f32 v185, v201, v201
s_waitcnt lgkmcnt(8)
v_mfma_f32_16x16x32_bf16 v[0:3], v[132:135], v[108:111], v[0:3]
v_add_u32 v248, 102400, v169
v_mfma_f32_16x16x32_bf16 v[4:7], v[132:135], v[112:115], v[4:7]
v_add_u32 v249, 102400, v170
v_mfma_f32_16x16x32_bf16 v[8:11], v[132:135], v[116:119], v[8:11]
v_add_u32 v250, 102400, v171
v_mfma_f32_16x16x32_bf16 v[12:15], v[132:135], v[120:123], v[12:15]
v_add_u32 v251, 102400, v172
v_mfma_f32_16x16x32_bf16 v[80:83], v[132:135], v[152:155], v[80:83]
s_waitcnt vmcnt(11)
s_waitcnt lgkmcnt(0)
s_barrier
ds_read_b64_tr_b16 v[132:133], v208 offset:20480
ds_read_b64_tr_b16 v[134:135], v208 offset:21504
s_lshr_b32 s46, s40, 1
v_mfma_f32_16x16x32_bf16 v[16:19], v[136:139], v[108:111], v[16:19]
ds_read_b128 v[156:159], v216 offset:16384
ds_read_b32 v166, v218 offset:51200
ds_read_b128 v[92:95], v214 offset:16384
ds_read_b128 v[96:99], v214 offset:18432
s_lshl_b32 s67, s59, 16
v_mfma_f32_16x16x32_bf16 v[20:23], v[136:139], v[112:115], v[20:23]
ds_read_b128 v[100:103], v214 offset:20480
ds_read_b128 v[104:107], v214 offset:22528
s_lshl_b32 s45, s46, 14
v_mfma_f32_16x16x32_bf16 v[24:27], v[136:139], v[116:119], v[24:27]
s_add_u32 s67, s67, s45
v_mfma_f32_16x16x32_bf16 v[28:31], v[136:139], v[120:123], v[28:31]
ds_read_b64_tr_b16 v[136:137], v208 offset:24576
ds_read_b64_tr_b16 v[138:139], v208 offset:25600
s_lshl_b32 s45, s62, 7
v_mfma_f32_16x16x32_bf16 v[32:35], v[140:143], v[108:111], v[32:35]
s_waitcnt lgkmcnt(6)
v_lshlrev_b32 v192, 16, v156
v_and_b32 v193, s58, v156
v_lshlrev_b32 v194, 16, v157
s_add_u32 s67, s67, s45
v_mfma_f32_16x16x32_bf16 v[36:39], v[140:143], v[112:115], v[36:39]
v_and_b32 v195, s58, v157
v_add_f32 v180, v180, v192
v_add_f32 v181, v181, v193
s_and_b32 s45, s40, 1
v_mfma_f32_16x16x32_bf16 v[40:43], v[140:143], v[116:119], v[40:43]
v_fmac_f32 v182, v192, v192
v_fmac_f32 v183, v193, v193
s_lshl_b32 s45, s45, 6
v_mfma_f32_16x16x32_bf16 v[44:47], v[140:143], v[120:123], v[44:47]
ds_read_b64_tr_b16 v[140:141], v208 offset:28672
ds_read_b64_tr_b16 v[142:143], v208 offset:29696
v_lshlrev_b32 v196, 16, v158
v_and_b32 v197, s58, v158
s_add_u32 s67, s67, s45
v_mfma_f32_16x16x32_bf16 v[48:51], v[144:147], v[108:111], v[48:51]
v_add_f32 v180, v180, v194
v_add_f32 v181, v181, v195
s_lshl_b32 s45, s59, 11
v_mfma_f32_16x16x32_bf16 v[52:55], v[144:147], v[112:115], v[52:55]
v_fmac_f32 v182, v194, v194
v_fmac_f32 v183, v195, v195
s_lshl_b32 s82, s46, 6
v_mfma_f32_16x16x32_bf16 v[56:59], v[144:147], v[116:119], v[56:59]
v_lshlrev_b32 v198, 16, v159
v_and_b32 v199, s58, v159
s_add_u32 s82, s82, s45
v_mfma_f32_16x16x32_bf16 v[60:63], v[144:147], v[120:123], v[60:63]
v_add_f32 v180, v180, v196
v_add_f32 v181, v181, v197
s_lshl_b32 s45, s101, 8
v_mfma_f32_16x16x32_bf16 v[84:87], v[144:147], v[152:155], v[84:87]
ds_read_b64_tr_b16 v[144:145], v208 offset:32768
ds_read_b64_tr_b16 v[146:147], v208 offset:33792
v_fmac_f32 v182, v196, v196
v_fmac_f32 v183, v197, v197
s_add_u32 s82, s82, s45
v_mfma_f32_16x16x32_bf16 v[64:67], v[148:151], v[108:111], v[64:67]
v_add_f32 v180, v180, v198
v_add_f32 v181, v181, v199
s_add_u32 s82, s82, 9535488
v_mfma_f32_16x16x32_bf16 v[68:71], v[148:151], v[112:115], v[68:71]
v_fmac_f32 v182, v198, v198
v_fmac_f32 v183, v199, v199
s_lshl_b32 s79, s43, 1
v_mfma_f32_16x16x32_bf16 v[72:75], v[148:151], v[116:119], v[72:75]
v_lshlrev_b32 v200, 16, v166
v_and_b32 v201, s58, v166
s_add_u32 s79, s79, s42
v_mfma_f32_16x16x32_bf16 v[76:79], v[148:151], v[120:123], v[76:79]
v_add_f32 v184, v184, v200
v_fmac_f32 v185, v200, v200
s_mul_i32 s45, s79, 294912
v_mfma_f32_16x16x32_bf16 v[88:91], v[148:151], v[152:155], v[88:91]
ds_read_b64_tr_b16 v[148:149], v208 offset:36864
ds_read_b64_tr_b16 v[150:151], v208 offset:37888
v_add_f32 v184, v184, v201
v_fmac_f32 v185, v201, v201
s_lshl_b32 s47, s44, 11
s_mov_b32 exec_lo, 0xffff0000
s_mov_b32 exec_hi, 0xffffff
buffer_load_dword v225, v226, s[32:35], 0 offen
s_mov_b64 exec, -1
s_waitcnt lgkmcnt(8)
v_mfma_f32_16x16x32_bf16 v[0:3], v[132:135], v[92:95], v[0:3]
s_lshl_b32 s48, s41, 9
v_mfma_f32_16x16x32_bf16 v[4:7], v[132:135], v[96:99], v[4:7]
s_add_u32 s45, s45, s47
v_mfma_f32_16x16x32_bf16 v[8:11], v[132:135], v[100:103], v[8:11]
s_add_u32 s50, s45, s48
v_mfma_f32_16x16x32_bf16 v[12:15], v[132:135], v[104:107], v[12:15]
s_add_u32 s51, s50, 147456
v_mfma_f32_16x16x32_bf16 v[80:83], v[132:135], v[152:155], v[80:83]
s_waitcnt vmcnt(10)
s_waitcnt lgkmcnt(0)
s_barrier
ds_read_b64_tr_b16 v[132:133], v208 offset:40960
ds_read_b64_tr_b16 v[134:135], v208 offset:41984
s_add_u32 s52, s50, 16384
v_mfma_f32_16x16x32_bf16 v[16:19], v[136:139], v[92:95], v[16:19]
ds_read_b128 v[156:159], v217 offset:16384
ds_read_b32 v166, v219 offset:51200
ds_read_b128 v[108:111], v215 offset:16384
ds_read_b128 v[112:115], v215 offset:18432
s_add_u32 m0, s63, 0
s_add_u32 s49, s3, 0
buffer_load_dwordx4 v168, s[32:35], s49 offen lds
s_add_u32 s53, s50, 163840
v_mfma_f32_16x16x32_bf16 v[20:23], v[136:139], v[96:99], v[20:23]
ds_read_b128 v[116:119], v215 offset:20480
ds_read_b128 v[120:123], v215 offset:22528
s_lshl_b32 s55, s79, 10
v_mfma_f32_16x16x32_bf16 v[24:27], v[136:139], v[100:103], v[24:27]
s_lshl_b32 s48, s44, 7
v_mfma_f32_16x16x32_bf16 v[28:31], v[136:139], v[104:107], v[28:31]
ds_read_b64_tr_b16 v[136:137], v208 offset:45056
ds_read_b64_tr_b16 v[138:139], v208 offset:46080
s_add_u32 m0, s63, 1024
s_add_u32 s49, s3, 4096
buffer_load_dwordx4 v168, s[32:35], s49 offen lds
s_add_u32 s55, s55, s48
v_mfma_f32_16x16x32_bf16 v[32:35], v[140:143], v[92:95], v[32:35]
s_waitcnt lgkmcnt(6)
v_lshlrev_b32 v192, 16, v156
v_and_b32 v193, s58, v156
v_lshlrev_b32 v194, 16, v157
s_lshl_b32 s48, s41, 4
v_mfma_f32_16x16x32_bf16 v[36:39], v[140:143], v[96:99], v[36:39]
v_and_b32 v195, s58, v157
v_add_f32 v180, v180, v192
v_add_f32 v181, v181, v193
s_lshr_b32 s56, s55, 1
v_mfma_f32_16x16x32_bf16 v[40:43], v[140:143], v[100:103], v[40:43]
s_add_u32 m0, s63, 2048
s_add_u32 s49, s3, 16384
buffer_load_dwordx4 v168, s[32:35], s49 offen lds
v_fmac_f32 v182, v192, v192
v_fmac_f32 v183, v193, v193
s_add_u32 s56, s56, s48
v_mfma_f32_16x16x32_bf16 v[44:47], v[140:143], v[104:107], v[44:47]
ds_read_b64_tr_b16 v[140:141], v208 offset:49152
ds_read_b64_tr_b16 v[142:143], v208 offset:50176
v_lshlrev_b32 v196, 16, v158
v_and_b32 v197, s58, v158
s_add_u32 s56, s56, 9469952
v_mfma_f32_16x16x32_bf16 v[48:51], v[144:147], v[92:95], v[48:51]
v_add_f32 v180, v180, v194
v_add_f32 v181, v181, v195
s_add_u32 s55, s55, s48
v_mfma_f32_16x16x32_bf16 v[52:55], v[144:147], v[96:99], v[52:55]
s_add_u32 m0, s63, 3072
s_add_u32 s49, s3, 20480
buffer_load_dwordx4 v168, s[32:35], s49 offen lds
v_fmac_f32 v182, v194, v194
v_fmac_f32 v183, v195, v195
s_add_u32 s55, s55, 9437248
v_mfma_f32_16x16x32_bf16 v[56:59], v[144:147], v[100:103], v[56:59]
v_lshlrev_b32 v198, 16, v159
v_and_b32 v199, s58, v159
s_lshl_b32 s57, s59, 10
v_mfma_f32_16x16x32_bf16 v[60:63], v[144:147], v[104:107], v[60:63]
v_add_f32 v180, v180, v196
v_add_f32 v181, v181, v197
s_lshl_b32 s48, s101, 7
v_mfma_f32_16x16x32_bf16 v[84:87], v[144:147], v[152:155], v[84:87]
ds_read_b64_tr_b16 v[144:145], v208 offset:53248
ds_read_b64_tr_b16 v[146:147], v208 offset:54272
v_fmac_f32 v182, v196, v196
v_fmac_f32 v183, v197, v197
s_add_u32 s57, s57, s48
v_mfma_f32_16x16x32_bf16 v[64:67], v[148:151], v[92:95], v[64:67]
v_add_f32 v180, v180, v198
v_add_f32 v181, v181, v199
s_add_u32 s57, s57, 9437184
v_mfma_f32_16x16x32_bf16 v[68:71], v[148:151], v[96:99], v[68:71]
v_fmac_f32 v182, v198, v198
v_fmac_f32 v183, v199, v199
s_lshl_b32 s66, s59, 9
v_mfma_f32_16x16x32_bf16 v[72:75], v[148:151], v[100:103], v[72:75]
v_lshlrev_b32 v200, 16, v166
v_and_b32 v201, s58, v166
s_lshl_b32 s48, s41, 7
v_mfma_f32_16x16x32_bf16 v[76:79], v[148:151], v[104:107], v[76:79]
v_add_f32 v184, v184, v200
v_fmac_f32 v185, v200, v200
s_add_u32 s66, s66, s48
v_mfma_f32_16x16x32_bf16 v[88:91], v[148:151], v[152:155], v[88:91]
ds_read_b64_tr_b16 v[148:149], v208 offset:57344
ds_read_b64_tr_b16 v[150:151], v208 offset:58368
v_add_f32 v184, v184, v201
v_fmac_f32 v185, v201, v201
s_add_u32 s66, s66, 9469952
s_waitcnt lgkmcnt(8)
v_mfma_f32_16x16x32_bf16 v[0:3], v[132:135], v[108:111], v[0:3]
s_lshl_b32 s48, s101, 16
v_mfma_f32_16x16x32_bf16 v[4:7], v[132:135], v[112:115], v[4:7]
s_lshl_b32 s68, s62, 7
v_mfma_f32_16x16x32_bf16 v[8:11], v[132:135], v[116:119], v[8:11]
s_add_u32 s68, s68, s48
v_mfma_f32_16x16x32_bf16 v[12:15], v[132:135], v[120:123], v[12:15]
s_lshl_b32 s69, s41, 14
v_mfma_f32_16x16x32_bf16 v[80:83], v[132:135], v[152:155], v[80:83]
s_waitcnt vmcnt(7)
s_waitcnt lgkmcnt(0)
s_barrier
ds_read_b64_tr_b16 v[132:133], v211 offset:0
ds_read_b64_tr_b16 v[134:135], v211 offset:1024
s_add_u32 s69, s69, 32768
v_mfma_f32_16x16x32_bf16 v[16:19], v[136:139], v[108:111], v[16:19]
ds_read_b128 v[156:159], v216 offset:32768
ds_read_b32 v166, v218 offset:53248
ds_read_b128 v[92:95], v214 offset:32768
ds_read_b128 v[96:99], v214 offset:34816
s_add_u32 m0, s63, 102400
s_add_u32 s49, s3, 32768
buffer_load_dwordx4 v168, s[32:35], s49 offen lds
s_sub_u32 s69, s69, s63
v_mfma_f32_16x16x32_bf16 v[20:23], v[136:139], v[112:115], v[20:23]
ds_read_b128 v[100:103], v214 offset:36864
ds_read_b128 v[104:107], v214 offset:38912
s_mov_b32 s74, 200000
v_mfma_f32_16x16x32_bf16 v[24:27], v[136:139], v[116:119], v[24:27]
s_lshl_b32 s75, s59, 2
v_mfma_f32_16x16x32_bf16 v[28:31], v[136:139], v[120:123], v[28:31]
ds_read_b64_tr_b16 v[136:137], v211 offset:4096
ds_read_b64_tr_b16 v[138:139], v211 offset:5120
s_add_u32 m0, s63, 103424
s_add_u32 s49, s3, 36864
buffer_load_dwordx4 v168, s[32:35], s49 offen lds
s_mul_i32 s76, s101, 5120
v_mfma_f32_16x16x32_bf16 v[32:35], v[140:143], v[108:111], v[32:35]
s_waitcnt lgkmcnt(6)
v_lshlrev_b32 v192, 16, v156
v_and_b32 v193, s58, v156
v_lshlrev_b32 v194, 16, v157
s_add_u32 s76, s76, 32768
v_mfma_f32_16x16x32_bf16 v[36:39], v[140:143], v[112:115], v[36:39]
v_and_b32 v195, s58, v157
v_add_f32 v180, v180, v192
v_add_f32 v181, v181, v193
s_lshl_b32 s77, s101, 11
v_mfma_f32_16x16x32_bf16 v[40:43], v[140:143], v[116:119], v[40:43]
s_add_u32 m0, s63, 104448
s_add_u32 s49, s3, 49152
buffer_load_dwordx4 v168, s[32:35], s49 offen lds
v_fmac_f32 v182, v192, v192
v_fmac_f32 v183, v193, v193
s_add_u32 s77, s77, 16384
v_mfma_f32_16x16x32_bf16 v[44:47], v[140:143], v[120:123], v[44:47]
ds_read_b64_tr_b16 v[140:141], v211 offset:8192
ds_read_b64_tr_b16 v[142:143], v211 offset:9216
v_lshlrev_b32 v196, 16, v158
v_and_b32 v197, s58, v158
s_lshl_b32 s78, s41, 12
v_mfma_f32_16x16x32_bf16 v[48:51], v[144:147], v[108:111], v[48:51]
v_add_f32 v180, v180, v194
v_add_f32 v181, v181, v195
s_xor_b32 s48, s46, 0
v_mfma_f32_16x16x32_bf16 v[52:55], v[144:147], v[112:115], v[52:55]
s_add_u32 m0, s63, 105472
s_add_u32 s49, s3, 53248
buffer_load_dwordx4 v168, s[32:35], s49 offen lds
v_fmac_f32 v182, v194, v194
v_fmac_f32 v183, v195, v195
s_add_u32 s48, s48, s75
v_mfma_f32_16x16x32_bf16 v[56:59], v[144:147], v[116:119], v[56:59]
v_lshlrev_b32 v198, 16, v159
v_and_b32 v199, s58, v159
s_mul_i32 s48, s48, 73728
v_mfma_f32_16x16x32_bf16 v[60:63], v[144:147], v[120:123], v[60:63]
v_add_f32 v180, v180, v196
v_add_f32 v181, v181, v197
s_add_u32 s8, s48, s76
v_mfma_f32_16x16x32_bf16 v[84:87], v[144:147], v[152:155], v[84:87]
ds_read_b64_tr_b16 v[144:145], v211 offset:12288
ds_read_b64_tr_b16 v[146:147], v211 offset:13312
v_fmac_f32 v182, v196, v196
v_fmac_f32 v183, v197, v197
s_add_u32 s12, s8, 4096
v_mfma_f32_16x16x32_bf16 v[64:67], v[148:151], v[108:111], v[64:67]
v_add_f32 v180, v180, v198
v_add_f32 v181, v181, v199
s_add_u32 s16, s48, s77
v_mfma_f32_16x16x32_bf16 v[68:71], v[148:151], v[112:115], v[68:71]
v_fmac_f32 v182, v198, v198
v_fmac_f32 v183, v199, v199
s_add_u32 s70, s48, s78
v_mfma_f32_16x16x32_bf16 v[72:75], v[148:151], v[116:119], v[72:75]
v_lshlrev_b32 v200, 16, v166
v_and_b32 v201, s58, v166
s_xor_b32 s48, s46, 1
v_mfma_f32_16x16x32_bf16 v[76:79], v[148:151], v[120:123], v[76:79]
v_add_f32 v184, v184, v200
v_fmac_f32 v185, v200, v200
s_add_u32 s48, s48, s75
v_mfma_f32_16x16x32_bf16 v[88:91], v[148:151], v[152:155], v[88:91]
ds_read_b64_tr_b16 v[148:149], v211 offset:16384
ds_read_b64_tr_b16 v[150:151], v211 offset:17408
v_add_f32 v184, v184, v201
v_fmac_f32 v185, v201, v201
s_mul_i32 s48, s48, 73728
s_waitcnt lgkmcnt(8)
v_mfma_f32_16x16x32_bf16 v[0:3], v[132:135], v[92:95], v[0:3]
s_add_u32 s9, s48, s76
v_mfma_f32_16x16x32_bf16 v[4:7], v[132:135], v[96:99], v[4:7]
s_add_u32 s13, s9, 4096
v_mfma_f32_16x16x32_bf16 v[8:11], v[132:135], v[100:103], v[8:11]
s_add_u32 s17, s48, s77
v_mfma_f32_16x16x32_bf16 v[12:15], v[132:135], v[104:107], v[12:15]
s_add_u32 s71, s48, s78
v_mfma_f32_16x16x32_bf16 v[80:83], v[132:135], v[152:155], v[80:83]
s_waitcnt vmcnt(9)
s_waitcnt lgkmcnt(0)
s_barrier
ds_read_b64_tr_b16 v[132:133], v211 offset:20480
ds_read_b64_tr_b16 v[134:135], v211 offset:21504
s_xor_b32 s48, s46, 2
v_mfma_f32_16x16x32_bf16 v[16:19], v[136:139], v[92:95], v[16:19]
ds_read_b128 v[156:159], v217 offset:32768
ds_read_b32 v166, v219 offset:53248
ds_read_b128 v[108:111], v215 offset:32768
ds_read_b128 v[112:115], v215 offset:34816
s_add_u32 m0, s63, 32768
s_add_u32 s49, s100, 0
buffer_load_dwordx4 v168, s[28:31], s49 offen lds
s_add_u32 s48, s48, s75
v_mfma_f32_16x16x32_bf16 v[20:23], v[136:139], v[96:99], v[20:23]
ds_read_b128 v[116:119], v215 offset:36864
ds_read_b128 v[120:123], v215 offset:38912
s_mul_i32 s48, s48, 73728
v_mfma_f32_16x16x32_bf16 v[24:27], v[136:139], v[100:103], v[24:27]
s_add_u32 s10, s48, s76
v_mfma_f32_16x16x32_bf16 v[28:31], v[136:139], v[104:107], v[28:31]
ds_read_b64_tr_b16 v[136:137], v211 offset:24576
ds_read_b64_tr_b16 v[138:139], v211 offset:25600
s_add_u32 m0, s63, 33792
s_add_u32 s49, s100, 4096
buffer_load_dwordx4 v168, s[28:31], s49 offen lds
s_add_u32 s14, s10, 4096
v_mfma_f32_16x16x32_bf16 v[32:35], v[140:143], v[92:95], v[32:35]
s_waitcnt lgkmcnt(6)
v_lshlrev_b32 v192, 16, v156
v_and_b32 v193, s58, v156
v_lshlrev_b32 v194, 16, v157
s_add_u32 s18, s48, s77
v_mfma_f32_16x16x32_bf16 v[36:39], v[140:143], v[96:99], v[36:39]
v_and_b32 v195, s58, v157
v_add_f32 v180, v180, v192
v_add_f32 v181, v181, v193
s_add_u32 s72, s48, s78
v_mfma_f32_16x16x32_bf16 v[40:43], v[140:143], v[100:103], v[40:43]
s_add_u32 m0, s63, 34816
s_add_u32 s49, s100, 16384
buffer_load_dwordx4 v168, s[28:31], s49 offen lds
v_fmac_f32 v182, v192, v192
v_fmac_f32 v183, v193, v193
s_xor_b32 s48, s46, 3
v_mfma_f32_16x16x32_bf16 v[44:47], v[140:143], v[104:107], v[44:47]
ds_read_b64_tr_b16 v[140:141], v211 offset:28672
ds_read_b64_tr_b16 v[142:143], v211 offset:29696
v_lshlrev_b32 v196, 16, v158
v_and_b32 v197, s58, v158
s_add_u32 s48, s48, s75
v_mfma_f32_16x16x32_bf16 v[48:51], v[144:147], v[92:95], v[48:51]
v_add_f32 v180, v180, v194
v_add_f32 v181, v181, v195
s_mul_i32 s48, s48, 73728
v_mfma_f32_16x16x32_bf16 v[52:55], v[144:147], v[96:99], v[52:55]
s_add_u32 m0, s63, 35840
s_add_u32 s49, s100, 20480
buffer_load_dwordx4 v168, s[28:31], s49 offen lds
v_fmac_f32 v182, v194, v194
v_fmac_f32 v183, v195, v195
s_add_u32 s11, s48, s76
v_mfma_f32_16x16x32_bf16 v[56:59], v[144:147], v[100:103], v[56:59]
v_lshlrev_b32 v198, 16, v159
v_and_b32 v199, s58, v159
s_add_u32 s15, s11, 4096
v_mfma_f32_16x16x32_bf16 v[60:63], v[144:147], v[104:107], v[60:63]
v_add_f32 v180, v180, v196
v_add_f32 v181, v181, v197
s_add_u32 s19, s48, s77
v_mfma_f32_16x16x32_bf16 v[84:87], v[144:147], v[152:155], v[84:87]
ds_read_b64_tr_b16 v[144:145], v211 offset:32768
ds_read_b64_tr_b16 v[146:147], v211 offset:33792
v_fmac_f32 v182, v196, v196
v_fmac_f32 v183, v197, v197
s_add_u32 s73, s48, s78
v_mfma_f32_16x16x32_bf16 v[64:67], v[148:151], v[92:95], v[64:67]
v_add_f32 v180, v180, v198
v_add_f32 v181, v181, v199
v_mfma_f32_16x16x32_bf16 v[68:71], v[148:151], v[96:99], v[68:71]
v_fmac_f32 v182, v198, v198
v_fmac_f32 v183, v199, v199
v_mfma_f32_16x16x32_bf16 v[72:75], v[148:151], v[100:103], v[72:75]
v_lshlrev_b32 v200, 16, v166
v_and_b32 v201, s58, v166
v_mfma_f32_16x16x32_bf16 v[76:79], v[148:151], v[104:107], v[76:79]
v_add_f32 v184, v184, v200
v_fmac_f32 v185, v200, v200
v_mfma_f32_16x16x32_bf16 v[88:91], v[148:151], v[152:155], v[88:91]
ds_read_b64_tr_b16 v[148:149], v211 offset:36864
ds_read_b64_tr_b16 v[150:151], v211 offset:37888
v_add_f32 v184, v184, v201
v_fmac_f32 v185, v201, v201
s_waitcnt lgkmcnt(8)
v_mfma_f32_16x16x32_bf16 v[0:3], v[132:135], v[108:111], v[0:3]
v_add_f32 v180, v180, v181
v_add_f32 v181, v182, v183
v_mov_b32 v192, v180
v_mov_b32 v193, v181
v_mfma_f32_16x16x32_bf16 v[4:7], v[132:135], v[112:115], v[4:7]
v_mov_b32 v194, v184
v_mov_b32 v195, v185
v_permlane32_swap_b32 v180, v192
v_permlane32_swap_b32 v181, v193
v_mfma_f32_16x16x32_bf16 v[8:11], v[132:135], v[116:119], v[8:11]
v_permlane32_swap_b32 v184, v194
v_permlane32_swap_b32 v185, v195
v_add_f32 v180, v180, v192
v_add_f32 v181, v181, v193
v_mfma_f32_16x16x32_bf16 v[12:15], v[132:135], v[120:123], v[12:15]
v_add_f32 v184, v184, v194
v_add_f32 v185, v185, v195
v_mov_b32 v192, v180
v_mov_b32 v193, v181
v_mfma_f32_16x16x32_bf16 v[80:83], v[132:135], v[152:155], v[80:83]
v_mov_b32 v194, v184
v_mov_b32 v195, v185
v_permlane16_swap_b32 v180, v192
v_permlane16_swap_b32 v181, v193
s_waitcnt lgkmcnt(6)
v_mfma_f32_16x16x32_bf16 v[16:19], v[136:139], v[108:111], v[16:19]
v_permlane16_swap_b32 v184, v194
v_permlane16_swap_b32 v185, v195
v_add_f32 v180, v180, v192
v_add_f32 v181, v181, v193
v_mfma_f32_16x16x32_bf16 v[20:23], v[136:139], v[112:115], v[20:23]
v_add_f32 v184, v184, v194
v_add_f32 v185, v185, v195
v_mul_f32 v180, 0x3b000000, v180
v_mul_f32 v181, 0x3b000000, v181
v_mfma_f32_16x16x32_bf16 v[24:27], v[136:139], v[116:119], v[24:27]
v_fma_f32 v181, -v180, v180, v181
v_max_f32 v181, 0, v181
v_cvt_pk_bf16_f32 v192, v180, v181
v_mfma_f32_16x16x32_bf16 v[28:31], v[136:139], v[120:123], v[28:31]
v_lshlrev_b32 v180, 16, v192
v_and_b32 v181, 0xffff0000, v192
v_add_f32 v181, 0x3727c5ac, v181
s_waitcnt lgkmcnt(2)
v_mfma_f32_16x16x32_bf16 v[84:87], v[144:147], v[152:155], v[84:87]
v_cvt_pk_bf16_f32 v181, v181, v181
v_lshlrev_b32 v181, 16, v181
v_sqrt_f32 v181, v181
s_waitcnt lgkmcnt(0)
v_mfma_f32_16x16x32_bf16 v[88:91], v[148:151], v[152:155], v[88:91]
v_cvt_pk_bf16_f32 v181, v181, v181
v_lshlrev_b32 v181, 16, v181
v_rcp_f32 v192, v181
v_mfma_f32_16x16x32_bf16 v[48:51], v[144:147], v[108:111], v[48:51]
v_xor_b32 v182, 0x80000000, v180
v_fma_f32 v181, -v181, v192, 1.0
v_fma_f32 v183, v181, v192, v192
v_mfma_f32_16x16x32_bf16 v[52:55], v[144:147], v[112:115], v[52:55]
s_not_b64 exec, s[60:61]
ds_write_b128 v246, v[80:83] offset:0
ds_write_b128 v246, v[84:87] offset:192
ds_write_b128 v246, v[88:91] offset:256
s_mov_b64 exec, 0xffff
ds_write_b64 v245, v[184:185] offset:512
ds_write_b64 v245, v[182:183]
s_mov_b64 exec, -1
v_mfma_f32_16x16x32_bf16 v[56:59], v[144:147], v[116:119], v[56:59]
v_mfma_f32_16x16x32_bf16 v[60:63], v[144:147], v[120:123], v[60:63]
v_mfma_f32_16x16x32_bf16 v[64:67], v[148:151], v[108:111], v[64:67]
s_waitcnt lgkmcnt(0)
s_barrier
ds_read_b64 v[228:229], v244 offset:0
ds_read_b64 v[230:231], v244 offset:128
ds_read_b64 v[232:233], v244 offset:256
ds_read_b64 v[234:235], v244 offset:384
ds_read_b128 v[220:223], v246 offset:192
ds_read_b128 v[224:227], v246 offset:256
ds_read_b128 v[216:219], v246 offset:128
ds_read_b128 v[212:215], v246 offset:64
ds_read_b128 v[208:211], v246 offset:0
v_mfma_f32_16x16x32_bf16 v[68:71], v[148:151], v[112:115], v[68:71]
ds_read_b64 v[174:175], v174
v_mfma_f32_16x16x32_bf16 v[72:75], v[148:151], v[116:119], v[72:75]
s_add_u32 m0, s63, 65536
s_add_u32 s49, s100, 262144
buffer_load_dwordx4 v168, s[28:31], s49 offen lds
v_mfma_f32_16x16x32_bf16 v[76:79], v[148:151], v[120:123], v[76:79]
s_add_u32 m0, s63, 66560
s_add_u32 s49, s100, 266240
buffer_load_dwordx4 v168, s[28:31], s49 offen lds
v_mfma_f32_16x16x32_bf16 v[32:35], v[140:143], v[108:111], v[32:35]
s_add_u32 m0, s63, 67584
s_add_u32 s49, s100, 278528
buffer_load_dwordx4 v168, s[28:31], s49 offen lds
v_mfma_f32_16x16x32_bf16 v[36:39], v[140:143], v[112:115], v[36:39]
s_add_u32 m0, s63, 68608
s_add_u32 s49, s100, 282624
buffer_load_dwordx4 v168, s[28:31], s49 offen lds
v_mfma_f32_16x16x32_bf16 v[40:43], v[140:143], v[116:119], v[40:43]
v_mfma_f32_16x16x32_bf16 v[44:47], v[140:143], v[120:123], v[44:47]
L_epi1:
s_waitcnt vmcnt(8) lgkmcnt(0)
ds_read_b64_tr_b16 v[176:177], v169 offset:0
ds_read_b64_tr_b16 v[178:179], v169 offset:1024
ds_read_b64_tr_b16 v[180:181], v170 offset:0
ds_read_b64_tr_b16 v[182:183], v170 offset:1024
ds_read_b64_tr_b16 v[184:185], v171 offset:0
ds_read_b64_tr_b16 v[186:187], v171 offset:1024
ds_read_b64_tr_b16 v[188:189], v172 offset:0
ds_read_b64_tr_b16 v[190:191], v172 offset:1024
ds_read_b64_tr_b16 v[192:193], v248 offset:0
ds_read_b64_tr_b16 v[194:195], v248 offset:1024
ds_read_b64_tr_b16 v[196:197], v249 offset:0
ds_read_b64_tr_b16 v[198:199], v249 offset:1024
ds_read_b64_tr_b16 v[200:201], v250 offset:0
ds_read_b64_tr_b16 v[202:203], v250 offset:1024
ds_read_b64_tr_b16 v[204:205], v251 offset:0
ds_read_b64_tr_b16 v[206:207], v251 offset:1024
v_pk_fma_f32 v[64:65], v[224:225], v[228:229], v[64:65] op_sel_hi:[1,0,1]
v_pk_fma_f32 v[66:67], v[226:227], v[228:229], v[66:67] op_sel_hi:[1,0,1]
v_pk_fma_f32 v[48:49], v[220:221], v[228:229], v[48:49] op_sel_hi:[1,0,1]
v_pk_fma_f32 v[50:51], v[222:223], v[228:229], v[50:51] op_sel_hi:[1,0,1]
v_max_f32 v48, 0, v48
v_max_f32 v49, 0, v49
v_max_f32 v50, 0, v50
v_max_f32 v51, 0, v51
v_pk_mul_f32 v[48:49], v[48:49], v[64:65]
v_pk_mul_f32 v[50:51], v[50:51], v[66:67]
v_cvt_pk_bf16_f32 v64, v48, v49
v_cvt_pk_bf16_f32 v65, v50, v51
v_pk_fma_f32 v[68:69], v[224:225], v[230:231], v[68:69] op_sel_hi:[1,0,1]
v_pk_fma_f32 v[70:71], v[226:227], v[230:231], v[70:71] op_sel_hi:[1,0,1]
v_pk_fma_f32 v[52:53], v[220:221], v[230:231], v[52:53] op_sel_hi:[1,0,1]
v_pk_fma_f32 v[54:55], v[222:223], v[230:231], v[54:55] op_sel_hi:[1,0,1]
v_max_f32 v52, 0, v52
v_max_f32 v53, 0, v53
v_max_f32 v54, 0, v54
v_max_f32 v55, 0, v55
v_pk_mul_f32 v[52:53], v[52:53], v[68:69]
v_pk_mul_f32 v[54:55], v[54:55], v[70:71]
v_cvt_pk_bf16_f32 v66, v52, v53
v_cvt_pk_bf16_f32 v67, v54, v55
s_nop 0
v_permlane16_swap_b32 v64, v66
v_permlane16_swap_b32 v65, v67
buffer_store_dwordx4 v[64:67], v240, s[20:23], s52 offen sc0 sc1
v_pk_fma_f32 v[72:73], v[224:225], v[232:233], v[72:73] op_sel_hi:[1,0,1]
v_pk_fma_f32 v[74:75], v[226:227], v[232:233], v[74:75] op_sel_hi:[1,0,1]
v_pk_fma_f32 v[56:57], v[220:221], v[232:233], v[56:57] op_sel_hi:[1,0,1]
v_pk_fma_f32 v[58:59], v[222:223], v[232:233], v[58:59] op_sel_hi:[1,0,1]
v_max_f32 v56, 0, v56
v_max_f32 v57, 0, v57
v_max_f32 v58, 0, v58
v_max_f32 v59, 0, v59
v_pk_mul_f32 v[56:57], v[56:57], v[72:73]
v_pk_mul_f32 v[58:59], v[58:59], v[74:75]
v_cvt_pk_bf16_f32 v72, v56, v57
v_cvt_pk_bf16_f32 v73, v58, v59
v_pk_fma_f32 v[76:77], v[224:225], v[234:235], v[76:77] op_sel_hi:[1,0,1]
v_pk_fma_f32 v[78:79], v[226:227], v[234:235], v[78:79] op_sel_hi:[1,0,1]
v_pk_fma_f32 v[60:61], v[220:221], v[234:235], v[60:61] op_sel_hi:[1,0,1]
v_pk_fma_f32 v[62:63], v[222:223], v[234:235], v[62:63] op_sel_hi:[1,0,1]
v_max_f32 v60, 0, v60
v_max_f32 v61, 0, v61
v_max_f32 v62, 0, v62
v_max_f32 v63, 0, v63
v_pk_mul_f32 v[60:61], v[60:61], v[76:77]
v_pk_mul_f32 v[62:63], v[62:63], v[78:79]
v_cvt_pk_bf16_f32 v74, v60, v61
v_cvt_pk_bf16_f32 v75, v62, v63
s_nop 0
v_permlane16_swap_b32 v72, v74
v_permlane16_swap_b32 v73, v75
buffer_store_dwordx4 v[72:75], v240, s[20:23], s53 offen sc0 sc1
s_waitcnt lgkmcnt(0)
s_add_u32 m0, s63, 0
s_add_u32 s49, s3, 65536
buffer_load_dwordx4 v168, s[32:35], s49 offen lds
s_add_u32 m0, s63, 1024
s_add_u32 s49, s3, 69632
buffer_load_dwordx4 v168, s[32:35], s49 offen lds
s_add_u32 m0, s63, 2048
s_add_u32 s49, s3, 81920
buffer_load_dwordx4 v168, s[32:35], s49 offen lds
s_add_u32 m0, s63, 3072
s_add_u32 s49, s3, 86016
buffer_load_dwordx4 v168, s[32:35], s49 offen lds
s_add_u32 m0, s63, 102400
s_add_u32 s49, s3, 98304
buffer_load_dwordx4 v168, s[32:35], s49 offen lds
s_add_u32 m0, s63, 103424
s_add_u32 s49, s3, 102400
buffer_load_dwordx4 v168, s[32:35], s49 offen lds
s_add_u32 m0, s63, 104448
s_add_u32 s49, s3, 114688
buffer_load_dwordx4 v168, s[32:35], s49 offen lds
s_add_u32 m0, s63, 105472
s_add_u32 s49, s3, 118784
buffer_load_dwordx4 v168, s[32:35], s49 offen lds
v_pk_fma_f32 v[32:33], v[216:217], v[228:229], v[32:33] op_sel_hi:[1,0,1]
v_pk_fma_f32 v[34:35], v[218:219], v[228:229], v[34:35] op_sel_hi:[1,0,1]
v_pk_mul_f32 v[32:33], v[32:33], v[228:229] op_sel:[0,1] op_sel_hi:[1,1]
v_pk_mul_f32 v[34:35], v[34:35], v[228:229] op_sel:[0,1] op_sel_hi:[1,1]
v_cvt_pk_bf16_f32 v112, v32, v33
v_cvt_pk_bf16_f32 v113, v34, v35
ds_write_b64 v241, v[112:113] offset:512
v_pk_fma_f32 v[36:37], v[216:217], v[230:231], v[36:37] op_sel_hi:[1,0,1]
v_pk_fma_f32 v[38:39], v[218:219], v[230:231], v[38:39] op_sel_hi:[1,0,1]
v_pk_mul_f32 v[36:37], v[36:37], v[230:231] op_sel:[0,1] op_sel_hi:[1,1]
v_pk_mul_f32 v[38:39], v[38:39], v[230:231] op_sel:[0,1] op_sel_hi:[1,1]
v_cvt_pk_bf16_f32 v114, v36, v37
v_cvt_pk_bf16_f32 v115, v38, v39
ds_write_b64 v241, v[114:115] offset:1024
v_pk_fma_f32 v[40:41], v[216:217], v[232:233], v[40:41] op_sel_hi:[1,0,1]
v_pk_fma_f32 v[42:43], v[218:219], v[232:233], v[42:43] op_sel_hi:[1,0,1]
v_pk_mul_f32 v[40:41], v[40:41], v[232:233] op_sel:[0,1] op_sel_hi:[1,1]
v_pk_mul_f32 v[42:43], v[42:43], v[232:233] op_sel:[0,1] op_sel_hi:[1,1]
v_cvt_pk_bf16_f32 v116, v40, v41
v_cvt_pk_bf16_f32 v117, v42, v43
ds_write_b64 v241, v[116:117] offset:1536
v_pk_fma_f32 v[44:45], v[216:217], v[234:235], v[44:45] op_sel_hi:[1,0,1]
v_pk_fma_f32 v[46:47], v[218:219], v[234:235], v[46:47] op_sel_hi:[1,0,1]
v_pk_mul_f32 v[44:45], v[44:45], v[234:235] op_sel:[0,1] op_sel_hi:[1,1]
v_pk_mul_f32 v[46:47], v[46:47], v[234:235] op_sel:[0,1] op_sel_hi:[1,1]
v_cvt_pk_bf16_f32 v118, v44, v45
v_cvt_pk_bf16_f32 v119, v46, v47
ds_write_b64 v241, v[118:119] offset:2048
v_pk_fma_f32 v[28:29], v[212:213], v[234:235], v[28:29] op_sel_hi:[1,0,1]
v_pk_fma_f32 v[30:31], v[214:215], v[234:235], v[30:31] op_sel_hi:[1,0,1]
v_pk_mul_f32 v[28:29], v[28:29], v[234:235] op_sel:[0,1] op_sel_hi:[1,1]
v_pk_mul_f32 v[30:31], v[30:31], v[234:235] op_sel:[0,1] op_sel_hi:[1,1]
v_cvt_pk_bf16_f32 v108, v28, v29
v_cvt_pk_bf16_f32 v109, v30, v31
v_pk_fma_f32 v[16:17], v[212:213], v[228:229], v[16:17] op_sel_hi:[1,0,1]
v_pk_fma_f32 v[18:19], v[214:215], v[228:229], v[18:19] op_sel_hi:[1,0,1]
v_pk_mul_f32 v[16:17], v[16:17], v[228:229] op_sel:[0,1] op_sel_hi:[1,1]
v_pk_mul_f32 v[18:19], v[18:19], v[228:229] op_sel:[0,1] op_sel_hi:[1,1]
v_cvt_pk_bf16_f32 v102, v16, v17
v_cvt_pk_bf16_f32 v103, v18, v19
v_pk_fma_f32 v[20:21], v[212:213], v[230:231], v[20:21] op_sel_hi:[1,0,1]
v_pk_fma_f32 v[22:23], v[214:215], v[230:231], v[22:23] op_sel_hi:[1,0,1]
v_pk_mul_f32 v[20:21], v[20:21], v[230:231] op_sel:[0,1] op_sel_hi:[1,1]
v_pk_mul_f32 v[22:23], v[22:23], v[230:231] op_sel:[0,1] op_sel_hi:[1,1]
v_cvt_pk_bf16_f32 v104, v20, v21
v_cvt_pk_bf16_f32 v105, v22, v23
v_pk_fma_f32 v[24:25], v[212:213], v[232:233], v[24:25] op_sel_hi:[1,0,1]
v_pk_fma_f32 v[26:27], v[214:215], v[232:233], v[26:27] op_sel_hi:[1,0,1]
v_pk_mul_f32 v[24:25], v[24:25], v[232:233] op_sel:[0,1] op_sel_hi:[1,1]
v_pk_mul_f32 v[26:27], v[26:27], v[232:233] op_sel:[0,1] op_sel_hi:[1,1]
v_cvt_pk_bf16_f32 v106, v24, v25
v_cvt_pk_bf16_f32 v107, v26, v27
s_cmp_lg_u32 s42, 0
s_cbranch_scc1 L_e1b
ds_write_b64 v243, v[108:109]
v_pk_add_f32 v[92:93], v[92:93], v[94:95]
v_pk_add_f32 v[96:97], v[96:97], v[98:99]
v_pk_add_f32 v[92:93], v[92:93], v[96:97]
v_mul_f32 v92, 0x3b000000, v92
v_mul_f32 v93, 0x3b000000, v93
v_fma_f32 v93, -v92, v92, v93
v_max_f32 v93, 0, v93
v_cvt_pk_bf16_f32 v94, v92, v93
v_lshlrev_b32 v92, 16, v94
v_and_b32 v93, 0xffff0000, v94
v_add_f32 v93, 0x3727c5ac, v93
v_cvt_pk_bf16_f32 v93, v93, v93
v_lshlrev_b32 v93, 16, v93
v_sqrt_f32 v93, v93
s_nop 0
v_cvt_pk_bf16_f32 v93, v93, v93
v_lshlrev_b32 v93, 16, v93
v_rcp_f32 v94, v93
v_xor_b32 v152, 0x80000000, v92
v_fma_f32 v93, -v93, v94, 1.0
v_fma_f32 v153, v93, v94, v94
v_pk_fma_f32 v[84:85], v[216:217], v[152:153], v[84:85] op_sel_hi:[1,0,1]
v_pk_fma_f32 v[86:87], v[218:219], v[152:153], v[86:87] op_sel_hi:[1,0,1]
v_pk_mul_f32 v[84:85], v[84:85], v[152:153] op_sel:[0,1] op_sel_hi:[1,1]
v_pk_mul_f32 v[86:87], v[86:87], v[152:153] op_sel:[0,1] op_sel_hi:[1,1]
v_cvt_pk_bf16_f32 v110, v84, v85
v_cvt_pk_bf16_f32 v111, v86, v87
ds_write_b64 v241, v[110:111]
v_pk_fma_f32 v[80:81], v[212:213], v[152:153], v[80:81] op_sel_hi:[1,0,1]
v_pk_fma_f32 v[82:83], v[214:215], v[152:153], v[82:83] op_sel_hi:[1,0,1]
v_pk_mul_f32 v[80:81], v[80:81], v[152:153] op_sel:[0,1] op_sel_hi:[1,1]
v_pk_mul_f32 v[82:83], v[82:83], v[152:153] op_sel:[0,1] op_sel_hi:[1,1]
v_cvt_pk_bf16_f32 v100, v80, v81
v_cvt_pk_bf16_f32 v101, v82, v83
L_e1b:
v_readfirstlane_b32 s64, v174
v_readfirstlane_b32 s65, v175
v_mov_b32 v166, v174
v_mov_b32 v167, v175
s_waitcnt vmcnt(10)
s_waitcnt lgkmcnt(0)
s_barrier
s_cmp_eq_u32 s42, 0
s_cbranch_scc1 L_e1c
ds_read_b64 v[100:101], v243
L_e1c:
ds_read_b64_tr_b16 v[24:25], v242 offset:0
ds_read_b64_tr_b16 v[26:27], v242 offset:512
ds_read_b64_tr_b16 v[28:29], v242 offset:1024
ds_read_b64_tr_b16 v[30:31], v242 offset:1536
ds_read_b64_tr_b16 v[32:33], v242 offset:2048
v_pk_fma_f32 v[0:1], v[208:209], v[228:229], v[0:1] op_sel_hi:[1,0,1]
v_pk_fma_f32 v[2:3], v[210:211], v[228:229], v[2:3] op_sel_hi:[1,0,1]
v_cvt_pk_bf16_f32 v92, v0, v1
v_cvt_pk_bf16_f32 v93, v2, v3
v_pk_fma_f32 v[4:5], v[208:209], v[230:231], v[4:5] op_sel_hi:[1,0,1]
v_pk_fma_f32 v[6:7], v[210:211], v[230:231], v[6:7] op_sel_hi:[1,0,1]
v_cvt_pk_bf16_f32 v94, v4, v5
v_cvt_pk_bf16_f32 v95, v6, v7
v_pk_fma_f32 v[8:9], v[208:209], v[232:233], v[8:9] op_sel_hi:[1,0,1]
v_pk_fma_f32 v[10:11], v[210:211], v[232:233], v[10:11] op_sel_hi:[1,0,1]
v_cvt_pk_bf16_f32 v96, v8, v9
v_cvt_pk_bf16_f32 v97, v10, v11
v_pk_fma_f32 v[12:13], v[208:209], v[234:235], v[12:13] op_sel_hi:[1,0,1]
v_pk_fma_f32 v[14:15], v[210:211], v[234:235], v[14:15] op_sel_hi:[1,0,1]
v_cvt_pk_bf16_f32 v98, v12, v13
v_cvt_pk_bf16_f32 v99, v14, v15
s_waitcnt lgkmcnt(5)
v_mfma_f32_16x16x16_bf16 v[48:51], v[100:101], v[92:93], 0
v_mfma_f32_16x16x16_bf16 v[52:55], v[102:103], v[92:93], 0
v_mfma_f32_16x16x16_bf16 v[56:59], v[102:103], v[94:95], 0
v_mfma_f32_16x16x16_bf16 v[60:63], v[104:105], v[94:95], 0
v_mfma_f32_16x16x16_bf16 v[64:67], v[104:105], v[96:97], 0
v_mfma_f32_16x16x16_bf16 v[68:71], v[106:107], v[96:97], 0
v_mfma_f32_16x16x16_bf16 v[72:75], v[106:107], v[98:99], 0
v_mfma_f32_16x16x16_bf16 v[76:79], v[108:109], v[98:99], 0
s_waitcnt vmcnt(8)
s_mov_b64 exec, 1
buffer_store_dwordx2 v[174:175], v164, s[20:23], s55 offen sc0 sc1
s_mov_b64 exec, -1
buffer_load_dwordx4 v[160:163], v165, s[4:7], s67 offen
v_mul_f32 v40, 0x3eb8aa3b, v229
v_mul_f32 v41, 0x3eb8aa3b, v231
v_mul_f32 v42, 0x3eb8aa3b, v233
v_mul_f32 v43, 0x3eb8aa3b, v235
s_or_b32 s45, s43, s42
s_cmp_eq_u32 s45, 0
s_cselect_b32 s45, 0xf149f2ca, 0
v_mov_b32 v44, s58
v_mov_b32 v45, 0xffff
s_mov_b32 vcc_lo, 0xaaaaaaaa
s_mov_b32 vcc_hi, 0xaaaaaaaa
v_cndmask_b32 v44, v45, v44, vcc
v_mov_b32 v45, s45
v_cndmask_b32 v48, v48, v49, vcc
v_cndmask_b32 v50, v50, v51, vcc
v_cndmask_b32 v52, v52, v53, vcc
v_cndmask_b32 v54, v54, v55, vcc
v_cndmask_b32 v56, v56, v57, vcc
v_cndmask_b32 v58, v58, v59, vcc
v_cndmask_b32 v60, v60, v61, vcc
v_cndmask_b32 v62, v62, v63, vcc
v_cndmask_b32 v64, v64, v65, vcc
v_cndmask_b32 v66, v66, v67, vcc
v_cndmask_b32 v68, v68, v69, vcc
v_cndmask_b32 v70, v70, v71, vcc
v_cndmask_b32 v72, v72, v73, vcc
v_cndmask_b32 v74, v74, v75, vcc
v_cndmask_b32 v76, v76, v77, vcc
v_cndmask_b32 v78, v78, v79, vcc
s_mov_b32 vcc_lo, 0xf0000
s_mov_b32 vcc_hi, 0xfff00ff
v_cndmask_b32 v34, 0, v44, vcc
v_cndmask_b32 v38, 0, v45, vcc
v_cndmask_b32 v48, v52, v48, vcc
v_cndmask_b32 v56, v60, v56, vcc
v_cndmask_b32 v64, v68, v64, vcc
v_cndmask_b32 v72, v76, v72, vcc
v_xor_b32 v36, v34, v44
s_mov_b32 vcc_lo, 0x3f0003
s_mov_b32 vcc_hi, 0x3fff03ff
v_cndmask_b32 v35, 0, v44, vcc
v_cndmask_b32 v39, 0, v45, vcc
v_cndmask_b32 v50, v54, v50, vcc
v_cndmask_b32 v58, v62, v58, vcc
v_cndmask_b32 v66, v70, v66, vcc
v_cndmask_b32 v74, v78, v74, vcc
v_xor_b32 v37, v35, v44
v_fma_f32 v48, v48, v40, v38
v_fma_f32 v50, v50, v40, v39
v_mul_f32 v56, v41, v56
v_mul_f32 v58, v41, v58
v_mul_f32 v64, v42, v64
v_mul_f32 v66, v42, v66
v_mul_f32 v72, v43, v72
v_mul_f32 v74, v43, v74
s_waitcnt vmcnt(2)
ds_read_b64_tr_b16 v[208:209], v169 offset:0
ds_read_b64_tr_b16 v[210:211], v169 offset:1024
ds_read_b64_tr_b16 v[212:213], v170 offset:0
ds_read_b64_tr_b16 v[214:215], v170 offset:1024
ds_read_b64_tr_b16 v[216:217], v171 offset:0
ds_read_b64_tr_b16 v[218:219], v171 offset:1024
ds_read_b64_tr_b16 v[220:221], v172 offset:0
ds_read_b64_tr_b16 v[222:223], v172 offset:1024
ds_read_b64_tr_b16 v[224:225], v248 offset:0
ds_read_b64_tr_b16 v[226:227], v248 offset:1024
ds_read_b64_tr_b16 v[228:229], v249 offset:0
ds_read_b64_tr_b16 v[230:231], v249 offset:1024
ds_read_b64_tr_b16 v[232:233], v250 offset:0
ds_read_b64_tr_b16 v[234:235], v250 offset:1024
ds_read_b64_tr_b16 v[236:237], v251 offset:0
ds_read_b64_tr_b16 v[238:239], v251 offset:1024
v_max_f32 v49, v48, v50
v_max_f32 v57, v56, v58
v_max_f32 v65, v64, v66
v_max_f32 v73, v72, v74
v_permlane32_swap_b32 v49, v57
s_nop 0
v_permlane32_swap_b32 v65, v73
v_max_f32 v49, v49, v57
v_max_f32 v65, v65, v73
s_nop 1
v_permlane16_swap_b32 v49, v65
v_max_f32 v49, v49, v65
v_mov_b32 v65, v49
s_nop 1
v_permlane16_swap_b32 v49, v65
v_mov_b32 v57, v49
v_mov_b32 v73, v65
s_nop 0
v_permlane32_swap_b32 v49, v57
v_permlane32_swap_b32 v65, v73
v_sub_f32 v48, v48, v49
v_sub_f32 v50, v50, v49
v_sub_f32 v56, v56, v57
v_sub_f32 v58, v58, v57
v_sub_f32 v64, v64, v65
v_sub_f32 v66, v66, v65
v_sub_f32 v72, v72, v73
v_sub_f32 v74, v74, v73
v_exp_f32 v48, v48
v_exp_f32 v50, v50
v_exp_f32 v56, v56
v_exp_f32 v58, v58
v_exp_f32 v64, v64
v_exp_f32 v66, v66
v_exp_f32 v72, v72
v_exp_f32 v74, v74
s_waitcnt lgkmcnt(0)
s_add_u32 m0, s63, 0
s_add_u32 s49, s3, 131072
buffer_load_dwordx4 v168, s[32:35], s49 offen lds
s_add_u32 m0, s63, 1024
s_add_u32 s49, s3, 135168
buffer_load_dwordx4 v168, s[32:35], s49 offen lds
s_add_u32 m0, s63, 2048
s_add_u32 s49, s3, 147456
buffer_load_dwordx4 v168, s[32:35], s49 offen lds
s_add_u32 m0, s63, 3072
s_add_u32 s49, s3, 151552
buffer_load_dwordx4 v168, s[32:35], s49 offen lds
v_add_f32 v49, v48, v50
v_add_f32 v57, v56, v58
v_add_f32 v65, v64, v66
v_add_f32 v73, v72, v74
v_permlane32_swap_b32 v49, v57
s_nop 0
v_permlane32_swap_b32 v65, v73
v_add_f32 v49, v49, v57
v_add_f32 v65, v65, v73
s_add_u32 m0, s63, 102400
s_add_u32 s49, s68, 0
buffer_load_dwordx4 v168, s[32:35], s49 offen lds
s_add_u32 m0, s63, 103424
s_add_u32 s49, s68, 4096
buffer_load_dwordx4 v168, s[32:35], s49 offen lds
s_add_u32 m0, s63, 104448
s_add_u32 s49, s68, 16384
buffer_load_dwordx4 v168, s[32:35], s49 offen lds
s_add_u32 m0, s63, 105472
s_add_u32 s49, s68, 20480
buffer_load_dwordx4 v168, s[32:35], s49 offen lds
v_permlane16_swap_b32 v49, v65
v_add_f32 v49, v49, v65
v_rcp_f32 v49, v49
s_nop 0
v_mov_b32 v65, v49
s_nop 1
v_permlane16_swap_b32 v49, v65
v_mov_b32 v57, v49
v_mov_b32 v73, v65
s_nop 0
v_permlane32_swap_b32 v49, v57
v_permlane32_swap_b32 v65, v73
v_mul_f32 v48, v48, v49
v_mul_f32 v50, v50, v49
v_mul_f32 v56, v56, v57
v_mul_f32 v58, v58, v57
v_mul_f32 v64, v64, v65
v_mul_f32 v66, v66, v65
v_mul_f32 v72, v72, v73
v_mul_f32 v74, v74, v73
v_cvt_pk_bf16_f32 v48, v48, v48
v_cvt_pk_bf16_f32 v50, v50, v50
v_and_b32 v52, v34, v48
v_and_b32 v53, v35, v50
v_and_b32 v54, v36, v48
v_and_b32 v55, v37, v50
v_cvt_pk_bf16_f32 v56, v56, v56
v_cvt_pk_bf16_f32 v58, v58, v58
v_and_b32 v60, v34, v56
v_and_b32 v61, v35, v58
v_and_b32 v62, v36, v56
v_and_b32 v63, v37, v58
v_cvt_pk_bf16_f32 v64, v64, v64
v_cvt_pk_bf16_f32 v66, v66, v66
v_and_b32 v68, v34, v64
v_and_b32 v69, v35, v66
v_and_b32 v70, v36, v64
v_and_b32 v71, v37, v66
v_cvt_pk_bf16_f32 v72, v72, v72
v_cvt_pk_bf16_f32 v74, v74, v74
v_and_b32 v76, v34, v72
v_and_b32 v77, v35, v74
v_and_b32 v78, v36, v72
v_and_b32 v79, v37, v74
v_mfma_f32_16x16x32_bf16 v[0:3], v[24:27], v[52:55], 0
v_mfma_f32_16x16x32_bf16 v[4:7], v[26:29], v[60:63], 0
v_mfma_f32_16x16x32_bf16 v[8:11], v[28:31], v[68:71], 0
v_mfma_f32_16x16x32_bf16 v[12:15], v[30:33], v[76:79], 0
s_nop 4
v_cvt_pk_bf16_f32 v16, v0, v1
v_cvt_pk_bf16_f32 v17, v2, v3
v_cvt_pk_bf16_f32 v18, v4, v5
v_cvt_pk_bf16_f32 v19, v6, v7
s_nop 0
v_permlane16_swap_b32 v16, v18
v_permlane16_swap_b32 v17, v19
buffer_store_dwordx4 v[16:19], v240, s[20:23], s50 offen sc0 sc1
v_cvt_pk_bf16_f32 v20, v8, v9
v_cvt_pk_bf16_f32 v21, v10, v11
v_cvt_pk_bf16_f32 v22, v12, v13
v_cvt_pk_bf16_f32 v23, v14, v15
s_nop 0
v_permlane16_swap_b32 v20, v22
v_permlane16_swap_b32 v21, v23
buffer_store_dwordx4 v[20:23], v240, s[20:23], s51 offen sc0 sc1
s_waitcnt vmcnt(6)
ds_read_b64_tr_b16 v[240:241], v169 offset:0
ds_read_b64_tr_b16 v[242:243], v169 offset:1024
ds_read_b64_tr_b16 v[244:245], v170 offset:0
ds_read_b64_tr_b16 v[246:247], v170 offset:1024
ds_read_b64_tr_b16 v[248:249], v171 offset:0
ds_read_b64_tr_b16 v[250:251], v171 offset:1024
ds_read_b64_tr_b16 v[252:253], v172 offset:0
ds_read_b64_tr_b16 v[254:255], v172 offset:1024
s_waitcnt lgkmcnt(0)
s_add_u32 m0, s63, 0
s_add_u32 s49, s68, 32768
buffer_load_dwordx4 v168, s[32:35], s49 offen lds
s_add_u32 m0, s63, 1024
s_add_u32 s49, s68, 36864
buffer_load_dwordx4 v168, s[32:35], s49 offen lds
s_add_u32 m0, s63, 2048
s_add_u32 s49, s68, 49152
buffer_load_dwordx4 v168, s[32:35], s49 offen lds
s_add_u32 m0, s63, 3072
s_add_u32 s49, s68, 53248
buffer_load_dwordx4 v168, s[32:35], s49 offen lds
s_mov_b64 exec, 0xff
buffer_load_dwordx2 v[174:175], v164, s[20:23], s57 offen sc0 sc1
s_mov_b64 exec, -1
v_mov_b32 v173, 160520
s_lshl_b32 s45, 16, s41
v_mov_b32 v16, s45
v_lshlrev_b32 v17, 10, v164
s_waitcnt vmcnt(0)
s_mov_b64 exec, 15
buffer_store_dwordx2 v[166:167], v17, s[20:23], s56 offen sc0 sc1
s_mov_b64 exec, -1
s_cmp_eq_u32 s42, 0
s_cbranch_scc1 L_e1f
s_mov_b64 exec, 1
ds_or_b32 v173, v16
s_mov_b64 exec, -1
s_branch L_e1g
L_e1f:
ds_read_b32 v16, v173
s_sub_u32 s74, s74, 1
s_cmp_lt_i32 s74, 0
s_waitcnt lgkmcnt(0)
s_cbranch_scc1 L_e1g
v_readfirstlane_b32 s45, v16
s_cmp_lt_u32 s45, 0xf0
s_cbranch_scc1 L_e1f
L_e1g:
v_cmp_eq_u64 vcc, s[64:65], v[174:175]
s_and_b32 s45, vcc_lo, 0xff
s_cmp_eq_u32 s45, 0xff
s_cbranch_scc1 L_loads
s_branch L_poll0
L_t2:
s_cmp_lg_u32 s42, 0
s_cbranch_scc1 L_t2m1
s_lshr_b32 s46, s2, 5
s_mul_i32 s0, s46, 3584
s_lshr_b32 s46, s44, 1
s_mul_i32 s46, s46, 640
s_add_u32 s0, s0, s46
s_lshl_b32 s46, s41, 7
s_add_u32 s0, s0, s46
s_add_u32 s0, s0, 230400
s_mov_b32 s1, 229376
s_mov_b32 s20, 0xff
s_mov_b32 s21, 1835008
v_mul_u32_u24 v247, 28672, v167
v_mul_u32_u24 v220, 3584, v232
v_add_u32 v220, v220, v233
s_mul_i32 s50, s44, 320
s_add_u32 s50, s50, 1024
s_bitcmp1_b32 s44, 0
s_cselect_b32 s45, 64, 0
s_cselect_b32 s46, 0, 256
s_add_u32 s51, s50, s46
s_add_u32 s50, s50, s45
s_waitcnt lgkmcnt(0)
s_mov_b64 s[4:5], s[64:65]
s_mov_b64 s[8:9], s[72:73]
s_mov_b64 s[12:13], s[74:75]
s_mov_b32 s70, s20
s_mov_b32 s71, 0
s_bitcmp0_b32 s2, 3
s_cselect_b64 s[72:73], s[72:73], s[74:75]
s_mov_b32 s74, s21
s_mov_b32 s75, 0x00020000
s_mov_b64 exec, s[70:71]
buffer_load_dword v225, v247, s[72:75], s0 offen
s_mov_b64 exec, -1
s_add_u32 s0, s0, s1
s_add_u32 m0, s56, 118784
s_nop 0
buffer_load_dwordx4 v222, s[4:7], s52 offen offset:0 lds
s_add_u32 m0, s55, 81920
s_nop 0
buffer_load_dwordx4 v220, s[8:11], s50 offen offset:0 lds
s_add_u32 m0, s55, 85888
s_nop 0
buffer_load_dwordx4 v220, s[8:11], s50 offen offset:128 lds
s_add_u32 m0, s55, 90112
s_nop 0
buffer_load_dwordx4 v220, s[12:15], s50 offen offset:0 lds
s_add_u32 s50, s50, 114688
s_add_u32 m0, s55, 0
s_nop 0
buffer_load_dwordx4 v220, s[8:11], s50 offen offset:0 lds
s_add_u32 m0, s55, 3968
s_nop 0
buffer_load_dwordx4 v220, s[8:11], s50 offen offset:128 lds
s_add_u32 m0, s55, 8192
s_nop 0
buffer_load_dwordx4 v220, s[12:15], s50 offen offset:0 lds
s_add_u32 s50, s50, 114688
s_mov_b64 exec, s[70:71]
buffer_load_dword v225, v247, s[72:75], s0 offen
s_mov_b64 exec, -1
s_add_u32 s0, s0, s1
s_add_u32 m0, s56, 135040
s_nop 0
buffer_load_dwordx4 v222, s[4:7], s52 offen offset:128 lds
s_add_u32 m0, s55, 20480
s_nop 0
buffer_load_dwordx4 v220, s[8:11], s50 offen offset:0 lds
s_add_u32 m0, s55, 24448
s_nop 0
buffer_load_dwordx4 v220, s[8:11], s50 offen offset:128 lds
s_add_u32 m0, s55, 28672
s_nop 0
buffer_load_dwordx4 v220, s[12:15], s50 offen offset:0 lds
s_add_u32 s50, s50, 114688
s_mov_b64 exec, s[70:71]
buffer_load_dword v225, v247, s[72:75], s0 offen
s_mov_b64 exec, -1
s_add_u32 s0, s0, s1
s_mov_b64 s[20:21], s[82:83]
s_mov_b64 s[24:25], s[80:81]
s_mov_b64 s[28:29], s[68:69]
s_mov_b64 s[32:33], s[76:77]
s_mov_b64 s[36:37], s[78:79]
s_mov_b32 s23, 0x00020000
s_mov_b32 s27, 0x00020000
s_mov_b32 s31, 0x00020000
s_mov_b32 s35, 0x00020000
s_mov_b32 s39, 0x00020000
s_mov_b32 s22, 9601024
s_mov_b32 s26, 256
s_mov_b32 s30, 524288
s_mov_b32 s34, 1835008
s_mov_b32 s38, 0x200000
s_mov_b32 s58, 0xffff0000
s_mov_b32 s60, 0xfffefffe
s_mov_b32 s61, 0xfffefffe
s_and_b32 s45, s2, 6
s_lshr_b32 s46, s2, 7
s_add_u32 s45, s45, s46
s_lshl_b32 s45, s45, 1
s_and_b32 s46, s2, 1
s_add_u32 s45, s45, s46
s_lshl_b32 s45, s45, 1
s_bfe_u32 s46, s2, 0x10006
s_add_u32 s59, s45, s46
s_bfe_u32 s62, s2, 0x30003
s_lshl_b32 s63, s40, 12
s_add_u32 s101, s40, s62
s_and_b32 s101, s101, 7
s_lshl_b32 s45, s62, 7
s_lshl_b32 s100, s40, 15
s_add_u32 s100, s100, s45
s_mul_i32 s3, s101, 163840
s_add_u32 s3, s3, 524288
s_add_u32 s3, s3, s45
v_bfe_u32 v232, v167, 2, 3
v_lshrrev_b32 v233, 5, v167
v_lshlrev_b32 v234, 11, v233
v_lshl_add_u32 v234, v232, 7, v234
v_and_b32 v235, 3, v167
v_lshl_add_u32 v234, v235, 3, v234
v_lshrrev_b32 v236, 1, v232
s_and_b32 s45, s40, 1
s_lshl_b32 s45, s45, 1
v_xor_b32 v237, s45, v236
v_add_u32 v239, s63, v234
v_xor_b32 v238, 0, v237
v_lshl_add_u32 v169, v238, 5, v239
v_xor_b32 v238, 1, v237
v_lshl_add_u32 v170, v238, 5, v239
v_xor_b32 v238, 2, v237
v_lshl_add_u32 v171, v238, 5, v239
v_xor_b32 v238, 3, v237
v_lshl_add_u32 v172, v238, 5, v239
s_and_b32 s45, s41, 1
s_lshl_b32 s46, s45, 1
v_xor_b32 v236, s46, v236
v_lshl_add_u32 v208, v236, 5, v234
s_lshr_b32 s46, s41, 1
s_lshl_b32 s46, s46, 12
v_add_u32 v208, s46, v208
v_xor_b32 v209, 32, v208
v_lshrrev_b32 v234, 1, v235
v_lshlrev_b32 v236, 11, v234
v_lshl_add_u32 v236, v233, 10, v236
v_lshl_add_u32 v236, v232, 6, v236
v_and_b32 v235, 1, v235
v_lshl_add_u32 v236, v235, 3, v236
v_bfe_u32 v235, v167, 4, 1
v_lshlrev_b32 v235, 1, v235
v_xor_b32 v235, v235, v234
v_xor_b32 v235, s41, v235
v_lshl_add_u32 v210, v235, 4, v236
v_add_u32 v211, 61440, v208
v_add_u32 v212, 61440, v209
v_add_u32 v213, 61440, v210
v_and_b32 v232, 15, v167
v_lshrrev_b32 v233, 4, v167
v_lshrrev_b32 v234, 1, v232
v_xor_b32 v233, v233, v234
v_lshlrev_b32 v233, 4, v233
v_lshl_add_u32 v233, v232, 7, v233
v_add_u32 v214, 102400, v233
v_xor_b32 v215, 64, v214
v_add_u32 v216, s56, v214
v_add_u32 v217, s56, v215
v_mov_b32 v152, 0x3f803f80
v_mov_b32 v153, 0x3f803f80
v_mov_b32 v154, 0x3f803f80
v_mov_b32 v155, 0x3f803f80
v_mov_b32 v180, 0
v_mov_b32 v181, 0
v_mov_b32 v182, 0
v_mov_b32 v183, 0
v_mov_b32 v184, 0
v_mov_b32 v185, 0
s_or_b32 s45, s41, s2
s_cmp_lg_u32 s45, 0
s_cbranch_scc1 L_tk2
s_or_b32 s98, s98, 1
v_mov_b32 v176, s98
v_mov_b32 v177, s99
s_mov_b64 exec, 1
buffer_store_dwordx2 v[176:177], off, s[24:27], 0 sc0 sc1
s_mov_b64 exec, -1
L_tk2:
v_lshrrev_b32 v226, 3, v167
v_lshlrev_b32 v226, 15, v226
v_and_b32 v227, 7, v167
v_lshl_add_u32 v226, v227, 10, v226
s_lshr_b32 s45, s2, 6
s_lshl_b32 s45, s45, 13
v_add_u32 v226, s45, v226
v_and_b32 v227, 8, v167
v_mul_u32_u24 v227, 28672, v227
v_add3_u32 v227, v227, v226, s100
s_lshl_b32 s45, s101, 16
s_lshl_b32 s46, s62, 7
s_add_u32 s45, s45, s46
s_sub_u32 s45, s45, 163840
v_add_u32 v233, s45, v226
v_add_u32 v226, s3, v226
v_cmp_lt_u32 vcc, 39, v167
s_nop 1
v_cndmask_b32 v226, v226, v233, vcc
v_lshlrev_b32 v164, 4, v167
v_and_b32 v232, 0xf0, v164
v_bfe_u32 v233, v167, 4, 1
v_lshrrev_b32 v234, 5, v167
v_lshl_add_u32 v235, v233, 1, v234
v_lshlrev_b32 v165, 6, v232
v_lshl_add_u32 v165, v235, 4, v165
v_mov_b32 v174, 160512
v_lshrrev_b32 v244, 1, v232
v_add_u32 v244, 157696, v244
s_lshl_b32 s45, s41, 7
v_add_u32 v245, s45, v244
v_and_b32 v246, 0x30, v167
s_mul_i32 s45, s41, 320
s_add_u32 s45, s45, 159232
v_lshl_add_u32 v240, v235, 8, v232
v_mul_u32_u24 v241, 73728, v235
v_add_u32 v241, v241, v232
v_add_u32 v246, s45, v246
s_waitcnt vmcnt(9)
s_waitcnt lgkmcnt(0)
s_barrier
ds_read_b128 v[92:95], v214 offset:16384
ds_read_b128 v[96:99], v214 offset:18432
ds_read_b128 v[100:103], v214 offset:20480
ds_read_b128 v[104:107], v214 offset:22528
ds_read_b64_tr_b16 v[132:133], v211 offset:20480
ds_read_b64_tr_b16 v[134:135], v211 offset:21504
ds_read_b64_tr_b16 v[136:137], v211 offset:28672
ds_read_b64_tr_b16 v[138:139], v211 offset:29696
ds_read_b64_tr_b16 v[140:141], v212 offset:20480
ds_read_b64_tr_b16 v[142:143], v212 offset:21504
ds_read_b64_tr_b16 v[144:145], v212 offset:28672
ds_read_b64_tr_b16 v[146:147], v212 offset:29696
ds_read_b64_tr_b16 v[148:149], v213 offset:36864
ds_read_b64_tr_b16 v[150:151], v213 offset:37376
ds_read_b128 v[248:251], v216 offset:16384
s_waitcnt lgkmcnt(9)
v_mfma_f32_16x16x32_bf16 v[0:3], v[132:135], v[92:95], 0
v_mfma_f32_16x16x32_bf16 v[4:7], v[132:135], v[96:99], 0
v_mfma_f32_16x16x32_bf16 v[8:11], v[132:135], v[100:103], 0
v_mfma_f32_16x16x32_bf16 v[12:15], v[132:135], v[104:107], 0
v_mfma_f32_16x16x32_bf16 v[80:83], v[132:135], v[152:155], 0
s_waitcnt vmcnt(6)
s_waitcnt lgkmcnt(0)
s_barrier
ds_read_b64_tr_b16 v[132:133], v208 offset:0
ds_read_b64_tr_b16 v[134:135], v208 offset:1024
v_mfma_f32_16x16x32_bf16 v[16:19], v[136:139], v[92:95], 0
ds_read_b128 v[156:159], v217 offset:16384
ds_read_b128 v[108:111], v215 offset:16384
ds_read_b128 v[112:115], v215 offset:18432
s_add_u32 m0, s55, 40960
s_nop 0
buffer_load_dwordx4 v220, s[8:11], s50 offen offset:0 lds
v_lshlrev_b32 v192, 16, v248
v_and_b32 v193, s58, v248
v_lshlrev_b32 v194, 16, v249
v_mfma_f32_16x16x32_bf16 v[20:23], v[136:139], v[96:99], 0
ds_read_b128 v[116:119], v215 offset:20480
ds_read_b128 v[120:123], v215 offset:22528
v_and_b32 v195, s58, v249
v_add_f32 v180, v180, v192
v_add_f32 v181, v181, v193
v_mfma_f32_16x16x32_bf16 v[24:27], v[136:139], v[100:103], 0
v_fmac_f32 v182, v192, v192
v_fmac_f32 v183, v193, v193
v_lshlrev_b32 v196, 16, v250
v_mfma_f32_16x16x32_bf16 v[28:31], v[136:139], v[104:107], 0
s_add_u32 m0, s55, 44928
s_nop 0
buffer_load_dwordx4 v220, s[8:11], s50 offen offset:128 lds
v_and_b32 v197, s58, v250
v_add_f32 v180, v180, v194
v_add_f32 v181, v181, v195
v_mfma_f32_16x16x32_bf16 v[84:87], v[136:139], v[152:155], 0
ds_read_b64_tr_b16 v[136:137], v208 offset:8192
ds_read_b64_tr_b16 v[138:139], v208 offset:9216
v_fmac_f32 v182, v194, v194
v_fmac_f32 v183, v195, v195
v_lshlrev_b32 v198, 16, v251
v_mfma_f32_16x16x32_bf16 v[32:35], v[140:143], v[92:95], 0
v_and_b32 v199, s58, v251
v_add_f32 v180, v180, v196
v_add_f32 v181, v181, v197
v_mfma_f32_16x16x32_bf16 v[36:39], v[140:143], v[96:99], 0
s_add_u32 m0, s55, 49152
s_nop 0
buffer_load_dwordx4 v220, s[12:15], s50 offen offset:0 lds
s_add_u32 s50, s50, 114688
v_fmac_f32 v182, v196, v196
v_fmac_f32 v183, v197, v197
v_add_f32 v180, v180, v198
v_mfma_f32_16x16x32_bf16 v[40:43], v[140:143], v[100:103], 0
v_add_f32 v181, v181, v199
v_fmac_f32 v182, v198, v198
v_fmac_f32 v183, v199, v199
v_mfma_f32_16x16x32_bf16 v[44:47], v[140:143], v[104:107], 0
ds_read_b64_tr_b16 v[140:141], v209 offset:0
ds_read_b64_tr_b16 v[142:143], v209 offset:1024
s_waitcnt lgkmcnt(8)
v_lshlrev_b32 v192, 16, v156
v_and_b32 v193, s58, v156
v_lshlrev_b32 v194, 16, v157
v_mfma_f32_16x16x32_bf16 v[48:51], v[144:147], v[92:95], 0
s_add_u32 m0, s56, 102144
s_nop 0
buffer_load_dwordx4 v222, s[4:7], s52 offen offset:256 lds
v_and_b32 v195, s58, v157
v_add_f32 v180, v180, v192
v_add_f32 v181, v181, v193
v_mfma_f32_16x16x32_bf16 v[52:55], v[144:147], v[96:99], 0
v_fmac_f32 v182, v192, v192
v_fmac_f32 v183, v193, v193
v_lshlrev_b32 v196, 16, v158
v_mfma_f32_16x16x32_bf16 v[56:59], v[144:147], v[100:103], 0
v_and_b32 v197, s58, v158
v_add_f32 v180, v180, v194
v_add_f32 v181, v181, v195
v_mfma_f32_16x16x32_bf16 v[60:63], v[144:147], v[104:107], 0
ds_read_b64_tr_b16 v[144:145], v209 offset:8192
ds_read_b64_tr_b16 v[146:147], v209 offset:9216
s_add_u32 m0, s55, 61440
s_nop 0
buffer_load_dwordx4 v220, s[8:11], s50 offen offset:0 lds
v_fmac_f32 v182, v194, v194
v_fmac_f32 v183, v195, v195
v_lshlrev_b32 v198, 16, v159
v_mfma_f32_16x16x32_bf16 v[64:67], v[148:151], v[92:95], 0
v_and_b32 v199, s58, v159
v_add_f32 v180, v180, v196
v_add_f32 v181, v181, v197
v_mfma_f32_16x16x32_bf16 v[68:71], v[148:151], v[96:99], 0
v_fmac_f32 v182, v196, v196
v_fmac_f32 v183, v197, v197
v_mfma_f32_16x16x32_bf16 v[72:75], v[148:151], v[100:103], 0
s_add_u32 m0, s55, 65408
s_nop 0
buffer_load_dwordx4 v220, s[8:11], s50 offen offset:128 lds
v_add_f32 v180, v180, v198
v_add_f32 v181, v181, v199
v_mfma_f32_16x16x32_bf16 v[76:79], v[148:151], v[104:107], 0
ds_read_b64_tr_b16 v[148:149], v210 offset:16384
ds_read_b64_tr_b16 v[150:151], v210 offset:16896
v_fmac_f32 v182, v198, v198
v_fmac_f32 v183, v199, v199
s_waitcnt lgkmcnt(8)
v_mfma_f32_16x16x32_bf16 v[0:3], v[132:135], v[108:111], v[0:3]
v_mfma_f32_16x16x32_bf16 v[4:7], v[132:135], v[112:115], v[4:7]
v_mfma_f32_16x16x32_bf16 v[8:11], v[132:135], v[116:119], v[8:11]
v_mfma_f32_16x16x32_bf16 v[12:15], v[132:135], v[120:123], v[12:15]
v_mfma_f32_16x16x32_bf16 v[80:83], v[132:135], v[152:155], v[80:83]
s_waitcnt vmcnt(7)
s_waitcnt lgkmcnt(0)
s_barrier
ds_read_b64_tr_b16 v[132:133], v208 offset:20480
ds_read_b64_tr_b16 v[134:135], v208 offset:21504
v_mfma_f32_16x16x32_bf16 v[16:19], v[136:139], v[108:111], v[16:19]
ds_read_b128 v[156:159], v216 offset:32768
ds_read_b128 v[92:95], v214 offset:32768
ds_read_b128 v[96:99], v214 offset:34816
s_add_u32 m0, s55, 69632
s_nop 0
buffer_load_dwordx4 v220, s[12:15], s50 offen offset:0 lds
s_add_u32 s50, s50, 114688
v_mfma_f32_16x16x32_bf16 v[20:23], v[136:139], v[112:115], v[20:23]
ds_read_b128 v[100:103], v214 offset:36864
ds_read_b128 v[104:107], v214 offset:38912
v_mfma_f32_16x16x32_bf16 v[24:27], v[136:139], v[116:119], v[24:27]
v_mfma_f32_16x16x32_bf16 v[28:31], v[136:139], v[120:123], v[28:31]
s_add_u32 m0, s55, 81920
s_nop 0
buffer_load_dwordx4 v220, s[8:11], s50 offen offset:0 lds
v_mfma_f32_16x16x32_bf16 v[84:87], v[136:139], v[152:155], v[84:87]
ds_read_b64_tr_b16 v[136:137], v208 offset:28672
ds_read_b64_tr_b16 v[138:139], v208 offset:29696
s_waitcnt lgkmcnt(6)
v_lshlrev_b32 v192, 16, v156
v_and_b32 v193, s58, v156
v_mfma_f32_16x16x32_bf16 v[32:35], v[140:143], v[108:111], v[32:35]
v_lshlrev_b32 v194, 16, v157
v_and_b32 v195, s58, v157
v_mfma_f32_16x16x32_bf16 v[36:39], v[140:143], v[112:115], v[36:39]
s_add_u32 m0, s55, 85888
s_nop 0
buffer_load_dwordx4 v220, s[8:11], s50 offen offset:128 lds
v_add_f32 v180, v180, v192
v_add_f32 v181, v181, v193
v_mfma_f32_16x16x32_bf16 v[40:43], v[140:143], v[116:119], v[40:43]
v_fmac_f32 v182, v192, v192
v_fmac_f32 v183, v193, v193
v_mfma_f32_16x16x32_bf16 v[44:47], v[140:143], v[120:123], v[44:47]
ds_read_b64_tr_b16 v[140:141], v209 offset:20480
ds_read_b64_tr_b16 v[142:143], v209 offset:21504
v_lshlrev_b32 v196, 16, v158
v_and_b32 v197, s58, v158
v_mfma_f32_16x16x32_bf16 v[48:51], v[144:147], v[108:111], v[48:51]
s_add_u32 m0, s55, 90112
s_nop 0
buffer_load_dwordx4 v220, s[12:15], s50 offen offset:0 lds
s_add_u32 s50, s50, 114688
v_add_f32 v180, v180, v194
v_add_f32 v181, v181, v195
v_mfma_f32_16x16x32_bf16 v[52:55], v[144:147], v[112:115], v[52:55]
v_fmac_f32 v182, v194, v194
v_fmac_f32 v183, v195, v195
v_mfma_f32_16x16x32_bf16 v[56:59], v[144:147], v[116:119], v[56:59]
v_lshlrev_b32 v198, 16, v159
v_and_b32 v199, s58, v159
v_mfma_f32_16x16x32_bf16 v[60:63], v[144:147], v[120:123], v[60:63]
ds_read_b64_tr_b16 v[144:145], v209 offset:28672
ds_read_b64_tr_b16 v[146:147], v209 offset:29696
s_add_u32 m0, s55, 0
s_nop 0
buffer_load_dwordx4 v220, s[8:11], s50 offen offset:0 lds
v_add_f32 v180, v180, v196
v_add_f32 v181, v181, v197
v_mfma_f32_16x16x32_bf16 v[64:67], v[148:151], v[108:111], v[64:67]
v_fmac_f32 v182, v196, v196
v_fmac_f32 v183, v197, v197
v_mfma_f32_16x16x32_bf16 v[68:71], v[148:151], v[112:115], v[68:71]
v_add_f32 v180, v180, v198
v_add_f32 v181, v181, v199
v_mfma_f32_16x16x32_bf16 v[72:75], v[148:151], v[116:119], v[72:75]
s_add_u32 m0, s55, 3968
s_nop 0
buffer_load_dwordx4 v220, s[8:11], s50 offen offset:128 lds
v_fmac_f32 v182, v198, v198
v_mfma_f32_16x16x32_bf16 v[76:79], v[148:151], v[120:123], v[76:79]
ds_read_b64_tr_b16 v[148:149], v210 offset:36864
ds_read_b64_tr_b16 v[150:151], v210 offset:37376
v_fmac_f32 v183, v199, v199
s_mov_b64 exec, s[70:71]
buffer_load_dword v225, v247, s[72:75], s0 offen
s_mov_b64 exec, -1
s_add_u32 s0, s0, s1
s_waitcnt lgkmcnt(8)
v_mfma_f32_16x16x32_bf16 v[0:3], v[132:135], v[92:95], v[0:3]
v_mfma_f32_16x16x32_bf16 v[4:7], v[132:135], v[96:99], v[4:7]
v_mfma_f32_16x16x32_bf16 v[8:11], v[132:135], v[100:103], v[8:11]
v_mfma_f32_16x16x32_bf16 v[12:15], v[132:135], v[104:107], v[12:15]
v_mfma_f32_16x16x32_bf16 v[80:83], v[132:135], v[152:155], v[80:83]
s_waitcnt vmcnt(10)
s_waitcnt lgkmcnt(0)
s_barrier
ds_read_b64_tr_b16 v[132:133], v208 offset:40960
ds_read_b64_tr_b16 v[134:135], v208 offset:41984
v_mfma_f32_16x16x32_bf16 v[16:19], v[136:139], v[92:95], v[16:19]
ds_read_b128 v[156:159], v217 offset:32768
ds_read_b128 v[108:111], v215 offset:32768
ds_read_b128 v[112:115], v215 offset:34816
s_add_u32 m0, s55, 8192
s_nop 0
buffer_load_dwordx4 v220, s[12:15], s50 offen offset:0 lds
s_add_u32 s50, s50, 114688
v_mfma_f32_16x16x32_bf16 v[20:23], v[136:139], v[96:99], v[20:23]
ds_read_b128 v[116:119], v215 offset:36864
ds_read_b128 v[120:123], v215 offset:38912
v_mfma_f32_16x16x32_bf16 v[24:27], v[136:139], v[100:103], v[24:27]
v_mfma_f32_16x16x32_bf16 v[28:31], v[136:139], v[104:107], v[28:31]
s_add_u32 m0, s56, 118400
s_nop 0
buffer_load_dwordx4 v222, s[4:7], s52 offen offset:384 lds
v_mfma_f32_16x16x32_bf16 v[84:87], v[136:139], v[152:155], v[84:87]
ds_read_b64_tr_b16 v[136:137], v208 offset:49152
ds_read_b64_tr_b16 v[138:139], v208 offset:50176
s_waitcnt lgkmcnt(6)
v_lshlrev_b32 v192, 16, v156
v_and_b32 v193, s58, v156
v_mfma_f32_16x16x32_bf16 v[32:35], v[140:143], v[92:95], v[32:35]
v_lshlrev_b32 v194, 16, v157
v_and_b32 v195, s58, v157
v_mfma_f32_16x16x32_bf16 v[36:39], v[140:143], v[96:99], v[36:39]
s_add_u32 m0, s55, 20480
s_nop 0
buffer_load_dwordx4 v220, s[8:11], s50 offen offset:0 lds
v_add_f32 v180, v180, v192
v_add_f32 v181, v181, v193
v_mfma_f32_16x16x32_bf16 v[40:43], v[140:143], v[100:103], v[40:43]
v_fmac_f32 v182, v192, v192
v_fmac_f32 v183, v193, v193
v_mfma_f32_16x16x32_bf16 v[44:47], v[140:143], v[104:107], v[44:47]
ds_read_b64_tr_b16 v[140:141], v209 offset:40960
ds_read_b64_tr_b16 v[142:143], v209 offset:41984
v_lshlrev_b32 v196, 16, v158
v_and_b32 v197, s58, v158
v_mfma_f32_16x16x32_bf16 v[48:51], v[144:147], v[92:95], v[48:51]
s_add_u32 m0, s55, 24448
s_nop 0
buffer_load_dwordx4 v220, s[8:11], s50 offen offset:128 lds
v_add_f32 v180, v180, v194
v_add_f32 v181, v181, v195
v_mfma_f32_16x16x32_bf16 v[52:55], v[144:147], v[96:99], v[52:55]
v_fmac_f32 v182, v194, v194
v_fmac_f32 v183, v195, v195
v_mfma_f32_16x16x32_bf16 v[56:59], v[144:147], v[100:103], v[56:59]
v_lshlrev_b32 v198, 16, v159
v_and_b32 v199, s58, v159
v_mfma_f32_16x16x32_bf16 v[60:63], v[144:147], v[104:107], v[60:63]
ds_read_b64_tr_b16 v[144:145], v209 offset:49152
ds_read_b64_tr_b16 v[146:147], v209 offset:50176
s_add_u32 m0, s55, 28672
s_nop 0
buffer_load_dwordx4 v220, s[12:15], s50 offen offset:0 lds
s_add_u32 s50, s50, 114688
v_add_f32 v180, v180, v196
v_add_f32 v181, v181, v197
v_mfma_f32_16x16x32_bf16 v[64:67], v[148:151], v[92:95], v[64:67]
v_fmac_f32 v182, v196, v196
v_fmac_f32 v183, v197, v197
v_mfma_f32_16x16x32_bf16 v[68:71], v[148:151], v[96:99], v[68:71]
v_add_f32 v180, v180, v198
v_add_f32 v181, v181, v199
v_mfma_f32_16x16x32_bf16 v[72:75], v[148:151], v[100:103], v[72:75]
v_fmac_f32 v182, v198, v198
v_mfma_f32_16x16x32_bf16 v[76:79], v[148:151], v[104:107], v[76:79]
ds_read_b64_tr_b16 v[148:149], v210 offset:57344
ds_read_b64_tr_b16 v[150:151], v210 offset:57856
v_fmac_f32 v183, v199, v199
s_waitcnt lgkmcnt(8)
v_mfma_f32_16x16x32_bf16 v[0:3], v[132:135], v[108:111], v[0:3]
v_mfma_f32_16x16x32_bf16 v[4:7], v[132:135], v[112:115], v[4:7]
v_mfma_f32_16x16x32_bf16 v[8:11], v[132:135], v[116:119], v[8:11]
v_mfma_f32_16x16x32_bf16 v[12:15], v[132:135], v[120:123], v[12:15]
v_mfma_f32_16x16x32_bf16 v[80:83], v[132:135], v[152:155], v[80:83]
s_waitcnt vmcnt(11)
s_waitcnt lgkmcnt(0)
s_barrier
ds_read_b64_tr_b16 v[132:133], v211 offset:0
ds_read_b64_tr_b16 v[134:135], v211 offset:1024
v_mfma_f32_16x16x32_bf16 v[16:19], v[136:139], v[108:111], v[16:19]
ds_read_b128 v[156:159], v216 offset:0
ds_read_b128 v[92:95], v214 offset:0
ds_read_b128 v[96:99], v214 offset:2048
s_add_u32 m0, s55, 40960
s_nop 0
buffer_load_dwordx4 v220, s[8:11], s50 offen offset:0 lds
v_mfma_f32_16x16x32_bf16 v[20:23], v[136:139], v[112:115], v[20:23]
ds_read_b128 v[100:103], v214 offset:4096
ds_read_b128 v[104:107], v214 offset:6144
v_mfma_f32_16x16x32_bf16 v[24:27], v[136:139], v[116:119], v[24:27]
v_mfma_f32_16x16x32_bf16 v[28:31], v[136:139], v[120:123], v[28:31]
s_add_u32 m0, s55, 44928
s_nop 0
buffer_load_dwordx4 v220, s[8:11], s50 offen offset:128 lds
v_mfma_f32_16x16x32_bf16 v[84:87], v[136:139], v[152:155], v[84:87]
ds_read_b64_tr_b16 v[136:137], v211 offset:8192
ds_read_b64_tr_b16 v[138:139], v211 offset:9216
s_waitcnt lgkmcnt(6)
v_lshlrev_b32 v192, 16, v156
v_and_b32 v193, s58, v156
v_mfma_f32_16x16x32_bf16 v[32:35], v[140:143], v[108:111], v[32:35]
v_lshlrev_b32 v194, 16, v157
v_and_b32 v195, s58, v157
v_mfma_f32_16x16x32_bf16 v[36:39], v[140:143], v[112:115], v[36:39]
s_add_u32 m0, s55, 49152
s_nop 0
buffer_load_dwordx4 v220, s[12:15], s50 offen offset:0 lds
s_add_u32 s50, s50, 114688
v_add_f32 v180, v180, v192
v_add_f32 v181, v181, v193
v_mfma_f32_16x16x32_bf16 v[40:43], v[140:143], v[116:119], v[40:43]
v_fmac_f32 v182, v192, v192
v_fmac_f32 v183, v193, v193
v_mfma_f32_16x16x32_bf16 v[44:47], v[140:143], v[120:123], v[44:47]
ds_read_b64_tr_b16 v[140:141], v212 offset:0
ds_read_b64_tr_b16 v[142:143], v212 offset:1024
v_lshlrev_b32 v196, 16, v158
v_and_b32 v197, s58, v158
v_mfma_f32_16x16x32_bf16 v[48:51], v[144:147], v[108:111], v[48:51]
v_add_f32 v180, v180, v194
v_add_f32 v181, v181, v195
v_mfma_f32_16x16x32_bf16 v[52:55], v[144:147], v[112:115], v[52:55]
v_fmac_f32 v182, v194, v194
v_fmac_f32 v183, v195, v195
v_mfma_f32_16x16x32_bf16 v[56:59], v[144:147], v[116:119], v[56:59]
v_lshlrev_b32 v198, 16, v159
v_and_b32 v199, s58, v159
v_mfma_f32_16x16x32_bf16 v[60:63], v[144:147], v[120:123], v[60:63]
ds_read_b64_tr_b16 v[144:145], v212 offset:8192
ds_read_b64_tr_b16 v[146:147], v212 offset:9216
v_add_f32 v180, v180, v196
v_add_f32 v181, v181, v197
v_mfma_f32_16x16x32_bf16 v[64:67], v[148:151], v[108:111], v[64:67]
v_fmac_f32 v182, v196, v196
v_fmac_f32 v183, v197, v197
v_mfma_f32_16x16x32_bf16 v[68:71], v[148:151], v[112:115], v[68:71]
v_add_f32 v180, v180, v198
v_add_f32 v181, v181, v199
v_mfma_f32_16x16x32_bf16 v[72:75], v[148:151], v[116:119], v[72:75]
v_fmac_f32 v182, v198, v198
v_mfma_f32_16x16x32_bf16 v[76:79], v[148:151], v[120:123], v[76:79]
ds_read_b64_tr_b16 v[148:149], v213 offset:16384
ds_read_b64_tr_b16 v[150:151], v213 offset:16896
v_fmac_f32 v183, v199, v199
s_mov_b64 exec, s[70:71]
buffer_load_dword v225, v247, s[72:75], s0 offen
s_mov_b64 exec, -1
s_add_u32 s0, s0, s1
s_waitcnt lgkmcnt(8)
v_mfma_f32_16x16x32_bf16 v[0:3], v[132:135], v[92:95], v[0:3]
v_mfma_f32_16x16x32_bf16 v[4:7], v[132:135], v[96:99], v[4:7]
v_mfma_f32_16x16x32_bf16 v[8:11], v[132:135], v[100:103], v[8:11]
v_mfma_f32_16x16x32_bf16 v[12:15], v[132:135], v[104:107], v[12:15]
v_mfma_f32_16x16x32_bf16 v[80:83], v[132:135], v[152:155], v[80:83]
s_waitcnt vmcnt(12)
s_waitcnt lgkmcnt(0)
s_barrier
ds_read_b64_tr_b16 v[132:133], v211 offset:20480
ds_read_b64_tr_b16 v[134:135], v211 offset:21504
v_mfma_f32_16x16x32_bf16 v[16:19], v[136:139], v[92:95], v[16:19]
ds_read_b128 v[156:159], v217 offset:0
ds_read_b128 v[108:111], v215 offset:0
ds_read_b128 v[112:115], v215 offset:2048
s_add_u32 m0, s56, 134656
s_nop 0
buffer_load_dwordx4 v222, s[4:7], s52 offen offset:512 lds
v_mfma_f32_16x16x32_bf16 v[20:23], v[136:139], v[96:99], v[20:23]
ds_read_b128 v[116:119], v215 offset:4096
ds_read_b128 v[120:123], v215 offset:6144
v_mfma_f32_16x16x32_bf16 v[24:27], v[136:139], v[100:103], v[24:27]
v_mfma_f32_16x16x32_bf16 v[28:31], v[136:139], v[104:107], v[28:31]
s_add_u32 m0, s55, 61440
s_nop 0
buffer_load_dwordx4 v220, s[8:11], s50 offen offset:0 lds
v_mfma_f32_16x16x32_bf16 v[84:87], v[136:139], v[152:155], v[84:87]
ds_read_b64_tr_b16 v[136:137], v211 offset:28672
ds_read_b64_tr_b16 v[138:139], v211 offset:29696
s_waitcnt lgkmcnt(6)
v_lshlrev_b32 v192, 16, v156
v_and_b32 v193, s58, v156
v_mfma_f32_16x16x32_bf16 v[32:35], v[140:143], v[92:95], v[32:35]
v_lshlrev_b32 v194, 16, v157
v_and_b32 v195, s58, v157
v_mfma_f32_16x16x32_bf16 v[36:39], v[140:143], v[96:99], v[36:39]
s_add_u32 m0, s55, 65408
s_nop 0
buffer_load_dwordx4 v220, s[8:11], s50 offen offset:128 lds
v_add_f32 v180, v180, v192
v_add_f32 v181, v181, v193
v_mfma_f32_16x16x32_bf16 v[40:43], v[140:143], v[100:103], v[40:43]
v_fmac_f32 v182, v192, v192
v_fmac_f32 v183, v193, v193
v_mfma_f32_16x16x32_bf16 v[44:47], v[140:143], v[104:107], v[44:47]
ds_read_b64_tr_b16 v[140:141], v212 offset:20480
ds_read_b64_tr_b16 v[142:143], v212 offset:21504
v_lshlrev_b32 v196, 16, v158
v_and_b32 v197, s58, v158
v_mfma_f32_16x16x32_bf16 v[48:51], v[144:147], v[92:95], v[48:51]
s_add_u32 m0, s55, 69632
s_nop 0
buffer_load_dwordx4 v220, s[12:15], s50 offen offset:0 lds
s_add_u32 s50, s50, 114688
v_add_f32 v180, v180, v194
v_add_f32 v181, v181, v195
v_mfma_f32_16x16x32_bf16 v[52:55], v[144:147], v[96:99], v[52:55]
v_fmac_f32 v182, v194, v194
v_fmac_f32 v183, v195, v195
v_mfma_f32_16x16x32_bf16 v[56:59], v[144:147], v[100:103], v[56:59]
v_lshlrev_b32 v198, 16, v159
v_and_b32 v199, s58, v159
v_mfma_f32_16x16x32_bf16 v[60:63], v[144:147], v[104:107], v[60:63]
ds_read_b64_tr_b16 v[144:145], v212 offset:28672
ds_read_b64_tr_b16 v[146:147], v212 offset:29696
v_add_f32 v180, v180, v196
v_add_f32 v181, v181, v197
v_mfma_f32_16x16x32_bf16 v[64:67], v[148:151], v[92:95], v[64:67]
v_fmac_f32 v182, v196, v196
v_fmac_f32 v183, v197, v197
v_mfma_f32_16x16x32_bf16 v[68:71], v[148:151], v[96:99], v[68:71]
v_add_f32 v180, v180, v198
v_add_f32 v181, v181, v199
v_mfma_f32_16x16x32_bf16 v[72:75], v[148:151], v[100:103], v[72:75]
v_fmac_f32 v182, v198, v198
v_mfma_f32_16x16x32_bf16 v[76:79], v[148:151], v[104:107], v[76:79]
ds_read_b64_tr_b16 v[148:149], v213 offset:36864
ds_read_b64_tr_b16 v[150:151], v213 offset:37376
v_fmac_f32 v183, v199, v199
s_waitcnt lgkmcnt(8)
v_mfma_f32_16x16x32_bf16 v[0:3], v[132:135], v[108:111], v[0:3]
v_mfma_f32_16x16x32_bf16 v[4:7], v[132:135], v[112:115], v[4:7]
v_mfma_f32_16x16x32_bf16 v[8:11], v[132:135], v[116:119], v[8:11]
v_mfma_f32_16x16x32_bf16 v[12:15], v[132:135], v[120:123], v[12:15]
v_mfma_f32_16x16x32_bf16 v[80:83], v[132:135], v[152:155], v[80:83]
s_waitcnt vmcnt(11)
s_waitcnt lgkmcnt(0)
s_barrier
ds_read_b64_tr_b16 v[132:133], v208 offset:0
ds_read_b64_tr_b16 v[134:135], v208 offset:1024
v_mfma_f32_16x16x32_bf16 v[16:19], v[136:139], v[108:111], v[16:19]
ds_read_b128 v[156:159], v216 offset:16384
ds_read_b128 v[92:95], v214 offset:16384
ds_read_b128 v[96:99], v214 offset:18432
s_add_u32 m0, s55, 81920
s_nop 0
buffer_load_dwordx4 v220, s[8:11], s50 offen offset:0 lds
v_mfma_f32_16x16x32_bf16 v[20:23], v[136:139], v[112:115], v[20:23]
ds_read_b128 v[100:103], v214 offset:20480
ds_read_b128 v[104:107], v214 offset:22528
v_mfma_f32_16x16x32_bf16 v[24:27], v[136:139], v[116:119], v[24:27]
v_mfma_f32_16x16x32_bf16 v[28:31], v[136:139], v[120:123], v[28:31]
s_add_u32 m0, s55, 85888
s_nop 0
buffer_load_dwordx4 v220, s[8:11], s50 offen offset:128 lds
v_mfma_f32_16x16x32_bf16 v[84:87], v[136:139], v[152:155], v[84:87]
ds_read_b64_tr_b16 v[136:137], v208 offset:8192
ds_read_b64_tr_b16 v[138:139], v208 offset:9216
s_waitcnt lgkmcnt(6)
v_lshlrev_b32 v192, 16, v156
v_and_b32 v193, s58, v156
v_mfma_f32_16x16x32_bf16 v[32:35], v[140:143], v[108:111], v[32:35]
v_lshlrev_b32 v194, 16, v157
v_and_b32 v195, s58, v157
v_mfma_f32_16x16x32_bf16 v[36:39], v[140:143], v[112:115], v[36:39]
s_add_u32 m0, s55, 90112
s_nop 0
buffer_load_dwordx4 v220, s[12:15], s50 offen offset:0 lds
s_add_u32 s50, s50, 114688
v_add_f32 v180, v180, v192
v_add_f32 v181, v181, v193
v_mfma_f32_16x16x32_bf16 v[40:43], v[140:143], v[116:119], v[40:43]
v_fmac_f32 v182, v192, v192
v_fmac_f32 v183, v193, v193
v_mfma_f32_16x16x32_bf16 v[44:47], v[140:143], v[120:123], v[44:47]
ds_read_b64_tr_b16 v[140:141], v209 offset:0
ds_read_b64_tr_b16 v[142:143], v209 offset:1024
v_lshlrev_b32 v196, 16, v158
v_and_b32 v197, s58, v158
v_mfma_f32_16x16x32_bf16 v[48:51], v[144:147], v[108:111], v[48:51]
v_add_f32 v180, v180, v194
v_add_f32 v181, v181, v195
v_mfma_f32_16x16x32_bf16 v[52:55], v[144:147], v[112:115], v[52:55]
v_fmac_f32 v182, v194, v194
v_fmac_f32 v183, v195, v195
v_mfma_f32_16x16x32_bf16 v[56:59], v[144:147], v[116:119], v[56:59]
v_lshlrev_b32 v198, 16, v159
v_and_b32 v199, s58, v159
v_mfma_f32_16x16x32_bf16 v[60:63], v[144:147], v[120:123], v[60:63]
ds_read_b64_tr_b16 v[144:145], v209 offset:8192
ds_read_b64_tr_b16 v[146:147], v209 offset:9216
v_add_f32 v180, v180, v196
v_add_f32 v181, v181, v197
v_mfma_f32_16x16x32_bf16 v[64:67], v[148:151], v[108:111], v[64:67]
v_fmac_f32 v182, v196, v196
v_fmac_f32 v183, v197, v197
v_mfma_f32_16x16x32_bf16 v[68:71], v[148:151], v[112:115], v[68:71]
v_add_f32 v180, v180, v198
v_add_f32 v181, v181, v199
v_mfma_f32_16x16x32_bf16 v[72:75], v[148:151], v[116:119], v[72:75]
v_fmac_f32 v182, v198, v198
v_mfma_f32_16x16x32_bf16 v[76:79], v[148:151], v[120:123], v[76:79]
ds_read_b64_tr_b16 v[148:149], v210 offset:16384
ds_read_b64_tr_b16 v[150:151], v210 offset:16896
v_fmac_f32 v183, v199, v199
s_mov_b64 exec, s[70:71]
buffer_load_dword v225, v247, s[72:75], s0 offen
s_mov_b64 exec, -1
s_add_u32 s0, s0, s1
s_cmp_lg_u32 s41, 0
s_cbranch_scc1 L_tl2
v_mov_b32 v176, 0
v_mov_b32 v177, 0
v_mov_b32 v178, 0
v_mov_b32 v179, 0
s_mov_b64 exec, 1
buffer_load_dwordx2 v[176:177], off, s[24:27], 0 sc0 sc1
s_mov_b64 exec, -1
L_tl2:
s_waitcnt lgkmcnt(8)
v_mfma_f32_16x16x32_bf16 v[0:3], v[132:135], v[92:95], v[0:3]
v_mfma_f32_16x16x32_bf16 v[4:7], v[132:135], v[96:99], v[4:7]
v_mfma_f32_16x16x32_bf16 v[8:11], v[132:135], v[100:103], v[8:11]
v_mfma_f32_16x16x32_bf16 v[12:15], v[132:135], v[104:107], v[12:15]
v_mfma_f32_16x16x32_bf16 v[80:83], v[132:135], v[152:155], v[80:83]
s_waitcnt vmcnt(12)
s_waitcnt lgkmcnt(0)
s_barrier
ds_read_b64_tr_b16 v[132:133], v208 offset:20480
ds_read_b64_tr_b16 v[134:135], v208 offset:21504
v_mfma_f32_16x16x32_bf16 v[16:19], v[136:139], v[92:95], v[16:19]
ds_read_b128 v[156:159], v217 offset:16384
ds_read_b128 v[108:111], v215 offset:16384
ds_read_b128 v[112:115], v215 offset:18432
s_add_u32 m0, s56, 101760
s_nop 0
buffer_load_dwordx4 v222, s[4:7], s52 offen offset:640 lds
v_mfma_f32_16x16x32_bf16 v[20:23], v[136:139], v[96:99], v[20:23]
ds_read_b128 v[116:119], v215 offset:20480
ds_read_b128 v[120:123], v215 offset:22528
v_mfma_f32_16x16x32_bf16 v[24:27], v[136:139], v[100:103], v[24:27]
v_mfma_f32_16x16x32_bf16 v[28:31], v[136:139], v[104:107], v[28:31]
s_add_u32 m0, s55, 0
s_nop 0
buffer_load_dwordx4 v220, s[8:11], s50 offen offset:0 lds
v_mfma_f32_16x16x32_bf16 v[84:87], v[136:139], v[152:155], v[84:87]
ds_read_b64_tr_b16 v[136:137], v208 offset:28672
ds_read_b64_tr_b16 v[138:139], v208 offset:29696
s_waitcnt lgkmcnt(6)
v_lshlrev_b32 v192, 16, v156
v_and_b32 v193, s58, v156
v_mfma_f32_16x16x32_bf16 v[32:35], v[140:143], v[92:95], v[32:35]
v_lshlrev_b32 v194, 16, v157
v_and_b32 v195, s58, v157
v_mfma_f32_16x16x32_bf16 v[36:39], v[140:143], v[96:99], v[36:39]
s_add_u32 m0, s55, 3968
s_nop 0
buffer_load_dwordx4 v220, s[8:11], s50 offen offset:128 lds
v_add_f32 v180, v180, v192
v_add_f32 v181, v181, v193
v_mfma_f32_16x16x32_bf16 v[40:43], v[140:143], v[100:103], v[40:43]
v_fmac_f32 v182, v192, v192
v_fmac_f32 v183, v193, v193
v_mfma_f32_16x16x32_bf16 v[44:47], v[140:143], v[104:107], v[44:47]
ds_read_b64_tr_b16 v[140:141], v209 offset:20480
ds_read_b64_tr_b16 v[142:143], v209 offset:21504
v_lshlrev_b32 v196, 16, v158
v_and_b32 v197, s58, v158
v_mfma_f32_16x16x32_bf16 v[48:51], v[144:147], v[92:95], v[48:51]
s_add_u32 m0, s55, 8192
s_nop 0
buffer_load_dwordx4 v220, s[12:15], s50 offen offset:0 lds
s_add_u32 s50, s50, 114688
v_add_f32 v180, v180, v194
v_add_f32 v181, v181, v195
v_mfma_f32_16x16x32_bf16 v[52:55], v[144:147], v[96:99], v[52:55]
v_fmac_f32 v182, v194, v194
v_fmac_f32 v183, v195, v195
v_mfma_f32_16x16x32_bf16 v[56:59], v[144:147], v[100:103], v[56:59]
v_lshlrev_b32 v198, 16, v159
v_and_b32 v199, s58, v159
v_mfma_f32_16x16x32_bf16 v[60:63], v[144:147], v[104:107], v[60:63]
ds_read_b64_tr_b16 v[144:145], v209 offset:28672
ds_read_b64_tr_b16 v[146:147], v209 offset:29696
v_add_f32 v180, v180, v196
v_add_f32 v181, v181, v197
v_mfma_f32_16x16x32_bf16 v[64:67], v[148:151], v[92:95], v[64:67]
v_fmac_f32 v182, v196, v196
v_fmac_f32 v183, v197, v197
v_mfma_f32_16x16x32_bf16 v[68:71], v[148:151], v[96:99], v[68:71]
v_add_f32 v180, v180, v198
v_add_f32 v181, v181, v199
v_mfma_f32_16x16x32_bf16 v[72:75], v[148:151], v[100:103], v[72:75]
v_fmac_f32 v182, v198, v198
v_mfma_f32_16x16x32_bf16 v[76:79], v[148:151], v[104:107], v[76:79]
ds_read_b64_tr_b16 v[148:149], v210 offset:36864
ds_read_b64_tr_b16 v[150:151], v210 offset:37376
v_fmac_f32 v183, v199, v199
s_waitcnt lgkmcnt(8)
v_mfma_f32_16x16x32_bf16 v[0:3], v[132:135], v[108:111], v[0:3]
v_mfma_f32_16x16x32_bf16 v[4:7], v[132:135], v[112:115], v[4:7]
v_mfma_f32_16x16x32_bf16 v[8:11], v[132:135], v[116:119], v[8:11]
v_mfma_f32_16x16x32_bf16 v[12:15], v[132:135], v[120:123], v[12:15]
v_mfma_f32_16x16x32_bf16 v[80:83], v[132:135], v[152:155], v[80:83]
s_waitcnt vmcnt(11)
s_waitcnt lgkmcnt(0)
s_barrier
ds_read_b64_tr_b16 v[132:133], v208 offset:40960
ds_read_b64_tr_b16 v[134:135], v208 offset:41984
v_mfma_f32_16x16x32_bf16 v[16:19], v[136:139], v[108:111], v[16:19]
ds_read_b128 v[156:159], v216 offset:32768
ds_read_b128 v[92:95], v214 offset:32768
ds_read_b128 v[96:99], v214 offset:34816
s_add_u32 m0, s55, 20480
s_nop 0
buffer_load_dwordx4 v220, s[8:11], s50 offen offset:0 lds
v_mfma_f32_16x16x32_bf16 v[20:23], v[136:139], v[112:115], v[20:23]
ds_read_b128 v[100:103], v214 offset:36864
ds_read_b128 v[104:107], v214 offset:38912
v_mfma_f32_16x16x32_bf16 v[24:27], v[136:139], v[116:119], v[24:27]
v_mfma_f32_16x16x32_bf16 v[28:31], v[136:139], v[120:123], v[28:31]
s_add_u32 m0, s55, 24448
s_nop 0
buffer_load_dwordx4 v220, s[8:11], s50 offen offset:128 lds
v_mfma_f32_16x16x32_bf16 v[84:87], v[136:139], v[152:155], v[84:87]
ds_read_b64_tr_b16 v[136:137], v208 offset:49152
ds_read_b64_tr_b16 v[138:139], v208 offset:50176
s_waitcnt lgkmcnt(6)
v_lshlrev_b32 v192, 16, v156
v_and_b32 v193, s58, v156
v_mfma_f32_16x16x32_bf16 v[32:35], v[140:143], v[108:111], v[32:35]
v_lshlrev_b32 v194, 16, v157
v_and_b32 v195, s58, v157
v_mfma_f32_16x16x32_bf16 v[36:39], v[140:143], v[112:115], v[36:39]
s_add_u32 m0, s55, 28672
s_nop 0
buffer_load_dwordx4 v220, s[12:15], s50 offen offset:0 lds
s_add_u32 s50, s50, 114688
v_add_f32 v180, v180, v192
v_add_f32 v181, v181, v193
v_mfma_f32_16x16x32_bf16 v[40:43], v[140:143], v[116:119], v[40:43]
v_fmac_f32 v182, v192, v192
v_fmac_f32 v183, v193, v193
v_mfma_f32_16x16x32_bf16 v[44:47], v[140:143], v[120:123], v[44:47]
ds_read_b64_tr_b16 v[140:141], v209 offset:40960
ds_read_b64_tr_b16 v[142:143], v209 offset:41984
v_lshlrev_b32 v196, 16, v158
v_and_b32 v197, s58, v158
v_mfma_f32_16x16x32_bf16 v[48:51], v[144:147], v[108:111], v[48:51]
v_add_f32 v180, v180, v194
v_add_f32 v181, v181, v195
v_mfma_f32_16x16x32_bf16 v[52:55], v[144:147], v[112:115], v[52:55]
v_fmac_f32 v182, v194, v194
v_fmac_f32 v183, v195, v195
v_mfma_f32_16x16x32_bf16 v[56:59], v[144:147], v[116:119], v[56:59]
v_lshlrev_b32 v198, 16, v159
v_and_b32 v199, s58, v159
v_mfma_f32_16x16x32_bf16 v[60:63], v[144:147], v[120:123], v[60:63]
ds_read_b64_tr_b16 v[144:145], v209 offset:49152
ds_read_b64_tr_b16 v[146:147], v209 offset:50176
v_add_f32 v180, v180, v196
v_add_f32 v181, v181, v197
v_mfma_f32_16x16x32_bf16 v[64:67], v[148:151], v[108:111], v[64:67]
v_fmac_f32 v182, v196, v196
v_fmac_f32 v183, v197, v197
v_mfma_f32_16x16x32_bf16 v[68:71], v[148:151], v[112:115], v[68:71]
v_add_f32 v180, v180, v198
v_add_f32 v181, v181, v199
v_mfma_f32_16x16x32_bf16 v[72:75], v[148:151], v[116:119], v[72:75]
v_fmac_f32 v182, v198, v198
v_mfma_f32_16x16x32_bf16 v[76:79], v[148:151], v[120:123], v[76:79]
ds_read_b64_tr_b16 v[148:149], v210 offset:57344
ds_read_b64_tr_b16 v[150:151], v210 offset:57856
v_fmac_f32 v183, v199, v199
s_mov_b64 exec, s[70:71]
buffer_load_dword v225, v247, s[72:75], s0 offen
s_mov_b64 exec, -1
s_add_u32 s0, s0, s1
s_waitcnt lgkmcnt(8)
v_mfma_f32_16x16x32_bf16 v[0:3], v[132:135], v[92:95], v[0:3]
v_mfma_f32_16x16x32_bf16 v[4:7], v[132:135], v[96:99], v[4:7]
v_mfma_f32_16x16x32_bf16 v[8:11], v[132:135], v[100:103], v[8:11]
v_mfma_f32_16x16x32_bf16 v[12:15], v[132:135], v[104:107], v[12:15]
v_mfma_f32_16x16x32_bf16 v[80:83], v[132:135], v[152:155], v[80:83]
s_waitcnt vmcnt(12)
s_waitcnt lgkmcnt(0)
s_barrier
ds_read_b64_tr_b16 v[132:133], v211 offset:0
ds_read_b64_tr_b16 v[134:135], v211 offset:1024
v_mfma_f32_16x16x32_bf16 v[16:19], v[136:139], v[92:95], v[16:19]
ds_read_b128 v[156:159], v217 offset:32768
ds_read_b128 v[108:111], v215 offset:32768
ds_read_b128 v[112:115], v215 offset:34816
s_add_u32 m0, s56, 118016
s_nop 0
buffer_load_dwordx4 v222, s[4:7], s52 offen offset:768 lds
v_mfma_f32_16x16x32_bf16 v[20:23], v[136:139], v[96:99], v[20:23]
ds_read_b128 v[116:119], v215 offset:36864
ds_read_b128 v[120:123], v215 offset:38912
v_mfma_f32_16x16x32_bf16 v[24:27], v[136:139], v[100:103], v[24:27]
v_mfma_f32_16x16x32_bf16 v[28:31], v[136:139], v[104:107], v[28:31]
s_add_u32 m0, s55, 40960
s_nop 0
buffer_load_dwordx4 v220, s[8:11], s50 offen offset:0 lds
v_mfma_f32_16x16x32_bf16 v[84:87], v[136:139], v[152:155], v[84:87]
ds_read_b64_tr_b16 v[136:137], v211 offset:8192
ds_read_b64_tr_b16 v[138:139], v211 offset:9216
s_waitcnt lgkmcnt(6)
v_lshlrev_b32 v192, 16, v156
v_and_b32 v193, s58, v156
v_mfma_f32_16x16x32_bf16 v[32:35], v[140:143], v[92:95], v[32:35]
v_lshlrev_b32 v194, 16, v157
v_and_b32 v195, s58, v157
v_mfma_f32_16x16x32_bf16 v[36:39], v[140:143], v[96:99], v[36:39]
s_add_u32 m0, s55, 44928
s_nop 0
buffer_load_dwordx4 v220, s[8:11], s50 offen offset:128 lds
v_add_f32 v180, v180, v192
v_add_f32 v181, v181, v193
v_mfma_f32_16x16x32_bf16 v[40:43], v[140:143], v[100:103], v[40:43]
v_fmac_f32 v182, v192, v192
v_fmac_f32 v183, v193, v193
v_mfma_f32_16x16x32_bf16 v[44:47], v[140:143], v[104:107], v[44:47]
ds_read_b64_tr_b16 v[140:141], v212 offset:0
ds_read_b64_tr_b16 v[142:143], v212 offset:1024
v_lshlrev_b32 v196, 16, v158
v_and_b32 v197, s58, v158
v_mfma_f32_16x16x32_bf16 v[48:51], v[144:147], v[92:95], v[48:51]
s_add_u32 m0, s55, 49152
s_nop 0
buffer_load_dwordx4 v220, s[12:15], s50 offen offset:0 lds
s_add_u32 s50, s50, 114688
v_add_f32 v180, v180, v194
v_add_f32 v181, v181, v195
v_mfma_f32_16x16x32_bf16 v[52:55], v[144:147], v[96:99], v[52:55]
v_fmac_f32 v182, v194, v194
v_fmac_f32 v183, v195, v195
v_mfma_f32_16x16x32_bf16 v[56:59], v[144:147], v[100:103], v[56:59]
v_lshlrev_b32 v198, 16, v159
v_and_b32 v199, s58, v159
v_mfma_f32_16x16x32_bf16 v[60:63], v[144:147], v[104:107], v[60:63]
ds_read_b64_tr_b16 v[144:145], v212 offset:8192
ds_read_b64_tr_b16 v[146:147], v212 offset:9216
v_add_f32 v180, v180, v196
v_add_f32 v181, v181, v197
v_mfma_f32_16x16x32_bf16 v[64:67], v[148:151], v[92:95], v[64:67]
v_fmac_f32 v182, v196, v196
v_fmac_f32 v183, v197, v197
v_mfma_f32_16x16x32_bf16 v[68:71], v[148:151], v[96:99], v[68:71]
v_add_f32 v180, v180, v198
v_add_f32 v181, v181, v199
v_mfma_f32_16x16x32_bf16 v[72:75], v[148:151], v[100:103], v[72:75]
v_fmac_f32 v182, v198, v198
v_mfma_f32_16x16x32_bf16 v[76:79], v[148:151], v[104:107], v[76:79]
ds_read_b64_tr_b16 v[148:149], v213 offset:16384
ds_read_b64_tr_b16 v[150:151], v213 offset:16896
v_fmac_f32 v183, v199, v199
s_waitcnt lgkmcnt(8)
v_mfma_f32_16x16x32_bf16 v[0:3], v[132:135], v[108:111], v[0:3]
v_mfma_f32_16x16x32_bf16 v[4:7], v[132:135], v[112:115], v[4:7]
v_mfma_f32_16x16x32_bf16 v[8:11], v[132:135], v[116:119], v[8:11]
v_mfma_f32_16x16x32_bf16 v[12:15], v[132:135], v[120:123], v[12:15]
v_mfma_f32_16x16x32_bf16 v[80:83], v[132:135], v[152:155], v[80:83]
s_waitcnt vmcnt(11)
s_waitcnt lgkmcnt(0)
s_barrier
ds_read_b64_tr_b16 v[132:133], v211 offset:20480
ds_read_b64_tr_b16 v[134:135], v211 offset:21504
v_mfma_f32_16x16x32_bf16 v[16:19], v[136:139], v[108:111], v[16:19]
ds_read_b128 v[156:159], v216 offset:0
ds_read_b128 v[92:95], v214 offset:0
ds_read_b128 v[96:99], v214 offset:2048
s_add_u32 m0, s55, 61440
s_nop 0
buffer_load_dwordx4 v220, s[8:11], s50 offen offset:0 lds
v_mfma_f32_16x16x32_bf16 v[20:23], v[136:139], v[112:115], v[20:23]
ds_read_b128 v[100:103], v214 offset:4096
ds_read_b128 v[104:107], v214 offset:6144
v_mfma_f32_16x16x32_bf16 v[24:27], v[136:139], v[116:119], v[24:27]
v_mfma_f32_16x16x32_bf16 v[28:31], v[136:139], v[120:123], v[28:31]
s_add_u32 m0, s55, 65408
s_nop 0
buffer_load_dwordx4 v220, s[8:11], s50 offen offset:128 lds
v_mfma_f32_16x16x32_bf16 v[84:87], v[136:139], v[152:155], v[84:87]
ds_read_b64_tr_b16 v[136:137], v211 offset:28672
ds_read_b64_tr_b16 v[138:139], v211 offset:29696
s_waitcnt lgkmcnt(6)
v_lshlrev_b32 v192, 16, v156
v_and_b32 v193, s58, v156
v_mfma_f32_16x16x32_bf16 v[32:35], v[140:143], v[108:111], v[32:35]
v_lshlrev_b32 v194, 16, v157
v_and_b32 v195, s58, v157
v_mfma_f32_16x16x32_bf16 v[36:39], v[140:143], v[112:115], v[36:39]
s_add_u32 m0, s55, 69632
s_nop 0
buffer_load_dwordx4 v220, s[12:15], s50 offen offset:0 lds
s_add_u32 s50, s50, 114688
v_add_f32 v180, v180, v192
v_add_f32 v181, v181, v193
v_mfma_f32_16x16x32_bf16 v[40:43], v[140:143], v[116:119], v[40:43]
v_fmac_f32 v182, v192, v192
v_fmac_f32 v183, v193, v193
v_mfma_f32_16x16x32_bf16 v[44:47], v[140:143], v[120:123], v[44:47]
ds_read_b64_tr_b16 v[140:141], v212 offset:20480
ds_read_b64_tr_b16 v[142:143], v212 offset:21504
v_lshlrev_b32 v196, 16, v158
v_and_b32 v197, s58, v158
v_mfma_f32_16x16x32_bf16 v[48:51], v[144:147], v[108:111], v[48:51]
v_add_f32 v180, v180, v194
v_add_f32 v181, v181, v195
v_mfma_f32_16x16x32_bf16 v[52:55], v[144:147], v[112:115], v[52:55]
v_fmac_f32 v182, v194, v194
v_fmac_f32 v183, v195, v195
v_mfma_f32_16x16x32_bf16 v[56:59], v[144:147], v[116:119], v[56:59]
v_lshlrev_b32 v198, 16, v159
v_and_b32 v199, s58, v159
v_mfma_f32_16x16x32_bf16 v[60:63], v[144:147], v[120:123], v[60:63]
ds_read_b64_tr_b16 v[144:145], v212 offset:28672
ds_read_b64_tr_b16 v[146:147], v212 offset:29696
v_add_f32 v180, v180, v196
v_add_f32 v181, v181, v197
v_mfma_f32_16x16x32_bf16 v[64:67], v[148:151], v[108:111], v[64:67]
v_fmac_f32 v182, v196, v196
v_fmac_f32 v183, v197, v197
v_mfma_f32_16x16x32_bf16 v[68:71], v[148:151], v[112:115], v[68:71]
v_add_f32 v180, v180, v198
v_add_f32 v181, v181, v199
v_mfma_f32_16x16x32_bf16 v[72:75], v[148:151], v[116:119], v[72:75]
v_fmac_f32 v182, v198, v198
v_mfma_f32_16x16x32_bf16 v[76:79], v[148:151], v[120:123], v[76:79]
ds_read_b64_tr_b16 v[148:149], v213 offset:36864
ds_read_b64_tr_b16 v[150:151], v213 offset:37376
v_fmac_f32 v183, v199, v199
s_mov_b32 exec_lo, 0xffff
s_mov_b32 exec_hi, 0x0
buffer_load_dword v225, v226, s[32:35], 0 offen
s_mov_b64 exec, -1
s_mov_b64 exec, 0xffff
buffer_load_dword v225, v227, s[28:31], 0 offen
s_mov_b64 exec, -1
s_waitcnt lgkmcnt(8)
v_mfma_f32_16x16x32_bf16 v[0:3], v[132:135], v[92:95], v[0:3]
v_mfma_f32_16x16x32_bf16 v[4:7], v[132:135], v[96:99], v[4:7]
v_mfma_f32_16x16x32_bf16 v[8:11], v[132:135], v[100:103], v[8:11]
v_mfma_f32_16x16x32_bf16 v[12:15], v[132:135], v[104:107], v[12:15]
v_mfma_f32_16x16x32_bf16 v[80:83], v[132:135], v[152:155], v[80:83]
s_waitcnt vmcnt(13)
s_waitcnt lgkmcnt(0)
s_barrier
ds_read_b64_tr_b16 v[132:133], v208 offset:0
ds_read_b64_tr_b16 v[134:135], v208 offset:1024
v_mfma_f32_16x16x32_bf16 v[16:19], v[136:139], v[92:95], v[16:19]
ds_read_b128 v[156:159], v217 offset:0
ds_read_b128 v[108:111], v215 offset:0
ds_read_b128 v[112:115], v215 offset:2048
s_add_u32 m0, s56, 134272
s_nop 0
buffer_load_dwordx4 v222, s[4:7], s52 offen offset:896 lds
v_mfma_f32_16x16x32_bf16 v[20:23], v[136:139], v[96:99], v[20:23]
ds_read_b128 v[116:119], v215 offset:4096
ds_read_b128 v[120:123], v215 offset:6144
v_mfma_f32_16x16x32_bf16 v[24:27], v[136:139], v[100:103], v[24:27]
v_mfma_f32_16x16x32_bf16 v[28:31], v[136:139], v[104:107], v[28:31]
s_add_u32 m0, s55, 81920
s_nop 0
buffer_load_dwordx4 v220, s[8:11], s50 offen offset:0 lds
v_mfma_f32_16x16x32_bf16 v[84:87], v[136:139], v[152:155], v[84:87]
ds_read_b64_tr_b16 v[136:137], v208 offset:8192
ds_read_b64_tr_b16 v[138:139], v208 offset:9216
s_waitcnt lgkmcnt(6)
v_lshlrev_b32 v192, 16, v156
v_and_b32 v193, s58, v156
v_mfma_f32_16x16x32_bf16 v[32:35], v[140:143], v[92:95], v[32:35]
v_lshlrev_b32 v194, 16, v157
v_and_b32 v195, s58, v157
v_mfma_f32_16x16x32_bf16 v[36:39], v[140:143], v[96:99], v[36:39]
s_add_u32 m0, s55, 85888
s_nop 0
buffer_load_dwordx4 v220, s[8:11], s50 offen offset:128 lds
v_add_f32 v180, v180, v192
v_add_f32 v181, v181, v193
v_mfma_f32_16x16x32_bf16 v[40:43], v[140:143], v[100:103], v[40:43]
v_fmac_f32 v182, v192, v192
v_fmac_f32 v183, v193, v193
v_mfma_f32_16x16x32_bf16 v[44:47], v[140:143], v[104:107], v[44:47]
ds_read_b64_tr_b16 v[140:141], v209 offset:0
ds_read_b64_tr_b16 v[142:143], v209 offset:1024
v_lshlrev_b32 v196, 16, v158
v_and_b32 v197, s58, v158
v_mfma_f32_16x16x32_bf16 v[48:51], v[144:147], v[92:95], v[48:51]
s_add_u32 m0, s55, 90112
s_nop 0
buffer_load_dwordx4 v220, s[12:15], s50 offen offset:0 lds
s_add_u32 s50, s50, 114688
v_add_f32 v180, v180, v194
v_add_f32 v181, v181, v195
v_mfma_f32_16x16x32_bf16 v[52:55], v[144:147], v[96:99], v[52:55]
v_fmac_f32 v182, v194, v194
v_fmac_f32 v183, v195, v195
v_mfma_f32_16x16x32_bf16 v[56:59], v[144:147], v[100:103], v[56:59]
v_lshlrev_b32 v198, 16, v159
v_and_b32 v199, s58, v159
v_mfma_f32_16x16x32_bf16 v[60:63], v[144:147], v[104:107], v[60:63]
ds_read_b64_tr_b16 v[144:145], v209 offset:8192
ds_read_b64_tr_b16 v[146:147], v209 offset:9216
v_add_f32 v180, v180, v196
v_add_f32 v181, v181, v197
v_mfma_f32_16x16x32_bf16 v[64:67], v[148:151], v[92:95], v[64:67]
v_fmac_f32 v182, v196, v196
v_fmac_f32 v183, v197, v197
v_mfma_f32_16x16x32_bf16 v[68:71], v[148:151], v[96:99], v[68:71]
v_add_f32 v180, v180, v198
v_add_f32 v181, v181, v199
v_mfma_f32_16x16x32_bf16 v[72:75], v[148:151], v[100:103], v[72:75]
v_fmac_f32 v182, v198, v198
v_mfma_f32_16x16x32_bf16 v[76:79], v[148:151], v[104:107], v[76:79]
ds_read_b64_tr_b16 v[148:149], v210 offset:16384
ds_read_b64_tr_b16 v[150:151], v210 offset:16896
v_fmac_f32 v183, v199, v199
s_cmp_lg_u32 s41, 0
s_cbranch_scc1 L_tw2
s_mov_b64 exec, 1
s_mov_b32 s46, 200000
s_waitcnt vmcnt(12)
L_ts2:
v_readfirstlane_b32 s45, v176
s_sub_u32 s46, s46, 1
s_cmp_lt_i32 s46, 0
s_cselect_b32 s45, 1, s45
s_cmp_lg_u32 s45, 0
s_cbranch_scc1 L_tx2
buffer_load_dwordx2 v[176:177], off, s[24:27], 0 sc0 sc1
s_waitcnt vmcnt(0)
s_branch L_ts2
L_tx2:
ds_write_b128 v174, v[176:179]
s_mov_b64 exec, -1
L_tw2:
s_waitcnt lgkmcnt(8)
v_mfma_f32_16x16x32_bf16 v[0:3], v[132:135], v[108:111], v[0:3]
v_add_u32 v248, 102400, v169
v_add_u32 v249, 102400, v170
v_mfma_f32_16x16x32_bf16 v[4:7], v[132:135], v[112:115], v[4:7]
v_add_u32 v250, 102400, v171
v_add_u32 v251, 102400, v172
v_mfma_f32_16x16x32_bf16 v[8:11], v[132:135], v[116:119], v[8:11]
s_lshr_b32 s46, s40, 1
s_lshl_b32 s67, s59, 16
v_mfma_f32_16x16x32_bf16 v[12:15], v[132:135], v[120:123], v[12:15]
s_lshl_b32 s45, s46, 14
s_add_u32 s67, s67, s45
v_mfma_f32_16x16x32_bf16 v[80:83], v[132:135], v[152:155], v[80:83]
s_waitcnt vmcnt(12)
s_waitcnt lgkmcnt(0)
s_barrier
ds_read_b64_tr_b16 v[132:133], v208 offset:20480
ds_read_b64_tr_b16 v[134:135], v208 offset:21504
s_lshl_b32 s45, s62, 7
s_add_u32 s67, s67, s45
v_mfma_f32_16x16x32_bf16 v[16:19], v[136:139], v[108:111], v[16:19]
ds_read_b128 v[156:159], v216 offset:16384
ds_read_b128 v[92:95], v214 offset:16384
ds_read_b128 v[96:99], v214 offset:18432
s_and_b32 s45, s40, 1
s_lshl_b32 s45, s45, 6
v_mfma_f32_16x16x32_bf16 v[20:23], v[136:139], v[112:115], v[20:23]
ds_read_b128 v[100:103], v214 offset:20480
ds_read_b128 v[104:107], v214 offset:22528
s_add_u32 s67, s67, s45
s_lshl_b32 s45, s59, 11
v_mfma_f32_16x16x32_bf16 v[24:27], v[136:139], v[116:119], v[24:27]
s_lshl_b32 s82, s46, 6
s_add_u32 s82, s82, s45
v_mfma_f32_16x16x32_bf16 v[28:31], v[136:139], v[120:123], v[28:31]
s_lshl_b32 s45, s101, 8
s_add_u32 s82, s82, s45
v_mfma_f32_16x16x32_bf16 v[84:87], v[136:139], v[152:155], v[84:87]
ds_read_b64_tr_b16 v[136:137], v208 offset:28672
ds_read_b64_tr_b16 v[138:139], v208 offset:29696
s_waitcnt lgkmcnt(6)
v_lshlrev_b32 v192, 16, v156
v_and_b32 v193, s58, v156
s_add_u32 s82, s82, 9535488
s_lshl_b32 s79, s43, 1
v_mfma_f32_16x16x32_bf16 v[32:35], v[140:143], v[108:111], v[32:35]
v_lshlrev_b32 v194, 16, v157
v_and_b32 v195, s58, v157
s_add_u32 s79, s79, s42
s_mul_i32 s45, s79, 294912
v_mfma_f32_16x16x32_bf16 v[36:39], v[140:143], v[112:115], v[36:39]
v_add_f32 v180, v180, v192
v_add_f32 v181, v181, v193
s_mul_i32 s47, s44, 5
s_and_b32 s48, s44, 1
v_mfma_f32_16x16x32_bf16 v[40:43], v[140:143], v[116:119], v[40:43]
v_fmac_f32 v182, v192, v192
v_fmac_f32 v183, v193, v193
s_add_u32 s50, s47, s48
s_add_u32 s50, s50, s41
v_mfma_f32_16x16x32_bf16 v[44:47], v[140:143], v[120:123], v[44:47]
ds_read_b64_tr_b16 v[140:141], v209 offset:20480
ds_read_b64_tr_b16 v[142:143], v209 offset:21504
v_lshlrev_b32 v196, 16, v158
v_and_b32 v197, s58, v158
s_lshl_b32 s50, s50, 10
s_add_u32 s45, s45, 32768
v_mfma_f32_16x16x32_bf16 v[48:51], v[144:147], v[108:111], v[48:51]
v_add_f32 v180, v180, v194
v_add_f32 v181, v181, v195
s_add_u32 s50, s50, s45
s_add_u32 s51, s50, 73728
v_mfma_f32_16x16x32_bf16 v[52:55], v[144:147], v[112:115], v[52:55]
v_fmac_f32 v182, v194, v194
v_fmac_f32 v183, v195, v195
s_add_u32 s52, s50, 147456
s_add_u32 s53, s50, 221184
v_mfma_f32_16x16x32_bf16 v[56:59], v[144:147], v[116:119], v[56:59]
v_lshlrev_b32 v198, 16, v159
v_and_b32 v199, s58, v159
s_cmp_eq_u32 s48, 0
s_cselect_b32 s48, 4, 0
s_add_u32 s47, s47, s48
v_mfma_f32_16x16x32_bf16 v[60:63], v[144:147], v[120:123], v[60:63]
ds_read_b64_tr_b16 v[144:145], v209 offset:28672
ds_read_b64_tr_b16 v[146:147], v209 offset:29696
v_add_f32 v180, v180, v196
v_add_f32 v181, v181, v197
s_lshl_b32 s47, s47, 10
s_add_u32 s47, s47, s45
v_mfma_f32_16x16x32_bf16 v[64:67], v[148:151], v[108:111], v[64:67]
v_fmac_f32 v182, v196, v196
v_fmac_f32 v183, v197, v197
s_lshl_b32 s48, s41, 8
s_add_u32 s54, s47, s48
v_mfma_f32_16x16x32_bf16 v[68:71], v[148:151], v[112:115], v[68:71]
v_add_f32 v180, v180, v198
v_add_f32 v181, v181, v199
s_lshl_b32 s55, s79, 10
s_lshl_b32 s48, s44, 7
v_mfma_f32_16x16x32_bf16 v[72:75], v[148:151], v[116:119], v[72:75]
v_fmac_f32 v182, v198, v198
s_add_u32 s55, s55, s48
s_lshl_b32 s80, s55, 1
v_mfma_f32_16x16x32_bf16 v[76:79], v[148:151], v[120:123], v[76:79]
ds_read_b64_tr_b16 v[148:149], v210 offset:36864
ds_read_b64_tr_b16 v[150:151], v210 offset:37376
v_fmac_f32 v183, v199, v199
s_lshl_b32 s48, s41, 6
s_add_u32 s80, s80, s48
s_mov_b32 exec_lo, 0xffff0000
s_mov_b32 exec_hi, 0xffffff
buffer_load_dword v225, v226, s[32:35], 0 offen
s_mov_b64 exec, -1
s_waitcnt lgkmcnt(8)
v_mfma_f32_16x16x32_bf16 v[0:3], v[132:135], v[92:95], v[0:3]
s_add_u32 s80, s80, 9535488
v_mfma_f32_16x16x32_bf16 v[4:7], v[132:135], v[96:99], v[4:7]
s_lshl_b32 s48, s41, 4
v_mfma_f32_16x16x32_bf16 v[8:11], v[132:135], v[100:103], v[8:11]
s_add_u32 s55, s55, s48
v_mfma_f32_16x16x32_bf16 v[12:15], v[132:135], v[104:107], v[12:15]
s_add_u32 s55, s55, 9437184
v_mfma_f32_16x16x32_bf16 v[80:83], v[132:135], v[152:155], v[80:83]
s_waitcnt vmcnt(10)
s_waitcnt lgkmcnt(0)
s_barrier
ds_read_b64_tr_b16 v[132:133], v208 offset:40960
ds_read_b64_tr_b16 v[134:135], v208 offset:41984
s_lshl_b32 s57, s59, 10
v_mfma_f32_16x16x32_bf16 v[16:19], v[136:139], v[92:95], v[16:19]
ds_read_b128 v[156:159], v217 offset:16384
ds_read_b128 v[108:111], v215 offset:16384
ds_read_b128 v[112:115], v215 offset:18432
s_add_u32 m0, s63, 0
s_add_u32 s49, s3, 0
buffer_load_dwordx4 v168, s[32:35], s49 offen lds
s_lshl_b32 s48, s101, 7
v_mfma_f32_16x16x32_bf16 v[20:23], v[136:139], v[96:99], v[20:23]
ds_read_b128 v[116:119], v215 offset:20480
ds_read_b128 v[120:123], v215 offset:22528
s_add_u32 s57, s57, s48
v_mfma_f32_16x16x32_bf16 v[24:27], v[136:139], v[100:103], v[24:27]
s_add_u32 s57, s57, 9437184
v_mfma_f32_16x16x32_bf16 v[28:31], v[136:139], v[104:107], v[28:31]
s_add_u32 m0, s63, 1024
s_add_u32 s49, s3, 4096
buffer_load_dwordx4 v168, s[32:35], s49 offen lds
s_lshl_b32 s66, s59, 9
v_mfma_f32_16x16x32_bf16 v[84:87], v[136:139], v[152:155], v[84:87]
ds_read_b64_tr_b16 v[136:137], v208 offset:49152
ds_read_b64_tr_b16 v[138:139], v208 offset:50176
s_waitcnt lgkmcnt(6)
v_lshlrev_b32 v192, 16, v156
v_and_b32 v193, s58, v156
s_lshl_b32 s48, s41, 7
v_mfma_f32_16x16x32_bf16 v[32:35], v[140:143], v[92:95], v[32:35]
v_lshlrev_b32 v194, 16, v157
v_and_b32 v195, s58, v157
s_add_u32 s66, s66, s48
v_mfma_f32_16x16x32_bf16 v[36:39], v[140:143], v[96:99], v[36:39]
s_add_u32 m0, s63, 2048
s_add_u32 s49, s3, 16384
buffer_load_dwordx4 v168, s[32:35], s49 offen lds
v_add_f32 v180, v180, v192
v_add_f32 v181, v181, v193
s_add_u32 s66, s66, 9469952
v_mfma_f32_16x16x32_bf16 v[40:43], v[140:143], v[100:103], v[40:43]
v_fmac_f32 v182, v192, v192
v_fmac_f32 v183, v193, v193
s_lshl_b32 s48, s101, 16
v_mfma_f32_16x16x32_bf16 v[44:47], v[140:143], v[104:107], v[44:47]
ds_read_b64_tr_b16 v[140:141], v209 offset:40960
ds_read_b64_tr_b16 v[142:143], v209 offset:41984
v_lshlrev_b32 v196, 16, v158
v_and_b32 v197, s58, v158
s_lshl_b32 s68, s62, 7
v_mfma_f32_16x16x32_bf16 v[48:51], v[144:147], v[92:95], v[48:51]
s_add_u32 m0, s63, 3072
s_add_u32 s49, s3, 20480
buffer_load_dwordx4 v168, s[32:35], s49 offen lds
v_add_f32 v180, v180, v194
v_add_f32 v181, v181, v195
s_add_u32 s68, s68, s48
v_mfma_f32_16x16x32_bf16 v[52:55], v[144:147], v[96:99], v[52:55]
v_fmac_f32 v182, v194, v194
v_fmac_f32 v183, v195, v195
s_lshl_b32 s69, s41, 14
v_mfma_f32_16x16x32_bf16 v[56:59], v[144:147], v[100:103], v[56:59]
v_lshlrev_b32 v198, 16, v159
v_and_b32 v199, s58, v159
s_add_u32 s69, s69, 32768
v_mfma_f32_16x16x32_bf16 v[60:63], v[144:147], v[104:107], v[60:63]
ds_read_b64_tr_b16 v[144:145], v209 offset:49152
ds_read_b64_tr_b16 v[146:147], v209 offset:50176
v_add_f32 v180, v180, v196
v_add_f32 v181, v181, v197
s_sub_u32 s69, s69, s63
v_mfma_f32_16x16x32_bf16 v[64:67], v[148:151], v[92:95], v[64:67]
v_fmac_f32 v182, v196, v196
v_fmac_f32 v183, v197, v197
s_mov_b32 s74, 200000
v_mfma_f32_16x16x32_bf16 v[68:71], v[148:151], v[96:99], v[68:71]
v_add_f32 v180, v180, v198
v_add_f32 v181, v181, v199
s_lshl_b32 s75, s59, 2
v_mfma_f32_16x16x32_bf16 v[72:75], v[148:151], v[100:103], v[72:75]
v_fmac_f32 v182, v198, v198
s_mul_i32 s76, s101, 5120
v_mfma_f32_16x16x32_bf16 v[76:79], v[148:151], v[104:107], v[76:79]
ds_read_b64_tr_b16 v[148:149], v210 offset:57344
ds_read_b64_tr_b16 v[150:151], v210 offset:57856
v_fmac_f32 v183, v199, v199
s_add_u32 s76, s76, 32768
s_waitcnt lgkmcnt(8)
v_mfma_f32_16x16x32_bf16 v[0:3], v[132:135], v[108:111], v[0:3]
s_lshl_b32 s77, s101, 11
v_mfma_f32_16x16x32_bf16 v[4:7], v[132:135], v[112:115], v[4:7]
s_add_u32 s77, s77, 16384
v_mfma_f32_16x16x32_bf16 v[8:11], v[132:135], v[116:119], v[8:11]
s_lshl_b32 s78, s41, 12
v_mfma_f32_16x16x32_bf16 v[12:15], v[132:135], v[120:123], v[12:15]
s_xor_b32 s48, s46, 0
v_mfma_f32_16x16x32_bf16 v[80:83], v[132:135], v[152:155], v[80:83]
s_waitcnt vmcnt(8)
s_waitcnt lgkmcnt(0)
s_barrier
ds_read_b64_tr_b16 v[132:133], v211 offset:0
ds_read_b64_tr_b16 v[134:135], v211 offset:1024
s_add_u32 s48, s48, s75
v_mfma_f32_16x16x32_bf16 v[16:19], v[136:139], v[108:111], v[16:19]
ds_read_b128 v[156:159], v216 offset:32768
ds_read_b128 v[92:95], v214 offset:32768
ds_read_b128 v[96:99], v214 offset:34816
s_add_u32 m0, s63, 102400
s_add_u32 s49, s3, 32768
buffer_load_dwordx4 v168, s[32:35], s49 offen lds
s_mul_i32 s48, s48, 73728
v_mfma_f32_16x16x32_bf16 v[20:23], v[136:139], v[112:115], v[20:23]
ds_read_b128 v[100:103], v214 offset:36864
ds_read_b128 v[104:107], v214 offset:38912
s_add_u32 s8, s48, s76
v_mfma_f32_16x16x32_bf16 v[24:27], v[136:139], v[116:119], v[24:27]
s_add_u32 s12, s8, 4096
v_mfma_f32_16x16x32_bf16 v[28:31], v[136:139], v[120:123], v[28:31]
s_add_u32 m0, s63, 103424
s_add_u32 s49, s3, 36864
buffer_load_dwordx4 v168, s[32:35], s49 offen lds
s_add_u32 s16, s48, s77
v_mfma_f32_16x16x32_bf16 v[84:87], v[136:139], v[152:155], v[84:87]
ds_read_b64_tr_b16 v[136:137], v211 offset:8192
ds_read_b64_tr_b16 v[138:139], v211 offset:9216
s_waitcnt lgkmcnt(6)
v_lshlrev_b32 v192, 16, v156
v_and_b32 v193, s58, v156
s_add_u32 s70, s48, s78
v_mfma_f32_16x16x32_bf16 v[32:35], v[140:143], v[108:111], v[32:35]
v_lshlrev_b32 v194, 16, v157
v_and_b32 v195, s58, v157
s_xor_b32 s48, s46, 1
v_mfma_f32_16x16x32_bf16 v[36:39], v[140:143], v[112:115], v[36:39]
s_add_u32 m0, s63, 104448
s_add_u32 s49, s3, 49152
buffer_load_dwordx4 v168, s[32:35], s49 offen lds
v_add_f32 v180, v180, v192
v_add_f32 v181, v181, v193
s_add_u32 s48, s48, s75
v_mfma_f32_16x16x32_bf16 v[40:43], v[140:143], v[116:119], v[40:43]
v_fmac_f32 v182, v192, v192
v_fmac_f32 v183, v193, v193
s_mul_i32 s48, s48, 73728
v_mfma_f32_16x16x32_bf16 v[44:47], v[140:143], v[120:123], v[44:47]
ds_read_b64_tr_b16 v[140:141], v212 offset:0
ds_read_b64_tr_b16 v[142:143], v212 offset:1024
v_lshlrev_b32 v196, 16, v158
v_and_b32 v197, s58, v158
s_add_u32 s9, s48, s76
v_mfma_f32_16x16x32_bf16 v[48:51], v[144:147], v[108:111], v[48:51]
s_add_u32 m0, s63, 105472
s_add_u32 s49, s3, 53248
buffer_load_dwordx4 v168, s[32:35], s49 offen lds
v_add_f32 v180, v180, v194
v_add_f32 v181, v181, v195
s_add_u32 s13, s9, 4096
v_mfma_f32_16x16x32_bf16 v[52:55], v[144:147], v[112:115], v[52:55]
v_fmac_f32 v182, v194, v194
v_fmac_f32 v183, v195, v195
s_add_u32 s17, s48, s77
v_mfma_f32_16x16x32_bf16 v[56:59], v[144:147], v[116:119], v[56:59]
v_lshlrev_b32 v198, 16, v159
v_and_b32 v199, s58, v159
s_add_u32 s71, s48, s78
v_mfma_f32_16x16x32_bf16 v[60:63], v[144:147], v[120:123], v[60:63]
ds_read_b64_tr_b16 v[144:145], v212 offset:8192
ds_read_b64_tr_b16 v[146:147], v212 offset:9216
v_add_f32 v180, v180, v196
v_add_f32 v181, v181, v197
s_xor_b32 s48, s46, 2
v_mfma_f32_16x16x32_bf16 v[64:67], v[148:151], v[108:111], v[64:67]
v_fmac_f32 v182, v196, v196
v_fmac_f32 v183, v197, v197
s_add_u32 s48, s48, s75
v_mfma_f32_16x16x32_bf16 v[68:71], v[148:151], v[112:115], v[68:71]
v_add_f32 v180, v180, v198
v_add_f32 v181, v181, v199
s_mul_i32 s48, s48, 73728
v_mfma_f32_16x16x32_bf16 v[72:75], v[148:151], v[116:119], v[72:75]
v_fmac_f32 v182, v198, v198
s_add_u32 s10, s48, s76
v_mfma_f32_16x16x32_bf16 v[76:79], v[148:151], v[120:123], v[76:79]
ds_read_b64_tr_b16 v[148:149], v213 offset:16384
ds_read_b64_tr_b16 v[150:151], v213 offset:16896
v_fmac_f32 v183, v199, v199
s_add_u32 s14, s10, 4096
s_waitcnt lgkmcnt(8)
v_mfma_f32_16x16x32_bf16 v[0:3], v[132:135], v[92:95], v[0:3]
s_add_u32 s18, s48, s77
v_mfma_f32_16x16x32_bf16 v[4:7], v[132:135], v[96:99], v[4:7]
s_add_u32 s72, s48, s78
v_mfma_f32_16x16x32_bf16 v[8:11], v[132:135], v[100:103], v[8:11]
s_xor_b32 s48, s46, 3
v_mfma_f32_16x16x32_bf16 v[12:15], v[132:135], v[104:107], v[12:15]
s_add_u32 s48, s48, s75
v_mfma_f32_16x16x32_bf16 v[80:83], v[132:135], v[152:155], v[80:83]
s_waitcnt vmcnt(9)
s_waitcnt lgkmcnt(0)
s_barrier
ds_read_b64_tr_b16 v[132:133], v211 offset:20480
ds_read_b64_tr_b16 v[134:135], v211 offset:21504
s_mul_i32 s48, s48, 73728
v_mfma_f32_16x16x32_bf16 v[16:19], v[136:139], v[92:95], v[16:19]
ds_read_b128 v[156:159], v217 offset:32768
ds_read_b128 v[108:111], v215 offset:32768
ds_read_b128 v[112:115], v215 offset:34816
s_add_u32 m0, s63, 32768
s_add_u32 s49, s100, 0
buffer_load_dwordx4 v168, s[28:31], s49 offen lds
s_add_u32 s11, s48, s76
v_mfma_f32_16x16x32_bf16 v[20:23], v[136:139], v[96:99], v[20:23]
ds_read_b128 v[116:119], v215 offset:36864
ds_read_b128 v[120:123], v215 offset:38912
s_add_u32 s15, s11, 4096
v_mfma_f32_16x16x32_bf16 v[24:27], v[136:139], v[100:103], v[24:27]
s_add_u32 s19, s48, s77
v_mfma_f32_16x16x32_bf16 v[28:31], v[136:139], v[104:107], v[28:31]
s_add_u32 m0, s63, 33792
s_add_u32 s49, s100, 4096
buffer_load_dwordx4 v168, s[28:31], s49 offen lds
s_add_u32 s73, s48, s78
v_mfma_f32_16x16x32_bf16 v[84:87], v[136:139], v[152:155], v[84:87]
ds_read_b64_tr_b16 v[136:137], v211 offset:28672
ds_read_b64_tr_b16 v[138:139], v211 offset:29696
s_waitcnt lgkmcnt(6)
v_lshlrev_b32 v192, 16, v156
v_and_b32 v193, s58, v156
v_mfma_f32_16x16x32_bf16 v[32:35], v[140:143], v[92:95], v[32:35]
v_lshlrev_b32 v194, 16, v157
v_and_b32 v195, s58, v157
v_mfma_f32_16x16x32_bf16 v[36:39], v[140:143], v[96:99], v[36:39]
s_add_u32 m0, s63, 34816
s_add_u32 s49, s100, 16384
buffer_load_dwordx4 v168, s[28:31], s49 offen lds
v_add_f32 v180, v180, v192
v_add_f32 v181, v181, v193
v_mfma_f32_16x16x32_bf16 v[40:43], v[140:143], v[100:103], v[40:43]
v_fmac_f32 v182, v192, v192
v_fmac_f32 v183, v193, v193
v_mfma_f32_16x16x32_bf16 v[44:47], v[140:143], v[104:107], v[44:47]
ds_read_b64_tr_b16 v[140:141], v212 offset:20480
ds_read_b64_tr_b16 v[142:143], v212 offset:21504
v_lshlrev_b32 v196, 16, v158
v_and_b32 v197, s58, v158
v_mfma_f32_16x16x32_bf16 v[48:51], v[144:147], v[92:95], v[48:51]
s_add_u32 m0, s63, 35840
s_add_u32 s49, s100, 20480
buffer_load_dwordx4 v168, s[28:31], s49 offen lds
v_add_f32 v180, v180, v194
v_add_f32 v181, v181, v195
v_mfma_f32_16x16x32_bf16 v[52:55], v[144:147], v[96:99], v[52:55]
v_fmac_f32 v182, v194, v194
v_fmac_f32 v183, v195, v195
v_mfma_f32_16x16x32_bf16 v[56:59], v[144:147], v[100:103], v[56:59]
v_lshlrev_b32 v198, 16, v159
v_and_b32 v199, s58, v159
v_mfma_f32_16x16x32_bf16 v[60:63], v[144:147], v[104:107], v[60:63]
ds_read_b64_tr_b16 v[144:145], v212 offset:28672
ds_read_b64_tr_b16 v[146:147], v212 offset:29696
v_add_f32 v180, v180, v196
v_add_f32 v181, v181, v197
v_mfma_f32_16x16x32_bf16 v[64:67], v[148:151], v[92:95], v[64:67]
v_fmac_f32 v182, v196, v196
v_fmac_f32 v183, v197, v197
v_mfma_f32_16x16x32_bf16 v[68:71], v[148:151], v[96:99], v[68:71]
v_add_f32 v180, v180, v198
v_add_f32 v181, v181, v199
v_mfma_f32_16x16x32_bf16 v[72:75], v[148:151], v[100:103], v[72:75]
v_fmac_f32 v182, v198, v198
v_mfma_f32_16x16x32_bf16 v[76:79], v[148:151], v[104:107], v[76:79]
ds_read_b64_tr_b16 v[148:149], v213 offset:36864
ds_read_b64_tr_b16 v[150:151], v213 offset:37376
v_fmac_f32 v183, v199, v199
s_waitcnt lgkmcnt(8)
v_mfma_f32_16x16x32_bf16 v[0:3], v[132:135], v[108:111], v[0:3]
v_add_f32 v180, v180, v181
v_add_f32 v181, v182, v183
v_mov_b32 v192, v180
v_mfma_f32_16x16x32_bf16 v[4:7], v[132:135], v[112:115], v[4:7]
v_mov_b32 v193, v181
v_permlane32_swap_b32 v180, v192
s_nop 0
v_permlane32_swap_b32 v181, v193
v_mfma_f32_16x16x32_bf16 v[8:11], v[132:135], v[116:119], v[8:11]
v_add_f32 v180, v180, v192
v_add_f32 v181, v181, v193
v_mov_b32 v192, v180
v_mfma_f32_16x16x32_bf16 v[12:15], v[132:135], v[120:123], v[12:15]
v_mov_b32 v193, v181
v_permlane16_swap_b32 v180, v192
s_nop 0
v_permlane16_swap_b32 v181, v193
v_mfma_f32_16x16x32_bf16 v[80:83], v[132:135], v[152:155], v[80:83]
v_add_f32 v180, v180, v192
v_add_f32 v181, v181, v193
v_mul_f32 v180, 0x3b000000, v180
s_waitcnt lgkmcnt(6)
v_mfma_f32_16x16x32_bf16 v[16:19], v[136:139], v[108:111], v[16:19]
v_mul_f32 v181, 0x3b000000, v181
v_fma_f32 v181, -v180, v180, v181
v_max_f32 v181, 0, v181
v_mfma_f32_16x16x32_bf16 v[20:23], v[136:139], v[112:115], v[20:23]
v_cvt_pk_bf16_f32 v192, v180, v181
v_lshlrev_b32 v180, 16, v192
v_and_b32 v181, 0xffff0000, v192
v_mfma_f32_16x16x32_bf16 v[24:27], v[136:139], v[116:119], v[24:27]
v_add_f32 v181, 0x3727c5ac, v181
v_cvt_pk_bf16_f32 v181, v181, v181
v_lshlrev_b32 v181, 16, v181
v_mfma_f32_16x16x32_bf16 v[28:31], v[136:139], v[120:123], v[28:31]
v_sqrt_f32 v181, v181
s_nop 0
v_cvt_pk_bf16_f32 v181, v181, v181
v_lshlrev_b32 v181, 16, v181
v_mfma_f32_16x16x32_bf16 v[84:87], v[136:139], v[152:155], v[84:87]
v_rcp_f32 v192, v181
v_xor_b32 v182, 0x80000000, v180
s_waitcnt lgkmcnt(4)
v_mfma_f32_16x16x32_bf16 v[32:35], v[140:143], v[108:111], v[32:35]
v_fma_f32 v181, -v181, v192, 1.0
v_fma_f32 v183, v181, v192, v192
v_mfma_f32_16x16x32_bf16 v[36:39], v[140:143], v[112:115], v[36:39]
s_not_b64 exec, s[60:61]
ds_write_b128 v246, v[80:83] offset:0
ds_write_b128 v246, v[84:87] offset:64
s_mov_b64 exec, 0xffff
ds_write_b64 v245, v[182:183]
v_lshrrev_b32 v192, 2, v164
buffer_store_dword v183, v192, s[20:23], s80 offen sc0 sc1
s_mov_b64 exec, -1
v_mfma_f32_16x16x32_bf16 v[40:43], v[140:143], v[116:119], v[40:43]
v_mfma_f32_16x16x32_bf16 v[44:47], v[140:143], v[120:123], v[44:47]
s_waitcnt lgkmcnt(2)
v_mfma_f32_16x16x32_bf16 v[48:51], v[144:147], v[108:111], v[48:51]
s_waitcnt lgkmcnt(0)
s_barrier
ds_read_b64 v[228:229], v244 offset:0
ds_read_b64 v[230:231], v244 offset:128
ds_read_b64 v[232:233], v244 offset:256
ds_read_b64 v[234:235], v244 offset:384
ds_read_b128 v[208:211], v246 offset:0
ds_read_b128 v[212:215], v246 offset:64
ds_read_b128 v[216:219], v246 offset:128
ds_read_b128 v[220:223], v246 offset:192
ds_read_b128 v[224:227], v246 offset:256
v_mfma_f32_16x16x32_bf16 v[52:55], v[144:147], v[112:115], v[52:55]
ds_read_b64 v[174:175], v174
v_mfma_f32_16x16x32_bf16 v[56:59], v[144:147], v[116:119], v[56:59]
s_add_u32 m0, s63, 65536
s_add_u32 s49, s100, 262144
buffer_load_dwordx4 v168, s[28:31], s49 offen lds
v_mfma_f32_16x16x32_bf16 v[60:63], v[144:147], v[120:123], v[60:63]
s_add_u32 m0, s63, 66560
s_add_u32 s49, s100, 266240
buffer_load_dwordx4 v168, s[28:31], s49 offen lds
v_mfma_f32_16x16x32_bf16 v[64:67], v[148:151], v[108:111], v[64:67]
s_add_u32 m0, s63, 67584
s_add_u32 s49, s100, 278528
buffer_load_dwordx4 v168, s[28:31], s49 offen lds
v_mfma_f32_16x16x32_bf16 v[68:71], v[148:151], v[112:115], v[68:71]
s_add_u32 m0, s63, 68608
s_add_u32 s49, s100, 282624
buffer_load_dwordx4 v168, s[28:31], s49 offen lds
v_mfma_f32_16x16x32_bf16 v[72:75], v[148:151], v[116:119], v[72:75]
v_mfma_f32_16x16x32_bf16 v[76:79], v[148:151], v[120:123], v[76:79]
s_branch L_epi2
L_t2m1:
s_lshr_b32 s46, s2, 5
s_mul_i32 s0, s46, 3584
s_lshr_b32 s46, s44, 1
s_mul_i32 s46, s46, 640
s_add_u32 s0, s0, s46
s_add_u32 s0, s0, 230912
s_mov_b32 s1, 229376
s_mov_b32 s20, 0xff
s_mov_b32 s21, 1835008
v_mul_u32_u24 v247, 28672, v167
s_cmp_lt_u32 s41, 1
s_cbranch_scc1 L_pf21
s_mul_i32 s46, s41, 11
s_sub_u32 s46, s46, 11
v_add_u32 v247, s46, v167
v_min_u32 v247, 31, v247
s_bfe_u32 s46, s2, 0x20003
s_lshl_b32 s49, s43, 2
s_add_u32 s49, s49, s46
s_lshl_b32 s49, s49, 5
v_add_u32 v247, s49, v247
v_lshlrev_b32 v247, 10, v247
s_mov_b32 s0, 128
s_mov_b32 s1, 128
s_mov_b32 s20, 0x7ff
s_mov_b32 s21, 0x200000
L_pf21:
v_mul_u32_u24 v220, 3584, v232
v_add_u32 v220, v220, v233
s_mul_i32 s50, s44, 320
s_add_u32 s50, s50, 1024
s_bitcmp1_b32 s44, 0
s_cselect_b32 s45, 64, 0
s_cselect_b32 s46, 0, 256
s_add_u32 s51, s50, s46
s_add_u32 s50, s50, s45
v_bfe_u32 v232, v167, 2, 2
v_bfe_u32 v233, v167, 5, 1
v_lshl_add_u32 v232, v233, 2, v232
v_bfe_u32 v233, v167, 4, 1
v_lshl_add_u32 v232, v233, 3, v232
s_lshl_b32 s48, s48, 2
v_add_u32 v232, s48, v232
v_mul_u32_u24 v221, 3584, v232
v_lshlrev_b32 v233, 1, v233
v_and_b32 v234, 3, v167
v_xor_b32 v233, v233, v234
s_lshr_b32 s48, s41, 1
v_xor_b32 v233, s48, v233
v_lshl_add_u32 v221, v233, 4, v221
s_waitcnt lgkmcnt(0)
s_mov_b64 s[4:5], s[64:65]
s_mov_b64 s[8:9], s[72:73]
s_mov_b64 s[12:13], s[74:75]
s_cmp_eq_u32 s48, 0
s_cselect_b64 s[16:17], s[72:73], s[74:75]
s_mov_b32 s70, s20
s_mov_b32 s71, 0
s_bitcmp0_b32 s2, 3
s_cselect_b64 s[72:73], s[72:73], s[74:75]
s_cmp_lt_u32 s41, 1
s_cselect_b64 s[72:73], s[72:73], s[64:65]
s_mov_b32 s74, s21
s_mov_b32 s75, 0x00020000
s_mov_b64 exec, s[70:71]
buffer_load_dword v225, v247, s[72:75], s0 offen
s_mov_b64 exec, -1
s_add_u32 s0, s0, s1
s_add_u32 m0, s56, 128000
s_nop 0
buffer_load_dwordx4 v223, s[4:7], s53 offen offset:0 lds
s_add_u32 m0, s56, 119808
s_nop 0
buffer_load_dwordx4 v223, s[4:7], s52 offen offset:0 lds
s_add_u32 m0, s56, 126976
s_nop 0
buffer_load_dwordx4 v222, s[4:7], s53 offen offset:0 lds
s_add_u32 m0, s55, 94080
s_nop 0
buffer_load_dwordx4 v220, s[12:15], s50 offen offset:128 lds
s_add_u32 m0, s55, 98304
s_nop 0
buffer_load_dwordx4 v221, s[16:19], s51 offen offset:0 lds
s_add_u32 s50, s50, 114688
s_add_u32 s51, s51, 114688
s_add_u32 m0, s55, 12160
s_nop 0
buffer_load_dwordx4 v220, s[12:15], s50 offen offset:128 lds
s_add_u32 m0, s55, 16384
s_nop 0
buffer_load_dwordx4 v221, s[16:19], s51 offen offset:0 lds
s_add_u32 s50, s50, 114688
s_add_u32 s51, s51, 114688
s_mov_b64 exec, s[70:71]
buffer_load_dword v225, v247, s[72:75], s0 offen
s_mov_b64 exec, -1
s_add_u32 s0, s0, s1
s_add_u32 m0, s56, 144256
s_nop 0
buffer_load_dwordx4 v223, s[4:7], s53 offen offset:128 lds
s_add_u32 m0, s56, 136064
s_nop 0
buffer_load_dwordx4 v223, s[4:7], s52 offen offset:128 lds
s_add_u32 m0, s56, 143232
s_nop 0
buffer_load_dwordx4 v222, s[4:7], s53 offen offset:128 lds
s_add_u32 m0, s55, 32640
s_nop 0
buffer_load_dwordx4 v220, s[12:15], s50 offen offset:128 lds
s_add_u32 m0, s55, 36864
s_nop 0
buffer_load_dwordx4 v221, s[16:19], s51 offen offset:0 lds
s_add_u32 s50, s50, 114688
s_add_u32 s51, s51, 114688
s_mov_b64 exec, s[70:71]
buffer_load_dword v225, v247, s[72:75], s0 offen
s_mov_b64 exec, -1
s_add_u32 s0, s0, s1
s_mov_b64 s[20:21], s[82:83]
s_mov_b64 s[24:25], s[80:81]
s_mov_b64 s[28:29], s[68:69]
s_mov_b64 s[32:33], s[76:77]
s_mov_b64 s[36:37], s[78:79]
s_mov_b32 s23, 0x00020000
s_mov_b32 s27, 0x00020000
s_mov_b32 s31, 0x00020000
s_mov_b32 s35, 0x00020000
s_mov_b32 s39, 0x00020000
s_mov_b32 s22, 9601024
s_mov_b32 s26, 256
s_mov_b32 s30, 524288
s_mov_b32 s34, 1835008
s_mov_b32 s38, 0x200000
s_mov_b32 s58, 0xffff0000
s_mov_b32 s60, 0xfffefffe
s_mov_b32 s61, 0xfffefffe
s_and_b32 s45, s2, 6
s_lshr_b32 s46, s2, 7
s_add_u32 s45, s45, s46
s_lshl_b32 s45, s45, 1
s_and_b32 s46, s2, 1
s_add_u32 s45, s45, s46
s_lshl_b32 s45, s45, 1
s_bfe_u32 s46, s2, 0x10006
s_add_u32 s59, s45, s46
s_bfe_u32 s62, s2, 0x30003
s_lshl_b32 s63, s40, 12
s_add_u32 s101, s40, s62
s_and_b32 s101, s101, 7
s_lshl_b32 s45, s62, 7
s_lshl_b32 s100, s40, 15
s_add_u32 s100, s100, s45
s_mul_i32 s3, s101, 163840
s_add_u32 s3, s3, 524288
s_add_u32 s3, s3, s45
v_bfe_u32 v232, v167, 2, 3
v_lshrrev_b32 v233, 5, v167
v_lshlrev_b32 v234, 11, v233
v_lshl_add_u32 v234, v232, 7, v234
v_and_b32 v235, 3, v167
v_lshl_add_u32 v234, v235, 3, v234
v_lshrrev_b32 v236, 1, v232
s_and_b32 s45, s40, 1
s_lshl_b32 s45, s45, 1
v_xor_b32 v237, s45, v236
v_add_u32 v239, s63, v234
v_xor_b32 v238, 0, v237
v_lshl_add_u32 v169, v238, 5, v239
v_xor_b32 v238, 1, v237
v_lshl_add_u32 v170, v238, 5, v239
v_xor_b32 v238, 2, v237
v_lshl_add_u32 v171, v238, 5, v239
v_xor_b32 v238, 3, v237
v_lshl_add_u32 v172, v238, 5, v239
s_and_b32 s45, s41, 1
s_lshl_b32 s46, s45, 1
v_xor_b32 v236, s46, v236
v_lshl_add_u32 v208, v236, 5, v234
s_lshr_b32 s46, s41, 1
s_lshl_b32 s46, s46, 12
v_add_u32 v208, s46, v208
v_xor_b32 v209, 32, v208
v_lshrrev_b32 v234, 1, v235
v_lshlrev_b32 v236, 11, v234
v_lshl_add_u32 v236, v233, 10, v236
v_lshl_add_u32 v236, v232, 6, v236
v_and_b32 v235, 1, v235
v_lshl_add_u32 v236, v235, 3, v236
v_bfe_u32 v235, v167, 4, 1
v_lshlrev_b32 v235, 1, v235
v_xor_b32 v235, v235, v234
v_xor_b32 v235, s41, v235
v_lshl_add_u32 v210, v235, 4, v236
v_add_u32 v211, 61440, v208
v_add_u32 v212, 61440, v209
v_add_u32 v213, 61440, v210
v_and_b32 v232, 15, v167
v_lshrrev_b32 v233, 4, v167
v_lshrrev_b32 v234, 1, v232
v_xor_b32 v233, v233, v234
v_lshlrev_b32 v233, 4, v233
v_lshl_add_u32 v233, v232, 7, v233
v_add_u32 v214, 110592, v233
v_xor_b32 v215, 64, v214
v_add_u32 v216, s56, v214
v_add_u32 v217, s56, v215
v_mov_b32 v152, 0x3f803f80
v_mov_b32 v153, 0x3f803f80
v_mov_b32 v154, 0x3f803f80
v_mov_b32 v155, 0x3f803f80
v_mov_b32 v180, 0
v_mov_b32 v181, 0
v_mov_b32 v182, 0
v_mov_b32 v183, 0
v_mov_b32 v184, 0
v_mov_b32 v185, 0
v_lshrrev_b32 v226, 3, v167
v_lshlrev_b32 v226, 15, v226
v_and_b32 v227, 7, v167
v_lshl_add_u32 v226, v227, 10, v226
s_lshr_b32 s45, s2, 6
s_lshl_b32 s45, s45, 13
v_add_u32 v226, s45, v226
v_and_b32 v227, 8, v167
v_mul_u32_u24 v227, 28672, v227
v_add3_u32 v227, v227, v226, s100
s_lshl_b32 s45, s101, 16
s_lshl_b32 s46, s62, 7
s_add_u32 s45, s45, s46
s_sub_u32 s45, s45, 163840
v_add_u32 v233, s45, v226
v_add_u32 v226, s3, v226
v_cmp_lt_u32 vcc, 39, v167
s_nop 1
v_cndmask_b32 v226, v226, v233, vcc
v_lshlrev_b32 v164, 4, v167
v_and_b32 v232, 0xf0, v164
v_bfe_u32 v233, v167, 4, 1
v_lshrrev_b32 v234, 5, v167
v_lshl_add_u32 v235, v233, 1, v234
v_lshlrev_b32 v165, 6, v232
v_lshl_add_u32 v165, v235, 4, v165
v_mov_b32 v174, 160512
v_lshrrev_b32 v244, 1, v232
v_add_u32 v244, 158208, v244
s_lshl_b32 s45, s41, 7
v_add_u32 v245, s45, v244
v_and_b32 v246, 0x30, v167
s_mul_i32 s45, s41, 320
s_add_u32 s45, s45, 159232
v_lshl_add_u32 v240, v235, 8, v232
v_mul_u32_u24 v241, 73728, v235
v_add_u32 v241, v241, v232
v_add_u32 v246, s45, v246
s_waitcnt vmcnt(9)
s_waitcnt lgkmcnt(0)
s_barrier
ds_read_b128 v[92:95], v214 offset:16384
ds_read_b128 v[96:99], v214 offset:18432
ds_read_b128 v[100:103], v214 offset:20480
ds_read_b128 v[104:107], v214 offset:22528
ds_read_b64_tr_b16 v[132:133], v211 offset:20480
ds_read_b64_tr_b16 v[134:135], v211 offset:21504
ds_read_b64_tr_b16 v[136:137], v211 offset:28672
ds_read_b64_tr_b16 v[138:139], v211 offset:29696
ds_read_b64_tr_b16 v[140:141], v212 offset:20480
ds_read_b64_tr_b16 v[142:143], v212 offset:21504
ds_read_b64_tr_b16 v[144:145], v212 offset:28672
ds_read_b64_tr_b16 v[146:147], v212 offset:29696
ds_read_b64_tr_b16 v[148:149], v213 offset:36864
ds_read_b64_tr_b16 v[150:151], v213 offset:37376
ds_read_b128 v[248:251], v216 offset:16384
s_waitcnt lgkmcnt(9)
v_mfma_f32_16x16x32_bf16 v[0:3], v[132:135], v[92:95], 0
v_mfma_f32_16x16x32_bf16 v[4:7], v[132:135], v[96:99], 0
v_mfma_f32_16x16x32_bf16 v[8:11], v[132:135], v[100:103], 0
v_mfma_f32_16x16x32_bf16 v[12:15], v[132:135], v[104:107], 0
s_waitcnt vmcnt(7)
s_waitcnt lgkmcnt(0)
s_barrier
ds_read_b64_tr_b16 v[132:133], v208 offset:0
ds_read_b64_tr_b16 v[134:135], v208 offset:1024
v_mfma_f32_16x16x32_bf16 v[16:19], v[136:139], v[92:95], 0
ds_read_b128 v[156:159], v217 offset:16384
ds_read_b128 v[108:111], v215 offset:16384
ds_read_b128 v[112:115], v215 offset:18432
s_add_u32 m0, s55, 53120
s_nop 0
buffer_load_dwordx4 v220, s[12:15], s50 offen offset:128 lds
v_lshlrev_b32 v192, 16, v248
v_and_b32 v193, s58, v248
v_lshlrev_b32 v194, 16, v249
v_mfma_f32_16x16x32_bf16 v[20:23], v[136:139], v[96:99], 0
ds_read_b128 v[116:119], v215 offset:20480
ds_read_b128 v[120:123], v215 offset:22528
v_and_b32 v195, s58, v249
v_add_f32 v180, v180, v192
v_add_f32 v181, v181, v193
v_mfma_f32_16x16x32_bf16 v[24:27], v[136:139], v[100:103], 0
v_fmac_f32 v182, v192, v192
v_fmac_f32 v183, v193, v193
v_lshlrev_b32 v196, 16, v250
v_mfma_f32_16x16x32_bf16 v[28:31], v[136:139], v[104:107], 0
ds_read_b64_tr_b16 v[136:137], v208 offset:8192
ds_read_b64_tr_b16 v[138:139], v208 offset:9216
s_add_u32 m0, s55, 57344
s_nop 0
buffer_load_dwordx4 v221, s[16:19], s51 offen offset:0 lds
s_add_u32 s50, s50, 114688
s_add_u32 s51, s51, 114688
v_and_b32 v197, s58, v250
v_add_f32 v180, v180, v194
v_add_f32 v181, v181, v195
v_mfma_f32_16x16x32_bf16 v[32:35], v[140:143], v[92:95], 0
v_fmac_f32 v182, v194, v194
v_fmac_f32 v183, v195, v195
v_lshlrev_b32 v198, 16, v251
v_mfma_f32_16x16x32_bf16 v[36:39], v[140:143], v[96:99], 0
v_and_b32 v199, s58, v251
v_add_f32 v180, v180, v196
v_add_f32 v181, v181, v197
v_mfma_f32_16x16x32_bf16 v[40:43], v[140:143], v[100:103], 0
s_add_u32 m0, s56, 111360
s_nop 0
buffer_load_dwordx4 v223, s[4:7], s53 offen offset:256 lds
v_fmac_f32 v182, v196, v196
v_fmac_f32 v183, v197, v197
v_mfma_f32_16x16x32_bf16 v[44:47], v[140:143], v[104:107], 0
v_add_f32 v180, v180, v198
v_add_f32 v181, v181, v199
v_mfma_f32_16x16x32_bf16 v[80:83], v[140:143], v[152:155], 0
ds_read_b64_tr_b16 v[140:141], v209 offset:0
ds_read_b64_tr_b16 v[142:143], v209 offset:1024
v_fmac_f32 v182, v198, v198
v_fmac_f32 v183, v199, v199
v_mfma_f32_16x16x32_bf16 v[48:51], v[144:147], v[92:95], 0
s_add_u32 m0, s56, 103168
s_nop 0
buffer_load_dwordx4 v223, s[4:7], s52 offen offset:256 lds
s_waitcnt lgkmcnt(8)
v_lshlrev_b32 v192, 16, v156
v_and_b32 v193, s58, v156
v_lshlrev_b32 v194, 16, v157
v_mfma_f32_16x16x32_bf16 v[52:55], v[144:147], v[96:99], 0
v_and_b32 v195, s58, v157
v_add_f32 v180, v180, v192
v_add_f32 v181, v181, v193
v_mfma_f32_16x16x32_bf16 v[56:59], v[144:147], v[100:103], 0
v_fmac_f32 v182, v192, v192
v_fmac_f32 v183, v193, v193
v_lshlrev_b32 v196, 16, v158
v_mfma_f32_16x16x32_bf16 v[60:63], v[144:147], v[104:107], 0
s_add_u32 m0, s56, 110336
s_nop 0
buffer_load_dwordx4 v222, s[4:7], s53 offen offset:256 lds
v_and_b32 v197, s58, v158
v_add_f32 v180, v180, v194
v_add_f32 v181, v181, v195
v_mfma_f32_16x16x32_bf16 v[84:87], v[144:147], v[152:155], 0
ds_read_b64_tr_b16 v[144:145], v209 offset:8192
ds_read_b64_tr_b16 v[146:147], v209 offset:9216
v_fmac_f32 v182, v194, v194
v_fmac_f32 v183, v195, v195
v_mfma_f32_16x16x32_bf16 v[64:67], v[148:151], v[92:95], 0
v_lshlrev_b32 v198, 16, v159
v_and_b32 v199, s58, v159
v_mfma_f32_16x16x32_bf16 v[68:71], v[148:151], v[96:99], 0
s_add_u32 m0, s55, 73600
s_nop 0
buffer_load_dwordx4 v220, s[12:15], s50 offen offset:128 lds
v_add_f32 v180, v180, v196
v_add_f32 v181, v181, v197
v_mfma_f32_16x16x32_bf16 v[72:75], v[148:151], v[100:103], 0
v_fmac_f32 v182, v196, v196
v_fmac_f32 v183, v197, v197
v_mfma_f32_16x16x32_bf16 v[76:79], v[148:151], v[104:107], 0
v_add_f32 v180, v180, v198
v_add_f32 v181, v181, v199
v_mfma_f32_16x16x32_bf16 v[88:91], v[148:151], v[152:155], 0
ds_read_b64_tr_b16 v[148:149], v210 offset:16384
ds_read_b64_tr_b16 v[150:151], v210 offset:16896
v_fmac_f32 v182, v198, v198
v_fmac_f32 v183, v199, v199
s_waitcnt lgkmcnt(8)
v_mfma_f32_16x16x32_bf16 v[0:3], v[132:135], v[108:111], v[0:3]
v_mfma_f32_16x16x32_bf16 v[4:7], v[132:135], v[112:115], v[4:7]
v_mfma_f32_16x16x32_bf16 v[8:11], v[132:135], v[116:119], v[8:11]
v_mfma_f32_16x16x32_bf16 v[12:15], v[132:135], v[120:123], v[12:15]
s_waitcnt vmcnt(7)
s_waitcnt lgkmcnt(0)
s_barrier
ds_read_b64_tr_b16 v[132:133], v208 offset:20480
ds_read_b64_tr_b16 v[134:135], v208 offset:21504
v_mfma_f32_16x16x32_bf16 v[16:19], v[136:139], v[108:111], v[16:19]
ds_read_b128 v[156:159], v216 offset:32768
ds_read_b128 v[92:95], v214 offset:32768
ds_read_b128 v[96:99], v214 offset:34816
s_add_u32 m0, s55, 77824
s_nop 0
buffer_load_dwordx4 v221, s[16:19], s51 offen offset:0 lds
s_add_u32 s50, s50, 114688
s_add_u32 s51, s51, 114688
v_mfma_f32_16x16x32_bf16 v[20:23], v[136:139], v[112:115], v[20:23]
ds_read_b128 v[100:103], v214 offset:36864
ds_read_b128 v[104:107], v214 offset:38912
v_mfma_f32_16x16x32_bf16 v[24:27], v[136:139], v[116:119], v[24:27]
v_mfma_f32_16x16x32_bf16 v[28:31], v[136:139], v[120:123], v[28:31]
ds_read_b64_tr_b16 v[136:137], v208 offset:28672
ds_read_b64_tr_b16 v[138:139], v208 offset:29696
s_add_u32 m0, s55, 94080
s_nop 0
buffer_load_dwordx4 v220, s[12:15], s50 offen offset:128 lds
v_mfma_f32_16x16x32_bf16 v[32:35], v[140:143], v[108:111], v[32:35]
v_mfma_f32_16x16x32_bf16 v[36:39], v[140:143], v[112:115], v[36:39]
s_waitcnt lgkmcnt(6)
v_lshlrev_b32 v192, 16, v156
v_and_b32 v193, s58, v156
v_mfma_f32_16x16x32_bf16 v[40:43], v[140:143], v[116:119], v[40:43]
s_add_u32 m0, s55, 98304
s_nop 0
buffer_load_dwordx4 v221, s[16:19], s51 offen offset:0 lds
s_add_u32 s50, s50, 114688
s_add_u32 s51, s51, 114688
v_lshlrev_b32 v194, 16, v157
v_and_b32 v195, s58, v157
v_mfma_f32_16x16x32_bf16 v[44:47], v[140:143], v[120:123], v[44:47]
v_add_f32 v180, v180, v192
v_add_f32 v181, v181, v193
v_mfma_f32_16x16x32_bf16 v[80:83], v[140:143], v[152:155], v[80:83]
ds_read_b64_tr_b16 v[140:141], v209 offset:20480
ds_read_b64_tr_b16 v[142:143], v209 offset:21504
v_fmac_f32 v182, v192, v192
v_fmac_f32 v183, v193, v193
v_mfma_f32_16x16x32_bf16 v[48:51], v[144:147], v[108:111], v[48:51]
s_add_u32 m0, s55, 12160
s_nop 0
buffer_load_dwordx4 v220, s[12:15], s50 offen offset:128 lds
v_lshlrev_b32 v196, 16, v158
v_and_b32 v197, s58, v158
v_mfma_f32_16x16x32_bf16 v[52:55], v[144:147], v[112:115], v[52:55]
v_add_f32 v180, v180, v194
v_add_f32 v181, v181, v195
v_mfma_f32_16x16x32_bf16 v[56:59], v[144:147], v[116:119], v[56:59]
v_fmac_f32 v182, v194, v194
v_fmac_f32 v183, v195, v195
v_mfma_f32_16x16x32_bf16 v[60:63], v[144:147], v[120:123], v[60:63]
s_add_u32 m0, s55, 16384
s_nop 0
buffer_load_dwordx4 v221, s[16:19], s51 offen offset:0 lds
s_add_u32 s50, s50, 114688
s_add_u32 s51, s51, 114688
v_lshlrev_b32 v198, 16, v159
v_and_b32 v199, s58, v159
v_mfma_f32_16x16x32_bf16 v[84:87], v[144:147], v[152:155], v[84:87]
ds_read_b64_tr_b16 v[144:145], v209 offset:28672
ds_read_b64_tr_b16 v[146:147], v209 offset:29696
v_add_f32 v180, v180, v196
v_add_f32 v181, v181, v197
v_mfma_f32_16x16x32_bf16 v[64:67], v[148:151], v[108:111], v[64:67]
v_fmac_f32 v182, v196, v196
v_fmac_f32 v183, v197, v197
v_mfma_f32_16x16x32_bf16 v[68:71], v[148:151], v[112:115], v[68:71]
s_add_u32 m0, s56, 119424
s_nop 0
buffer_load_dwordx4 v223, s[4:7], s52 offen offset:384 lds
v_add_f32 v180, v180, v198
v_mfma_f32_16x16x32_bf16 v[72:75], v[148:151], v[116:119], v[72:75]
v_add_f32 v181, v181, v199
v_mfma_f32_16x16x32_bf16 v[76:79], v[148:151], v[120:123], v[76:79]
v_fmac_f32 v182, v198, v198
v_mfma_f32_16x16x32_bf16 v[88:91], v[148:151], v[152:155], v[88:91]
ds_read_b64_tr_b16 v[148:149], v210 offset:36864
ds_read_b64_tr_b16 v[150:151], v210 offset:37376
v_fmac_f32 v183, v199, v199
s_mov_b64 exec, s[70:71]
buffer_load_dword v225, v247, s[72:75], s0 offen
s_mov_b64 exec, -1
s_add_u32 s0, s0, s1
s_waitcnt lgkmcnt(8)
v_mfma_f32_16x16x32_bf16 v[0:3], v[132:135], v[92:95], v[0:3]
v_mfma_f32_16x16x32_bf16 v[4:7], v[132:135], v[96:99], v[4:7]
v_mfma_f32_16x16x32_bf16 v[8:11], v[132:135], v[100:103], v[8:11]
v_mfma_f32_16x16x32_bf16 v[12:15], v[132:135], v[104:107], v[12:15]
s_waitcnt vmcnt(11)
s_waitcnt lgkmcnt(0)
s_barrier
ds_read_b64_tr_b16 v[132:133], v208 offset:40960
ds_read_b64_tr_b16 v[134:135], v208 offset:41984
v_mfma_f32_16x16x32_bf16 v[16:19], v[136:139], v[92:95], v[16:19]
ds_read_b128 v[156:159], v217 offset:32768
ds_read_b128 v[108:111], v215 offset:32768
ds_read_b128 v[112:115], v215 offset:34816
s_add_u32 m0, s56, 126592
s_nop 0
buffer_load_dwordx4 v222, s[4:7], s53 offen offset:384 lds
v_mfma_f32_16x16x32_bf16 v[20:23], v[136:139], v[96:99], v[20:23]
ds_read_b128 v[116:119], v215 offset:36864
ds_read_b128 v[120:123], v215 offset:38912
v_mfma_f32_16x16x32_bf16 v[24:27], v[136:139], v[100:103], v[24:27]
v_mfma_f32_16x16x32_bf16 v[28:31], v[136:139], v[104:107], v[28:31]
ds_read_b64_tr_b16 v[136:137], v208 offset:49152
ds_read_b64_tr_b16 v[138:139], v208 offset:50176
s_add_u32 m0, s56, 127616
s_nop 0
buffer_load_dwordx4 v223, s[4:7], s53 offen offset:384 lds
v_mfma_f32_16x16x32_bf16 v[32:35], v[140:143], v[92:95], v[32:35]
v_mfma_f32_16x16x32_bf16 v[36:39], v[140:143], v[96:99], v[36:39]
s_waitcnt lgkmcnt(6)
v_lshlrev_b32 v192, 16, v156
v_and_b32 v193, s58, v156
v_mfma_f32_16x16x32_bf16 v[40:43], v[140:143], v[100:103], v[40:43]
s_add_u32 m0, s55, 32640
s_nop 0
buffer_load_dwordx4 v220, s[12:15], s50 offen offset:128 lds
v_lshlrev_b32 v194, 16, v157
v_and_b32 v195, s58, v157
v_mfma_f32_16x16x32_bf16 v[44:47], v[140:143], v[104:107], v[44:47]
v_add_f32 v180, v180, v192
v_add_f32 v181, v181, v193
v_mfma_f32_16x16x32_bf16 v[80:83], v[140:143], v[152:155], v[80:83]
ds_read_b64_tr_b16 v[140:141], v209 offset:40960
ds_read_b64_tr_b16 v[142:143], v209 offset:41984
v_fmac_f32 v182, v192, v192
v_fmac_f32 v183, v193, v193
v_mfma_f32_16x16x32_bf16 v[48:51], v[144:147], v[92:95], v[48:51]
s_add_u32 m0, s55, 36864
s_nop 0
buffer_load_dwordx4 v221, s[16:19], s51 offen offset:0 lds
s_add_u32 s50, s50, 114688
s_add_u32 s51, s51, 114688
v_lshlrev_b32 v196, 16, v158
v_and_b32 v197, s58, v158
v_mfma_f32_16x16x32_bf16 v[52:55], v[144:147], v[96:99], v[52:55]
v_add_f32 v180, v180, v194
v_add_f32 v181, v181, v195
v_mfma_f32_16x16x32_bf16 v[56:59], v[144:147], v[100:103], v[56:59]
v_fmac_f32 v182, v194, v194
v_fmac_f32 v183, v195, v195
v_mfma_f32_16x16x32_bf16 v[60:63], v[144:147], v[104:107], v[60:63]
v_lshlrev_b32 v198, 16, v159
v_and_b32 v199, s58, v159
v_mfma_f32_16x16x32_bf16 v[84:87], v[144:147], v[152:155], v[84:87]
ds_read_b64_tr_b16 v[144:145], v209 offset:49152
ds_read_b64_tr_b16 v[146:147], v209 offset:50176
v_add_f32 v180, v180, v196
v_add_f32 v181, v181, v197
v_mfma_f32_16x16x32_bf16 v[64:67], v[148:151], v[92:95], v[64:67]
v_fmac_f32 v182, v196, v196
v_fmac_f32 v183, v197, v197
v_mfma_f32_16x16x32_bf16 v[68:71], v[148:151], v[96:99], v[68:71]
v_add_f32 v180, v180, v198
v_mfma_f32_16x16x32_bf16 v[72:75], v[148:151], v[100:103], v[72:75]
v_add_f32 v181, v181, v199
v_mfma_f32_16x16x32_bf16 v[76:79], v[148:151], v[104:107], v[76:79]
v_fmac_f32 v182, v198, v198
v_mfma_f32_16x16x32_bf16 v[88:91], v[148:151], v[152:155], v[88:91]
ds_read_b64_tr_b16 v[148:149], v210 offset:57344
ds_read_b64_tr_b16 v[150:151], v210 offset:57856
v_fmac_f32 v183, v199, v199
s_waitcnt lgkmcnt(8)
v_mfma_f32_16x16x32_bf16 v[0:3], v[132:135], v[108:111], v[0:3]
v_mfma_f32_16x16x32_bf16 v[4:7], v[132:135], v[112:115], v[4:7]
v_mfma_f32_16x16x32_bf16 v[8:11], v[132:135], v[116:119], v[8:11]
v_mfma_f32_16x16x32_bf16 v[12:15], v[132:135], v[120:123], v[12:15]
s_waitcnt vmcnt(10)
s_waitcnt lgkmcnt(0)
s_barrier
ds_read_b64_tr_b16 v[132:133], v211 offset:0
ds_read_b64_tr_b16 v[134:135], v211 offset:1024
v_mfma_f32_16x16x32_bf16 v[16:19], v[136:139], v[108:111], v[16:19]
ds_read_b128 v[156:159], v216 offset:0
ds_read_b128 v[92:95], v214 offset:0
ds_read_b128 v[96:99], v214 offset:2048
s_add_u32 m0, s55, 53120
s_nop 0
buffer_load_dwordx4 v220, s[12:15], s50 offen offset:128 lds
v_mfma_f32_16x16x32_bf16 v[20:23], v[136:139], v[112:115], v[20:23]
ds_read_b128 v[100:103], v214 offset:4096
ds_read_b128 v[104:107], v214 offset:6144
v_mfma_f32_16x16x32_bf16 v[24:27], v[136:139], v[116:119], v[24:27]
v_mfma_f32_16x16x32_bf16 v[28:31], v[136:139], v[120:123], v[28:31]
ds_read_b64_tr_b16 v[136:137], v211 offset:8192
ds_read_b64_tr_b16 v[138:139], v211 offset:9216
s_add_u32 m0, s55, 57344
s_nop 0
buffer_load_dwordx4 v221, s[16:19], s51 offen offset:0 lds
s_add_u32 s50, s50, 114688
s_add_u32 s51, s51, 114688
v_mfma_f32_16x16x32_bf16 v[32:35], v[140:143], v[108:111], v[32:35]
v_mfma_f32_16x16x32_bf16 v[36:39], v[140:143], v[112:115], v[36:39]
s_waitcnt lgkmcnt(6)
v_lshlrev_b32 v192, 16, v156
v_and_b32 v193, s58, v156
v_mfma_f32_16x16x32_bf16 v[40:43], v[140:143], v[116:119], v[40:43]
s_add_u32 m0, s56, 135680
s_nop 0
buffer_load_dwordx4 v223, s[4:7], s52 offen offset:512 lds
v_lshlrev_b32 v194, 16, v157
v_and_b32 v195, s58, v157
v_mfma_f32_16x16x32_bf16 v[44:47], v[140:143], v[120:123], v[44:47]
v_add_f32 v180, v180, v192
v_add_f32 v181, v181, v193
v_mfma_f32_16x16x32_bf16 v[80:83], v[140:143], v[152:155], v[80:83]
ds_read_b64_tr_b16 v[140:141], v212 offset:0
ds_read_b64_tr_b16 v[142:143], v212 offset:1024
v_fmac_f32 v182, v192, v192
v_fmac_f32 v183, v193, v193
v_mfma_f32_16x16x32_bf16 v[48:51], v[144:147], v[108:111], v[48:51]
s_add_u32 m0, s56, 142848
s_nop 0
buffer_load_dwordx4 v222, s[4:7], s53 offen offset:512 lds
v_lshlrev_b32 v196, 16, v158
v_and_b32 v197, s58, v158
v_mfma_f32_16x16x32_bf16 v[52:55], v[144:147], v[112:115], v[52:55]
v_add_f32 v180, v180, v194
v_add_f32 v181, v181, v195
v_mfma_f32_16x16x32_bf16 v[56:59], v[144:147], v[116:119], v[56:59]
v_fmac_f32 v182, v194, v194
v_fmac_f32 v183, v195, v195
v_mfma_f32_16x16x32_bf16 v[60:63], v[144:147], v[120:123], v[60:63]
v_lshlrev_b32 v198, 16, v159
v_and_b32 v199, s58, v159
v_mfma_f32_16x16x32_bf16 v[84:87], v[144:147], v[152:155], v[84:87]
ds_read_b64_tr_b16 v[144:145], v212 offset:8192
ds_read_b64_tr_b16 v[146:147], v212 offset:9216
v_add_f32 v180, v180, v196
v_add_f32 v181, v181, v197
v_mfma_f32_16x16x32_bf16 v[64:67], v[148:151], v[108:111], v[64:67]
v_fmac_f32 v182, v196, v196
v_fmac_f32 v183, v197, v197
v_mfma_f32_16x16x32_bf16 v[68:71], v[148:151], v[112:115], v[68:71]
v_add_f32 v180, v180, v198
v_mfma_f32_16x16x32_bf16 v[72:75], v[148:151], v[116:119], v[72:75]
v_add_f32 v181, v181, v199
v_mfma_f32_16x16x32_bf16 v[76:79], v[148:151], v[120:123], v[76:79]
v_fmac_f32 v182, v198, v198
v_mfma_f32_16x16x32_bf16 v[88:91], v[148:151], v[152:155], v[88:91]
ds_read_b64_tr_b16 v[148:149], v213 offset:16384
ds_read_b64_tr_b16 v[150:151], v213 offset:16896
v_fmac_f32 v183, v199, v199
s_mov_b64 exec, s[70:71]
buffer_load_dword v225, v247, s[72:75], s0 offen
s_mov_b64 exec, -1
s_add_u32 s0, s0, s1
s_waitcnt lgkmcnt(8)
v_mfma_f32_16x16x32_bf16 v[0:3], v[132:135], v[92:95], v[0:3]
v_mfma_f32_16x16x32_bf16 v[4:7], v[132:135], v[96:99], v[4:7]
v_mfma_f32_16x16x32_bf16 v[8:11], v[132:135], v[100:103], v[8:11]
v_mfma_f32_16x16x32_bf16 v[12:15], v[132:135], v[104:107], v[12:15]
s_waitcnt vmcnt(13)
s_waitcnt lgkmcnt(0)
s_barrier
ds_read_b64_tr_b16 v[132:133], v211 offset:20480
ds_read_b64_tr_b16 v[134:135], v211 offset:21504
v_mfma_f32_16x16x32_bf16 v[16:19], v[136:139], v[92:95], v[16:19]
ds_read_b128 v[156:159], v217 offset:0
ds_read_b128 v[108:111], v215 offset:0
ds_read_b128 v[112:115], v215 offset:2048
s_add_u32 m0, s56, 143872
s_nop 0
buffer_load_dwordx4 v223, s[4:7], s53 offen offset:512 lds
v_mfma_f32_16x16x32_bf16 v[20:23], v[136:139], v[96:99], v[20:23]
ds_read_b128 v[116:119], v215 offset:4096
ds_read_b128 v[120:123], v215 offset:6144
v_mfma_f32_16x16x32_bf16 v[24:27], v[136:139], v[100:103], v[24:27]
v_mfma_f32_16x16x32_bf16 v[28:31], v[136:139], v[104:107], v[28:31]
ds_read_b64_tr_b16 v[136:137], v211 offset:28672
ds_read_b64_tr_b16 v[138:139], v211 offset:29696
s_add_u32 m0, s55, 73600
s_nop 0
buffer_load_dwordx4 v220, s[12:15], s50 offen offset:128 lds
v_mfma_f32_16x16x32_bf16 v[32:35], v[140:143], v[92:95], v[32:35]
v_mfma_f32_16x16x32_bf16 v[36:39], v[140:143], v[96:99], v[36:39]
s_waitcnt lgkmcnt(6)
v_lshlrev_b32 v192, 16, v156
v_and_b32 v193, s58, v156
v_mfma_f32_16x16x32_bf16 v[40:43], v[140:143], v[100:103], v[40:43]
s_add_u32 m0, s55, 77824
s_nop 0
buffer_load_dwordx4 v221, s[16:19], s51 offen offset:0 lds
s_add_u32 s50, s50, 114688
s_add_u32 s51, s51, 114688
v_lshlrev_b32 v194, 16, v157
v_and_b32 v195, s58, v157
v_mfma_f32_16x16x32_bf16 v[44:47], v[140:143], v[104:107], v[44:47]
v_add_f32 v180, v180, v192
v_add_f32 v181, v181, v193
v_mfma_f32_16x16x32_bf16 v[80:83], v[140:143], v[152:155], v[80:83]
ds_read_b64_tr_b16 v[140:141], v212 offset:20480
ds_read_b64_tr_b16 v[142:143], v212 offset:21504
v_fmac_f32 v182, v192, v192
v_fmac_f32 v183, v193, v193
v_mfma_f32_16x16x32_bf16 v[48:51], v[144:147], v[92:95], v[48:51]
v_lshlrev_b32 v196, 16, v158
v_and_b32 v197, s58, v158
v_mfma_f32_16x16x32_bf16 v[52:55], v[144:147], v[96:99], v[52:55]
v_add_f32 v180, v180, v194
v_add_f32 v181, v181, v195
v_mfma_f32_16x16x32_bf16 v[56:59], v[144:147], v[100:103], v[56:59]
v_fmac_f32 v182, v194, v194
v_fmac_f32 v183, v195, v195
v_mfma_f32_16x16x32_bf16 v[60:63], v[144:147], v[104:107], v[60:63]
v_lshlrev_b32 v198, 16, v159
v_and_b32 v199, s58, v159
v_mfma_f32_16x16x32_bf16 v[84:87], v[144:147], v[152:155], v[84:87]
ds_read_b64_tr_b16 v[144:145], v212 offset:28672
ds_read_b64_tr_b16 v[146:147], v212 offset:29696
v_add_f32 v180, v180, v196
v_add_f32 v181, v181, v197
v_mfma_f32_16x16x32_bf16 v[64:67], v[148:151], v[92:95], v[64:67]
v_fmac_f32 v182, v196, v196
v_fmac_f32 v183, v197, v197
v_mfma_f32_16x16x32_bf16 v[68:71], v[148:151], v[96:99], v[68:71]
v_add_f32 v180, v180, v198
v_mfma_f32_16x16x32_bf16 v[72:75], v[148:151], v[100:103], v[72:75]
v_add_f32 v181, v181, v199
v_mfma_f32_16x16x32_bf16 v[76:79], v[148:151], v[104:107], v[76:79]
v_fmac_f32 v182, v198, v198
v_mfma_f32_16x16x32_bf16 v[88:91], v[148:151], v[152:155], v[88:91]
ds_read_b64_tr_b16 v[148:149], v213 offset:36864
ds_read_b64_tr_b16 v[150:151], v213 offset:37376
v_fmac_f32 v183, v199, v199
s_waitcnt lgkmcnt(8)
v_mfma_f32_16x16x32_bf16 v[0:3], v[132:135], v[108:111], v[0:3]
v_mfma_f32_16x16x32_bf16 v[4:7], v[132:135], v[112:115], v[4:7]
v_mfma_f32_16x16x32_bf16 v[8:11], v[132:135], v[116:119], v[8:11]
v_mfma_f32_16x16x32_bf16 v[12:15], v[132:135], v[120:123], v[12:15]
s_waitcnt vmcnt(10)
s_waitcnt lgkmcnt(0)
s_barrier
ds_read_b64_tr_b16 v[132:133], v208 offset:0
ds_read_b64_tr_b16 v[134:135], v208 offset:1024
v_mfma_f32_16x16x32_bf16 v[16:19], v[136:139], v[108:111], v[16:19]
ds_read_b128 v[156:159], v216 offset:16384
ds_read_b128 v[92:95], v214 offset:16384
ds_read_b128 v[96:99], v214 offset:18432
s_add_u32 m0, s55, 94080
s_nop 0
buffer_load_dwordx4 v220, s[12:15], s50 offen offset:128 lds
v_mfma_f32_16x16x32_bf16 v[20:23], v[136:139], v[112:115], v[20:23]
ds_read_b128 v[100:103], v214 offset:20480
ds_read_b128 v[104:107], v214 offset:22528
v_mfma_f32_16x16x32_bf16 v[24:27], v[136:139], v[116:119], v[24:27]
v_mfma_f32_16x16x32_bf16 v[28:31], v[136:139], v[120:123], v[28:31]
ds_read_b64_tr_b16 v[136:137], v208 offset:8192
ds_read_b64_tr_b16 v[138:139], v208 offset:9216
s_add_u32 m0, s55, 98304
s_nop 0
buffer_load_dwordx4 v221, s[16:19], s51 offen offset:0 lds
s_add_u32 s50, s50, 114688
s_add_u32 s51, s51, 114688
v_mfma_f32_16x16x32_bf16 v[32:35], v[140:143], v[108:111], v[32:35]
v_mfma_f32_16x16x32_bf16 v[36:39], v[140:143], v[112:115], v[36:39]
s_waitcnt lgkmcnt(6)
v_lshlrev_b32 v192, 16, v156
v_and_b32 v193, s58, v156
v_mfma_f32_16x16x32_bf16 v[40:43], v[140:143], v[116:119], v[40:43]
s_add_u32 m0, s56, 102784
s_nop 0
buffer_load_dwordx4 v223, s[4:7], s52 offen offset:640 lds
v_lshlrev_b32 v194, 16, v157
v_and_b32 v195, s58, v157
v_mfma_f32_16x16x32_bf16 v[44:47], v[140:143], v[120:123], v[44:47]
v_add_f32 v180, v180, v192
v_add_f32 v181, v181, v193
v_mfma_f32_16x16x32_bf16 v[80:83], v[140:143], v[152:155], v[80:83]
ds_read_b64_tr_b16 v[140:141], v209 offset:0
ds_read_b64_tr_b16 v[142:143], v209 offset:1024
v_fmac_f32 v182, v192, v192
v_fmac_f32 v183, v193, v193
v_mfma_f32_16x16x32_bf16 v[48:51], v[144:147], v[108:111], v[48:51]
s_add_u32 m0, s56, 109952
s_nop 0
buffer_load_dwordx4 v222, s[4:7], s53 offen offset:640 lds
v_lshlrev_b32 v196, 16, v158
v_and_b32 v197, s58, v158
v_mfma_f32_16x16x32_bf16 v[52:55], v[144:147], v[112:115], v[52:55]
v_add_f32 v180, v180, v194
v_add_f32 v181, v181, v195
v_mfma_f32_16x16x32_bf16 v[56:59], v[144:147], v[116:119], v[56:59]
v_fmac_f32 v182, v194, v194
v_fmac_f32 v183, v195, v195
v_mfma_f32_16x16x32_bf16 v[60:63], v[144:147], v[120:123], v[60:63]
v_lshlrev_b32 v198, 16, v159
v_and_b32 v199, s58, v159
v_mfma_f32_16x16x32_bf16 v[84:87], v[144:147], v[152:155], v[84:87]
ds_read_b64_tr_b16 v[144:145], v209 offset:8192
ds_read_b64_tr_b16 v[146:147], v209 offset:9216
v_add_f32 v180, v180, v196
v_add_f32 v181, v181, v197
v_mfma_f32_16x16x32_bf16 v[64:67], v[148:151], v[108:111], v[64:67]
v_fmac_f32 v182, v196, v196
v_fmac_f32 v183, v197, v197
v_mfma_f32_16x16x32_bf16 v[68:71], v[148:151], v[112:115], v[68:71]
v_add_f32 v180, v180, v198
v_mfma_f32_16x16x32_bf16 v[72:75], v[148:151], v[116:119], v[72:75]
v_add_f32 v181, v181, v199
v_mfma_f32_16x16x32_bf16 v[76:79], v[148:151], v[120:123], v[76:79]
v_fmac_f32 v182, v198, v198
v_mfma_f32_16x16x32_bf16 v[88:91], v[148:151], v[152:155], v[88:91]
ds_read_b64_tr_b16 v[148:149], v210 offset:16384
ds_read_b64_tr_b16 v[150:151], v210 offset:16896
v_fmac_f32 v183, v199, v199
s_mov_b64 exec, s[70:71]
buffer_load_dword v225, v247, s[72:75], s0 offen
s_mov_b64 exec, -1
s_add_u32 s0, s0, s1
s_waitcnt lgkmcnt(8)
v_mfma_f32_16x16x32_bf16 v[0:3], v[132:135], v[92:95], v[0:3]
v_mfma_f32_16x16x32_bf16 v[4:7], v[132:135], v[96:99], v[4:7]
v_mfma_f32_16x16x32_bf16 v[8:11], v[132:135], v[100:103], v[8:11]
v_mfma_f32_16x16x32_bf16 v[12:15], v[132:135], v[104:107], v[12:15]
s_waitcnt vmcnt(13)
s_waitcnt lgkmcnt(0)
s_barrier
ds_read_b64_tr_b16 v[132:133], v208 offset:20480
ds_read_b64_tr_b16 v[134:135], v208 offset:21504
v_mfma_f32_16x16x32_bf16 v[16:19], v[136:139], v[92:95], v[16:19]
ds_read_b128 v[156:159], v217 offset:16384
ds_read_b128 v[108:111], v215 offset:16384
ds_read_b128 v[112:115], v215 offset:18432
s_add_u32 m0, s56, 110976
s_nop 0
buffer_load_dwordx4 v223, s[4:7], s53 offen offset:640 lds
v_mfma_f32_16x16x32_bf16 v[20:23], v[136:139], v[96:99], v[20:23]
ds_read_b128 v[116:119], v215 offset:20480
ds_read_b128 v[120:123], v215 offset:22528
v_mfma_f32_16x16x32_bf16 v[24:27], v[136:139], v[100:103], v[24:27]
v_mfma_f32_16x16x32_bf16 v[28:31], v[136:139], v[104:107], v[28:31]
ds_read_b64_tr_b16 v[136:137], v208 offset:28672
ds_read_b64_tr_b16 v[138:139], v208 offset:29696
s_add_u32 m0, s55, 12160
s_nop 0
buffer_load_dwordx4 v220, s[12:15], s50 offen offset:128 lds
v_mfma_f32_16x16x32_bf16 v[32:35], v[140:143], v[92:95], v[32:35]
v_mfma_f32_16x16x32_bf16 v[36:39], v[140:143], v[96:99], v[36:39]
s_waitcnt lgkmcnt(6)
v_lshlrev_b32 v192, 16, v156
v_and_b32 v193, s58, v156
v_mfma_f32_16x16x32_bf16 v[40:43], v[140:143], v[100:103], v[40:43]
s_add_u32 m0, s55, 16384
s_nop 0
buffer_load_dwordx4 v221, s[16:19], s51 offen offset:0 lds
s_add_u32 s50, s50, 114688
s_add_u32 s51, s51, 114688
v_lshlrev_b32 v194, 16, v157
v_and_b32 v195, s58, v157
v_mfma_f32_16x16x32_bf16 v[44:47], v[140:143], v[104:107], v[44:47]
v_add_f32 v180, v180, v192
v_add_f32 v181, v181, v193
v_mfma_f32_16x16x32_bf16 v[80:83], v[140:143], v[152:155], v[80:83]
ds_read_b64_tr_b16 v[140:141], v209 offset:20480
ds_read_b64_tr_b16 v[142:143], v209 offset:21504
v_fmac_f32 v182, v192, v192
v_fmac_f32 v183, v193, v193
v_mfma_f32_16x16x32_bf16 v[48:51], v[144:147], v[92:95], v[48:51]
v_lshlrev_b32 v196, 16, v158
v_and_b32 v197, s58, v158
v_mfma_f32_16x16x32_bf16 v[52:55], v[144:147], v[96:99], v[52:55]
v_add_f32 v180, v180, v194
v_add_f32 v181, v181, v195
v_mfma_f32_16x16x32_bf16 v[56:59], v[144:147], v[100:103], v[56:59]
v_fmac_f32 v182, v194, v194
v_fmac_f32 v183, v195, v195
v_mfma_f32_16x16x32_bf16 v[60:63], v[144:147], v[104:107], v[60:63]
v_lshlrev_b32 v198, 16, v159
v_and_b32 v199, s58, v159
v_mfma_f32_16x16x32_bf16 v[84:87], v[144:147], v[152:155], v[84:87]
ds_read_b64_tr_b16 v[144:145], v209 offset:28672
ds_read_b64_tr_b16 v[146:147], v209 offset:29696
v_add_f32 v180, v180, v196
v_add_f32 v181, v181, v197
v_mfma_f32_16x16x32_bf16 v[64:67], v[148:151], v[92:95], v[64:67]
v_fmac_f32 v182, v196, v196
v_fmac_f32 v183, v197, v197
v_mfma_f32_16x16x32_bf16 v[68:71], v[148:151], v[96:99], v[68:71]
v_add_f32 v180, v180, v198
v_mfma_f32_16x16x32_bf16 v[72:75], v[148:151], v[100:103], v[72:75]
v_add_f32 v181, v181, v199
v_mfma_f32_16x16x32_bf16 v[76:79], v[148:151], v[104:107], v[76:79]
v_fmac_f32 v182, v198, v198
v_mfma_f32_16x16x32_bf16 v[88:91], v[148:151], v[152:155], v[88:91]
ds_read_b64_tr_b16 v[148:149], v210 offset:36864
ds_read_b64_tr_b16 v[150:151], v210 offset:37376
v_fmac_f32 v183, v199, v199
s_waitcnt lgkmcnt(8)
v_mfma_f32_16x16x32_bf16 v[0:3], v[132:135], v[108:111], v[0:3]
v_mfma_f32_16x16x32_bf16 v[4:7], v[132:135], v[112:115], v[4:7]
v_mfma_f32_16x16x32_bf16 v[8:11], v[132:135], v[116:119], v[8:11]
v_mfma_f32_16x16x32_bf16 v[12:15], v[132:135], v[120:123], v[12:15]
s_waitcnt vmcnt(10)
s_waitcnt lgkmcnt(0)
s_barrier
ds_read_b64_tr_b16 v[132:133], v208 offset:40960
ds_read_b64_tr_b16 v[134:135], v208 offset:41984
v_mfma_f32_16x16x32_bf16 v[16:19], v[136:139], v[108:111], v[16:19]
ds_read_b128 v[156:159], v216 offset:32768
ds_read_b128 v[92:95], v214 offset:32768
ds_read_b128 v[96:99], v214 offset:34816
s_add_u32 m0, s55, 32640
s_nop 0
buffer_load_dwordx4 v220, s[12:15], s50 offen offset:128 lds
v_mfma_f32_16x16x32_bf16 v[20:23], v[136:139], v[112:115], v[20:23]
ds_read_b128 v[100:103], v214 offset:36864
ds_read_b128 v[104:107], v214 offset:38912
v_mfma_f32_16x16x32_bf16 v[24:27], v[136:139], v[116:119], v[24:27]
v_mfma_f32_16x16x32_bf16 v[28:31], v[136:139], v[120:123], v[28:31]
ds_read_b64_tr_b16 v[136:137], v208 offset:49152
ds_read_b64_tr_b16 v[138:139], v208 offset:50176
s_add_u32 m0, s55, 36864
s_nop 0
buffer_load_dwordx4 v221, s[16:19], s51 offen offset:0 lds
s_add_u32 s50, s50, 114688
s_add_u32 s51, s51, 114688
v_mfma_f32_16x16x32_bf16 v[32:35], v[140:143], v[108:111], v[32:35]
v_mfma_f32_16x16x32_bf16 v[36:39], v[140:143], v[112:115], v[36:39]
s_waitcnt lgkmcnt(6)
v_lshlrev_b32 v192, 16, v156
v_and_b32 v193, s58, v156
v_mfma_f32_16x16x32_bf16 v[40:43], v[140:143], v[116:119], v[40:43]
s_add_u32 m0, s56, 119040
s_nop 0
buffer_load_dwordx4 v223, s[4:7], s52 offen offset:768 lds
v_lshlrev_b32 v194, 16, v157
v_and_b32 v195, s58, v157
v_mfma_f32_16x16x32_bf16 v[44:47], v[140:143], v[120:123], v[44:47]
v_add_f32 v180, v180, v192
v_add_f32 v181, v181, v193
v_mfma_f32_16x16x32_bf16 v[80:83], v[140:143], v[152:155], v[80:83]
ds_read_b64_tr_b16 v[140:141], v209 offset:40960
ds_read_b64_tr_b16 v[142:143], v209 offset:41984
v_fmac_f32 v182, v192, v192
v_fmac_f32 v183, v193, v193
v_mfma_f32_16x16x32_bf16 v[48:51], v[144:147], v[108:111], v[48:51]
s_add_u32 m0, s56, 126208
s_nop 0
buffer_load_dwordx4 v222, s[4:7], s53 offen offset:768 lds
v_lshlrev_b32 v196, 16, v158
v_and_b32 v197, s58, v158
v_mfma_f32_16x16x32_bf16 v[52:55], v[144:147], v[112:115], v[52:55]
v_add_f32 v180, v180, v194
v_add_f32 v181, v181, v195
v_mfma_f32_16x16x32_bf16 v[56:59], v[144:147], v[116:119], v[56:59]
v_fmac_f32 v182, v194, v194
v_fmac_f32 v183, v195, v195
v_mfma_f32_16x16x32_bf16 v[60:63], v[144:147], v[120:123], v[60:63]
v_lshlrev_b32 v198, 16, v159
v_and_b32 v199, s58, v159
v_mfma_f32_16x16x32_bf16 v[84:87], v[144:147], v[152:155], v[84:87]
ds_read_b64_tr_b16 v[144:145], v209 offset:49152
ds_read_b64_tr_b16 v[146:147], v209 offset:50176
v_add_f32 v180, v180, v196
v_add_f32 v181, v181, v197
v_mfma_f32_16x16x32_bf16 v[64:67], v[148:151], v[108:111], v[64:67]
v_fmac_f32 v182, v196, v196
v_fmac_f32 v183, v197, v197
v_mfma_f32_16x16x32_bf16 v[68:71], v[148:151], v[112:115], v[68:71]
v_add_f32 v180, v180, v198
v_mfma_f32_16x16x32_bf16 v[72:75], v[148:151], v[116:119], v[72:75]
v_add_f32 v181, v181, v199
v_mfma_f32_16x16x32_bf16 v[76:79], v[148:151], v[120:123], v[76:79]
v_fmac_f32 v182, v198, v198
v_mfma_f32_16x16x32_bf16 v[88:91], v[148:151], v[152:155], v[88:91]
ds_read_b64_tr_b16 v[148:149], v210 offset:57344
ds_read_b64_tr_b16 v[150:151], v210 offset:57856
v_fmac_f32 v183, v199, v199
s_mov_b64 exec, s[70:71]
buffer_load_dword v225, v247, s[72:75], s0 offen
s_mov_b64 exec, -1
s_add_u32 s0, s0, s1
s_waitcnt lgkmcnt(8)
v_mfma_f32_16x16x32_bf16 v[0:3], v[132:135], v[92:95], v[0:3]
v_mfma_f32_16x16x32_bf16 v[4:7], v[132:135], v[96:99], v[4:7]
v_mfma_f32_16x16x32_bf16 v[8:11], v[132:135], v[100:103], v[8:11]
v_mfma_f32_16x16x32_bf16 v[12:15], v[132:135], v[104:107], v[12:15]
s_waitcnt vmcnt(13)
s_waitcnt lgkmcnt(0)
s_barrier
ds_read_b64_tr_b16 v[132:133], v211 offset:0
ds_read_b64_tr_b16 v[134:135], v211 offset:1024
v_mfma_f32_16x16x32_bf16 v[16:19], v[136:139], v[92:95], v[16:19]
ds_read_b128 v[156:159], v217 offset:32768
ds_read_b128 v[108:111], v215 offset:32768
ds_read_b128 v[112:115], v215 offset:34816
s_add_u32 m0, s56, 127232
s_nop 0
buffer_load_dwordx4 v223, s[4:7], s53 offen offset:768 lds
v_mfma_f32_16x16x32_bf16 v[20:23], v[136:139], v[96:99], v[20:23]
ds_read_b128 v[116:119], v215 offset:36864
ds_read_b128 v[120:123], v215 offset:38912
v_mfma_f32_16x16x32_bf16 v[24:27], v[136:139], v[100:103], v[24:27]
v_mfma_f32_16x16x32_bf16 v[28:31], v[136:139], v[104:107], v[28:31]
ds_read_b64_tr_b16 v[136:137], v211 offset:8192
ds_read_b64_tr_b16 v[138:139], v211 offset:9216
s_add_u32 m0, s55, 53120
s_nop 0
buffer_load_dwordx4 v220, s[12:15], s50 offen offset:128 lds
v_mfma_f32_16x16x32_bf16 v[32:35], v[140:143], v[92:95], v[32:35]
v_mfma_f32_16x16x32_bf16 v[36:39], v[140:143], v[96:99], v[36:39]
s_waitcnt lgkmcnt(6)
v_lshlrev_b32 v192, 16, v156
v_and_b32 v193, s58, v156
v_mfma_f32_16x16x32_bf16 v[40:43], v[140:143], v[100:103], v[40:43]
s_add_u32 m0, s55, 57344
s_nop 0
buffer_load_dwordx4 v221, s[16:19], s51 offen offset:0 lds
s_add_u32 s50, s50, 114688
s_add_u32 s51, s51, 114688
v_lshlrev_b32 v194, 16, v157
v_and_b32 v195, s58, v157
v_mfma_f32_16x16x32_bf16 v[44:47], v[140:143], v[104:107], v[44:47]
v_add_f32 v180, v180, v192
v_add_f32 v181, v181, v193
v_mfma_f32_16x16x32_bf16 v[80:83], v[140:143], v[152:155], v[80:83]
ds_read_b64_tr_b16 v[140:141], v212 offset:0
ds_read_b64_tr_b16 v[142:143], v212 offset:1024
v_fmac_f32 v182, v192, v192
v_fmac_f32 v183, v193, v193
v_mfma_f32_16x16x32_bf16 v[48:51], v[144:147], v[92:95], v[48:51]
v_lshlrev_b32 v196, 16, v158
v_and_b32 v197, s58, v158
v_mfma_f32_16x16x32_bf16 v[52:55], v[144:147], v[96:99], v[52:55]
v_add_f32 v180, v180, v194
v_add_f32 v181, v181, v195
v_mfma_f32_16x16x32_bf16 v[56:59], v[144:147], v[100:103], v[56:59]
v_fmac_f32 v182, v194, v194
v_fmac_f32 v183, v195, v195
v_mfma_f32_16x16x32_bf16 v[60:63], v[144:147], v[104:107], v[60:63]
v_lshlrev_b32 v198, 16, v159
v_and_b32 v199, s58, v159
v_mfma_f32_16x16x32_bf16 v[84:87], v[144:147], v[152:155], v[84:87]
ds_read_b64_tr_b16 v[144:145], v212 offset:8192
ds_read_b64_tr_b16 v[146:147], v212 offset:9216
v_add_f32 v180, v180, v196
v_add_f32 v181, v181, v197
v_mfma_f32_16x16x32_bf16 v[64:67], v[148:151], v[92:95], v[64:67]
v_fmac_f32 v182, v196, v196
v_fmac_f32 v183, v197, v197
v_mfma_f32_16x16x32_bf16 v[68:71], v[148:151], v[96:99], v[68:71]
v_add_f32 v180, v180, v198
v_mfma_f32_16x16x32_bf16 v[72:75], v[148:151], v[100:103], v[72:75]
v_add_f32 v181, v181, v199
v_mfma_f32_16x16x32_bf16 v[76:79], v[148:151], v[104:107], v[76:79]
v_fmac_f32 v182, v198, v198
v_mfma_f32_16x16x32_bf16 v[88:91], v[148:151], v[152:155], v[88:91]
ds_read_b64_tr_b16 v[148:149], v213 offset:16384
ds_read_b64_tr_b16 v[150:151], v213 offset:16896
v_fmac_f32 v183, v199, v199
s_waitcnt lgkmcnt(8)
v_mfma_f32_16x16x32_bf16 v[0:3], v[132:135], v[108:111], v[0:3]
v_mfma_f32_16x16x32_bf16 v[4:7], v[132:135], v[112:115], v[4:7]
v_mfma_f32_16x16x32_bf16 v[8:11], v[132:135], v[116:119], v[8:11]
v_mfma_f32_16x16x32_bf16 v[12:15], v[132:135], v[120:123], v[12:15]
s_waitcnt vmcnt(10)
s_waitcnt lgkmcnt(0)
s_barrier
ds_read_b64_tr_b16 v[132:133], v211 offset:20480
ds_read_b64_tr_b16 v[134:135], v211 offset:21504
v_mfma_f32_16x16x32_bf16 v[16:19], v[136:139], v[108:111], v[16:19]
ds_read_b128 v[156:159], v216 offset:0
ds_read_b128 v[92:95], v214 offset:0
ds_read_b128 v[96:99], v214 offset:2048
s_add_u32 m0, s55, 73600
s_nop 0
buffer_load_dwordx4 v220, s[12:15], s50 offen offset:128 lds
v_mfma_f32_16x16x32_bf16 v[20:23], v[136:139], v[112:115], v[20:23]
ds_read_b128 v[100:103], v214 offset:4096
ds_read_b128 v[104:107], v214 offset:6144
v_mfma_f32_16x16x32_bf16 v[24:27], v[136:139], v[116:119], v[24:27]
v_mfma_f32_16x16x32_bf16 v[28:31], v[136:139], v[120:123], v[28:31]
ds_read_b64_tr_b16 v[136:137], v211 offset:28672
ds_read_b64_tr_b16 v[138:139], v211 offset:29696
s_add_u32 m0, s55, 77824
s_nop 0
buffer_load_dwordx4 v221, s[16:19], s51 offen offset:0 lds
s_add_u32 s50, s50, 114688
s_add_u32 s51, s51, 114688
v_mfma_f32_16x16x32_bf16 v[32:35], v[140:143], v[108:111], v[32:35]
v_mfma_f32_16x16x32_bf16 v[36:39], v[140:143], v[112:115], v[36:39]
s_waitcnt lgkmcnt(6)
v_lshlrev_b32 v192, 16, v156
v_and_b32 v193, s58, v156
v_mfma_f32_16x16x32_bf16 v[40:43], v[140:143], v[116:119], v[40:43]
s_add_u32 m0, s56, 135296
s_nop 0
buffer_load_dwordx4 v223, s[4:7], s52 offen offset:896 lds
v_lshlrev_b32 v194, 16, v157
v_and_b32 v195, s58, v157
v_mfma_f32_16x16x32_bf16 v[44:47], v[140:143], v[120:123], v[44:47]
v_add_f32 v180, v180, v192
v_add_f32 v181, v181, v193
v_mfma_f32_16x16x32_bf16 v[80:83], v[140:143], v[152:155], v[80:83]
ds_read_b64_tr_b16 v[140:141], v212 offset:20480
ds_read_b64_tr_b16 v[142:143], v212 offset:21504
v_fmac_f32 v182, v192, v192
v_fmac_f32 v183, v193, v193
v_mfma_f32_16x16x32_bf16 v[48:51], v[144:147], v[108:111], v[48:51]
s_add_u32 m0, s56, 142464
s_nop 0
buffer_load_dwordx4 v222, s[4:7], s53 offen offset:896 lds
v_lshlrev_b32 v196, 16, v158
v_and_b32 v197, s58, v158
v_mfma_f32_16x16x32_bf16 v[52:55], v[144:147], v[112:115], v[52:55]
v_add_f32 v180, v180, v194
v_add_f32 v181, v181, v195
v_mfma_f32_16x16x32_bf16 v[56:59], v[144:147], v[116:119], v[56:59]
v_fmac_f32 v182, v194, v194
v_fmac_f32 v183, v195, v195
v_mfma_f32_16x16x32_bf16 v[60:63], v[144:147], v[120:123], v[60:63]
v_lshlrev_b32 v198, 16, v159
v_and_b32 v199, s58, v159
v_mfma_f32_16x16x32_bf16 v[84:87], v[144:147], v[152:155], v[84:87]
ds_read_b64_tr_b16 v[144:145], v212 offset:28672
ds_read_b64_tr_b16 v[146:147], v212 offset:29696
v_add_f32 v180, v180, v196
v_add_f32 v181, v181, v197
v_mfma_f32_16x16x32_bf16 v[64:67], v[148:151], v[108:111], v[64:67]
v_fmac_f32 v182, v196, v196
v_fmac_f32 v183, v197, v197
v_mfma_f32_16x16x32_bf16 v[68:71], v[148:151], v[112:115], v[68:71]
v_add_f32 v180, v180, v198
v_mfma_f32_16x16x32_bf16 v[72:75], v[148:151], v[116:119], v[72:75]
v_add_f32 v181, v181, v199
v_mfma_f32_16x16x32_bf16 v[76:79], v[148:151], v[120:123], v[76:79]
v_fmac_f32 v182, v198, v198
v_mfma_f32_16x16x32_bf16 v[88:91], v[148:151], v[152:155], v[88:91]
ds_read_b64_tr_b16 v[148:149], v213 offset:36864
ds_read_b64_tr_b16 v[150:151], v213 offset:37376
v_fmac_f32 v183, v199, v199
s_mov_b32 exec_lo, 0xffff
s_mov_b32 exec_hi, 0x0
buffer_load_dword v225, v226, s[32:35], 0 offen
s_mov_b64 exec, -1
s_mov_b64 exec, 0xffff
buffer_load_dword v225, v227, s[28:31], 0 offen
s_mov_b64 exec, -1
s_waitcnt lgkmcnt(8)
v_mfma_f32_16x16x32_bf16 v[0:3], v[132:135], v[92:95], v[0:3]
v_mfma_f32_16x16x32_bf16 v[4:7], v[132:135], v[96:99], v[4:7]
v_mfma_f32_16x16x32_bf16 v[8:11], v[132:135], v[100:103], v[8:11]
v_mfma_f32_16x16x32_bf16 v[12:15], v[132:135], v[104:107], v[12:15]
s_waitcnt vmcnt(14)
s_waitcnt lgkmcnt(0)
s_barrier
ds_read_b64_tr_b16 v[132:133], v208 offset:0
ds_read_b64_tr_b16 v[134:135], v208 offset:1024
v_mfma_f32_16x16x32_bf16 v[16:19], v[136:139], v[92:95], v[16:19]
ds_read_b128 v[156:159], v217 offset:0
ds_read_b128 v[108:111], v215 offset:0
ds_read_b128 v[112:115], v215 offset:2048
s_add_u32 m0, s56, 143488
s_nop 0
buffer_load_dwordx4 v223, s[4:7], s53 offen offset:896 lds
v_mfma_f32_16x16x32_bf16 v[20:23], v[136:139], v[96:99], v[20:23]
ds_read_b128 v[116:119], v215 offset:4096
ds_read_b128 v[120:123], v215 offset:6144
v_mfma_f32_16x16x32_bf16 v[24:27], v[136:139], v[100:103], v[24:27]
v_mfma_f32_16x16x32_bf16 v[28:31], v[136:139], v[104:107], v[28:31]
ds_read_b64_tr_b16 v[136:137], v208 offset:8192
ds_read_b64_tr_b16 v[138:139], v208 offset:9216
s_add_u32 m0, s55, 94080
s_nop 0
buffer_load_dwordx4 v220, s[12:15], s50 offen offset:128 lds
v_mfma_f32_16x16x32_bf16 v[32:35], v[140:143], v[92:95], v[32:35]
v_mfma_f32_16x16x32_bf16 v[36:39], v[140:143], v[96:99], v[36:39]
s_waitcnt lgkmcnt(6)
v_lshlrev_b32 v192, 16, v156
v_and_b32 v193, s58, v156
v_mfma_f32_16x16x32_bf16 v[40:43], v[140:143], v[100:103], v[40:43]
s_add_u32 m0, s55, 98304
s_nop 0
buffer_load_dwordx4 v221, s[16:19], s51 offen offset:0 lds
s_add_u32 s50, s50, 114688
s_add_u32 s51, s51, 114688
v_lshlrev_b32 v194, 16, v157
v_and_b32 v195, s58, v157
v_mfma_f32_16x16x32_bf16 v[44:47], v[140:143], v[104:107], v[44:47]
v_add_f32 v180, v180, v192
v_add_f32 v181, v181, v193
v_mfma_f32_16x16x32_bf16 v[80:83], v[140:143], v[152:155], v[80:83]
ds_read_b64_tr_b16 v[140:141], v209 offset:0
ds_read_b64_tr_b16 v[142:143], v209 offset:1024
v_fmac_f32 v182, v192, v192
v_fmac_f32 v183, v193, v193
v_mfma_f32_16x16x32_bf16 v[48:51], v[144:147], v[92:95], v[48:51]
v_lshlrev_b32 v196, 16, v158
v_and_b32 v197, s58, v158
v_mfma_f32_16x16x32_bf16 v[52:55], v[144:147], v[96:99], v[52:55]
v_add_f32 v180, v180, v194
v_add_f32 v181, v181, v195
v_mfma_f32_16x16x32_bf16 v[56:59], v[144:147], v[100:103], v[56:59]
v_fmac_f32 v182, v194, v194
v_fmac_f32 v183, v195, v195
v_mfma_f32_16x16x32_bf16 v[60:63], v[144:147], v[104:107], v[60:63]
v_lshlrev_b32 v198, 16, v159
v_and_b32 v199, s58, v159
v_mfma_f32_16x16x32_bf16 v[84:87], v[144:147], v[152:155], v[84:87]
ds_read_b64_tr_b16 v[144:145], v209 offset:8192
ds_read_b64_tr_b16 v[146:147], v209 offset:9216
v_add_f32 v180, v180, v196
v_add_f32 v181, v181, v197
v_mfma_f32_16x16x32_bf16 v[64:67], v[148:151], v[92:95], v[64:67]
v_fmac_f32 v182, v196, v196
v_fmac_f32 v183, v197, v197
v_mfma_f32_16x16x32_bf16 v[68:71], v[148:151], v[96:99], v[68:71]
v_add_f32 v180, v180, v198
v_mfma_f32_16x16x32_bf16 v[72:75], v[148:151], v[100:103], v[72:75]
v_add_f32 v181, v181, v199
v_mfma_f32_16x16x32_bf16 v[76:79], v[148:151], v[104:107], v[76:79]
v_fmac_f32 v182, v198, v198
v_mfma_f32_16x16x32_bf16 v[88:91], v[148:151], v[152:155], v[88:91]
ds_read_b64_tr_b16 v[148:149], v210 offset:16384
ds_read_b64_tr_b16 v[150:151], v210 offset:16896
v_fmac_f32 v183, v199, v199
s_waitcnt lgkmcnt(8)
v_mfma_f32_16x16x32_bf16 v[0:3], v[132:135], v[108:111], v[0:3]
v_add_u32 v248, 102400, v169
v_add_u32 v249, 102400, v170
v_mfma_f32_16x16x32_bf16 v[4:7], v[132:135], v[112:115], v[4:7]
v_add_u32 v250, 102400, v171
v_add_u32 v251, 102400, v172
v_mfma_f32_16x16x32_bf16 v[8:11], v[132:135], v[116:119], v[8:11]
s_lshr_b32 s46, s40, 1
s_lshl_b32 s67, s59, 16
v_mfma_f32_16x16x32_bf16 v[12:15], v[132:135], v[120:123], v[12:15]
s_waitcnt vmcnt(11)
s_waitcnt lgkmcnt(0)
s_barrier
ds_read_b64_tr_b16 v[132:133], v208 offset:20480
ds_read_b64_tr_b16 v[134:135], v208 offset:21504
s_lshl_b32 s45, s46, 14
s_add_u32 s67, s67, s45
v_mfma_f32_16x16x32_bf16 v[16:19], v[136:139], v[108:111], v[16:19]
ds_read_b128 v[156:159], v216 offset:16384
ds_read_b128 v[92:95], v214 offset:16384
ds_read_b128 v[96:99], v214 offset:18432
s_lshl_b32 s45, s62, 7
s_add_u32 s67, s67, s45
v_mfma_f32_16x16x32_bf16 v[20:23], v[136:139], v[112:115], v[20:23]
ds_read_b128 v[100:103], v214 offset:20480
ds_read_b128 v[104:107], v214 offset:22528
s_and_b32 s45, s40, 1
s_lshl_b32 s45, s45, 6
v_mfma_f32_16x16x32_bf16 v[24:27], v[136:139], v[116:119], v[24:27]
s_add_u32 s67, s67, s45
s_lshl_b32 s45, s59, 11
v_mfma_f32_16x16x32_bf16 v[28:31], v[136:139], v[120:123], v[28:31]
ds_read_b64_tr_b16 v[136:137], v208 offset:28672
ds_read_b64_tr_b16 v[138:139], v208 offset:29696
s_lshl_b32 s82, s46, 6
s_add_u32 s82, s82, s45
v_mfma_f32_16x16x32_bf16 v[32:35], v[140:143], v[108:111], v[32:35]
s_lshl_b32 s45, s101, 8
s_add_u32 s82, s82, s45
v_mfma_f32_16x16x32_bf16 v[36:39], v[140:143], v[112:115], v[36:39]
s_waitcnt lgkmcnt(6)
v_lshlrev_b32 v192, 16, v156
v_and_b32 v193, s58, v156
s_add_u32 s82, s82, 9535488
s_lshl_b32 s79, s43, 1
v_mfma_f32_16x16x32_bf16 v[40:43], v[140:143], v[116:119], v[40:43]
v_lshlrev_b32 v194, 16, v157
v_and_b32 v195, s58, v157
s_add_u32 s79, s79, s42
s_mul_i32 s45, s79, 294912
v_mfma_f32_16x16x32_bf16 v[44:47], v[140:143], v[120:123], v[44:47]
v_add_f32 v180, v180, v192
v_add_f32 v181, v181, v193
s_mul_i32 s47, s44, 5
s_and_b32 s48, s44, 1
v_mfma_f32_16x16x32_bf16 v[80:83], v[140:143], v[152:155], v[80:83]
ds_read_b64_tr_b16 v[140:141], v209 offset:20480
ds_read_b64_tr_b16 v[142:143], v209 offset:21504
v_fmac_f32 v182, v192, v192
v_fmac_f32 v183, v193, v193
s_add_u32 s50, s47, s48
s_add_u32 s50, s50, s41
v_mfma_f32_16x16x32_bf16 v[48:51], v[144:147], v[108:111], v[48:51]
v_lshlrev_b32 v196, 16, v158
v_and_b32 v197, s58, v158
s_lshl_b32 s50, s50, 10
s_add_u32 s45, s45, 32768
v_mfma_f32_16x16x32_bf16 v[52:55], v[144:147], v[112:115], v[52:55]
v_add_f32 v180, v180, v194
v_add_f32 v181, v181, v195
s_add_u32 s50, s50, s45
s_add_u32 s51, s50, 73728
v_mfma_f32_16x16x32_bf16 v[56:59], v[144:147], v[116:119], v[56:59]
v_fmac_f32 v182, v194, v194
v_fmac_f32 v183, v195, v195
s_add_u32 s52, s50, 147456
s_add_u32 s53, s50, 221184
v_mfma_f32_16x16x32_bf16 v[60:63], v[144:147], v[120:123], v[60:63]
v_lshlrev_b32 v198, 16, v159
v_and_b32 v199, s58, v159
s_cmp_eq_u32 s48, 0
s_cselect_b32 s48, 4, 0
s_add_u32 s47, s47, s48
v_mfma_f32_16x16x32_bf16 v[84:87], v[144:147], v[152:155], v[84:87]
ds_read_b64_tr_b16 v[144:145], v209 offset:28672
ds_read_b64_tr_b16 v[146:147], v209 offset:29696
v_add_f32 v180, v180, v196
v_add_f32 v181, v181, v197
s_lshl_b32 s47, s47, 10
s_add_u32 s47, s47, s45
v_mfma_f32_16x16x32_bf16 v[64:67], v[148:151], v[108:111], v[64:67]
v_fmac_f32 v182, v196, v196
v_fmac_f32 v183, v197, v197
s_lshl_b32 s48, s41, 8
s_add_u32 s54, s47, s48
v_mfma_f32_16x16x32_bf16 v[68:71], v[148:151], v[112:115], v[68:71]
v_add_f32 v180, v180, v198
s_lshl_b32 s55, s79, 10
s_lshl_b32 s48, s44, 7
v_mfma_f32_16x16x32_bf16 v[72:75], v[148:151], v[116:119], v[72:75]
v_add_f32 v181, v181, v199
s_add_u32 s55, s55, s48
s_lshl_b32 s80, s55, 1
v_mfma_f32_16x16x32_bf16 v[76:79], v[148:151], v[120:123], v[76:79]
v_fmac_f32 v182, v198, v198
s_lshl_b32 s48, s41, 6
s_add_u32 s80, s80, s48
v_mfma_f32_16x16x32_bf16 v[88:91], v[148:151], v[152:155], v[88:91]
ds_read_b64_tr_b16 v[148:149], v210 offset:36864
ds_read_b64_tr_b16 v[150:151], v210 offset:37376
v_fmac_f32 v183, v199, v199
s_add_u32 s80, s80, 9535488
s_lshl_b32 s48, s41, 4
s_mov_b32 exec_lo, 0xffff0000
s_mov_b32 exec_hi, 0xffffff
buffer_load_dword v225, v226, s[32:35], 0 offen
s_mov_b64 exec, -1
s_waitcnt lgkmcnt(8)
v_mfma_f32_16x16x32_bf16 v[0:3], v[132:135], v[92:95], v[0:3]
s_add_u32 s55, s55, s48
v_mfma_f32_16x16x32_bf16 v[4:7], v[132:135], v[96:99], v[4:7]
s_add_u32 s55, s55, 9437184
v_mfma_f32_16x16x32_bf16 v[8:11], v[132:135], v[100:103], v[8:11]
s_lshl_b32 s57, s59, 10
v_mfma_f32_16x16x32_bf16 v[12:15], v[132:135], v[104:107], v[12:15]
s_waitcnt vmcnt(10)
s_waitcnt lgkmcnt(0)
s_barrier
ds_read_b64_tr_b16 v[132:133], v208 offset:40960
ds_read_b64_tr_b16 v[134:135], v208 offset:41984
s_lshl_b32 s48, s101, 7
v_mfma_f32_16x16x32_bf16 v[16:19], v[136:139], v[92:95], v[16:19]
ds_read_b128 v[156:159], v217 offset:16384
ds_read_b128 v[108:111], v215 offset:16384
ds_read_b128 v[112:115], v215 offset:18432
s_add_u32 m0, s63, 0
s_add_u32 s49, s3, 0
buffer_load_dwordx4 v168, s[32:35], s49 offen lds
s_add_u32 s57, s57, s48
v_mfma_f32_16x16x32_bf16 v[20:23], v[136:139], v[96:99], v[20:23]
ds_read_b128 v[116:119], v215 offset:20480
ds_read_b128 v[120:123], v215 offset:22528
s_add_u32 s57, s57, 9437184
v_mfma_f32_16x16x32_bf16 v[24:27], v[136:139], v[100:103], v[24:27]
s_lshl_b32 s66, s59, 9
v_mfma_f32_16x16x32_bf16 v[28:31], v[136:139], v[104:107], v[28:31]
ds_read_b64_tr_b16 v[136:137], v208 offset:49152
ds_read_b64_tr_b16 v[138:139], v208 offset:50176
s_add_u32 m0, s63, 1024
s_add_u32 s49, s3, 4096
buffer_load_dwordx4 v168, s[32:35], s49 offen lds
s_lshl_b32 s48, s41, 7
v_mfma_f32_16x16x32_bf16 v[32:35], v[140:143], v[92:95], v[32:35]
s_add_u32 s66, s66, s48
v_mfma_f32_16x16x32_bf16 v[36:39], v[140:143], v[96:99], v[36:39]
s_waitcnt lgkmcnt(6)
v_lshlrev_b32 v192, 16, v156
v_and_b32 v193, s58, v156
s_add_u32 s66, s66, 9469952
v_mfma_f32_16x16x32_bf16 v[40:43], v[140:143], v[100:103], v[40:43]
s_add_u32 m0, s63, 2048
s_add_u32 s49, s3, 16384
buffer_load_dwordx4 v168, s[32:35], s49 offen lds
v_lshlrev_b32 v194, 16, v157
v_and_b32 v195, s58, v157
s_lshl_b32 s48, s101, 16
v_mfma_f32_16x16x32_bf16 v[44:47], v[140:143], v[104:107], v[44:47]
v_add_f32 v180, v180, v192
v_add_f32 v181, v181, v193
s_lshl_b32 s68, s62, 7
v_mfma_f32_16x16x32_bf16 v[80:83], v[140:143], v[152:155], v[80:83]
ds_read_b64_tr_b16 v[140:141], v209 offset:40960
ds_read_b64_tr_b16 v[142:143], v209 offset:41984
v_fmac_f32 v182, v192, v192
v_fmac_f32 v183, v193, v193
s_add_u32 s68, s68, s48
v_mfma_f32_16x16x32_bf16 v[48:51], v[144:147], v[92:95], v[48:51]
s_add_u32 m0, s63, 3072
s_add_u32 s49, s3, 20480
buffer_load_dwordx4 v168, s[32:35], s49 offen lds
v_lshlrev_b32 v196, 16, v158
v_and_b32 v197, s58, v158
s_lshl_b32 s69, s41, 14
v_mfma_f32_16x16x32_bf16 v[52:55], v[144:147], v[96:99], v[52:55]
v_add_f32 v180, v180, v194
v_add_f32 v181, v181, v195
s_add_u32 s69, s69, 32768
v_mfma_f32_16x16x32_bf16 v[56:59], v[144:147], v[100:103], v[56:59]
v_fmac_f32 v182, v194, v194
v_fmac_f32 v183, v195, v195
s_sub_u32 s69, s69, s63
v_mfma_f32_16x16x32_bf16 v[60:63], v[144:147], v[104:107], v[60:63]
v_lshlrev_b32 v198, 16, v159
v_and_b32 v199, s58, v159
s_mov_b32 s74, 200000
v_mfma_f32_16x16x32_bf16 v[84:87], v[144:147], v[152:155], v[84:87]
ds_read_b64_tr_b16 v[144:145], v209 offset:49152
ds_read_b64_tr_b16 v[146:147], v209 offset:50176
v_add_f32 v180, v180, v196
v_add_f32 v181, v181, v197
s_lshl_b32 s75, s59, 2
v_mfma_f32_16x16x32_bf16 v[64:67], v[148:151], v[92:95], v[64:67]
v_fmac_f32 v182, v196, v196
v_fmac_f32 v183, v197, v197
s_mul_i32 s76, s101, 5120
v_mfma_f32_16x16x32_bf16 v[68:71], v[148:151], v[96:99], v[68:71]
v_add_f32 v180, v180, v198
s_add_u32 s76, s76, 32768
v_mfma_f32_16x16x32_bf16 v[72:75], v[148:151], v[100:103], v[72:75]
v_add_f32 v181, v181, v199
s_lshl_b32 s77, s101, 11
v_mfma_f32_16x16x32_bf16 v[76:79], v[148:151], v[104:107], v[76:79]
v_fmac_f32 v182, v198, v198
s_add_u32 s77, s77, 16384
v_mfma_f32_16x16x32_bf16 v[88:91], v[148:151], v[152:155], v[88:91]
ds_read_b64_tr_b16 v[148:149], v210 offset:57344
ds_read_b64_tr_b16 v[150:151], v210 offset:57856
v_fmac_f32 v183, v199, v199
s_lshl_b32 s78, s41, 12
s_waitcnt lgkmcnt(8)
v_mfma_f32_16x16x32_bf16 v[0:3], v[132:135], v[108:111], v[0:3]
s_xor_b32 s48, s46, 0
v_mfma_f32_16x16x32_bf16 v[4:7], v[132:135], v[112:115], v[4:7]
s_add_u32 s48, s48, s75
v_mfma_f32_16x16x32_bf16 v[8:11], v[132:135], v[116:119], v[8:11]
s_mul_i32 s48, s48, 73728
v_mfma_f32_16x16x32_bf16 v[12:15], v[132:135], v[120:123], v[12:15]
s_waitcnt vmcnt(7)
s_waitcnt lgkmcnt(0)
s_barrier
ds_read_b64_tr_b16 v[132:133], v211 offset:0
ds_read_b64_tr_b16 v[134:135], v211 offset:1024
s_add_u32 s8, s48, s76
v_mfma_f32_16x16x32_bf16 v[16:19], v[136:139], v[108:111], v[16:19]
ds_read_b128 v[156:159], v216 offset:32768
ds_read_b128 v[92:95], v214 offset:32768
ds_read_b128 v[96:99], v214 offset:34816
s_add_u32 m0, s63, 102400
s_add_u32 s49, s3, 32768
buffer_load_dwordx4 v168, s[32:35], s49 offen lds
s_add_u32 s12, s8, 4096
v_mfma_f32_16x16x32_bf16 v[20:23], v[136:139], v[112:115], v[20:23]
ds_read_b128 v[100:103], v214 offset:36864
ds_read_b128 v[104:107], v214 offset:38912
s_add_u32 s16, s48, s77
v_mfma_f32_16x16x32_bf16 v[24:27], v[136:139], v[116:119], v[24:27]
s_add_u32 s70, s48, s78
v_mfma_f32_16x16x32_bf16 v[28:31], v[136:139], v[120:123], v[28:31]
ds_read_b64_tr_b16 v[136:137], v211 offset:8192
ds_read_b64_tr_b16 v[138:139], v211 offset:9216
s_add_u32 m0, s63, 103424
s_add_u32 s49, s3, 36864
buffer_load_dwordx4 v168, s[32:35], s49 offen lds
s_xor_b32 s48, s46, 1
v_mfma_f32_16x16x32_bf16 v[32:35], v[140:143], v[108:111], v[32:35]
s_add_u32 s48, s48, s75
v_mfma_f32_16x16x32_bf16 v[36:39], v[140:143], v[112:115], v[36:39]
s_waitcnt lgkmcnt(6)
v_lshlrev_b32 v192, 16, v156
v_and_b32 v193, s58, v156
s_mul_i32 s48, s48, 73728
v_mfma_f32_16x16x32_bf16 v[40:43], v[140:143], v[116:119], v[40:43]
s_add_u32 m0, s63, 104448
s_add_u32 s49, s3, 49152
buffer_load_dwordx4 v168, s[32:35], s49 offen lds
v_lshlrev_b32 v194, 16, v157
v_and_b32 v195, s58, v157
s_add_u32 s9, s48, s76
v_mfma_f32_16x16x32_bf16 v[44:47], v[140:143], v[120:123], v[44:47]
v_add_f32 v180, v180, v192
v_add_f32 v181, v181, v193
s_add_u32 s13, s9, 4096
v_mfma_f32_16x16x32_bf16 v[80:83], v[140:143], v[152:155], v[80:83]
ds_read_b64_tr_b16 v[140:141], v212 offset:0
ds_read_b64_tr_b16 v[142:143], v212 offset:1024
v_fmac_f32 v182, v192, v192
v_fmac_f32 v183, v193, v193
s_add_u32 s17, s48, s77
v_mfma_f32_16x16x32_bf16 v[48:51], v[144:147], v[108:111], v[48:51]
s_add_u32 m0, s63, 105472
s_add_u32 s49, s3, 53248
buffer_load_dwordx4 v168, s[32:35], s49 offen lds
v_lshlrev_b32 v196, 16, v158
v_and_b32 v197, s58, v158
s_add_u32 s71, s48, s78
v_mfma_f32_16x16x32_bf16 v[52:55], v[144:147], v[112:115], v[52:55]
v_add_f32 v180, v180, v194
v_add_f32 v181, v181, v195
s_xor_b32 s48, s46, 2
v_mfma_f32_16x16x32_bf16 v[56:59], v[144:147], v[116:119], v[56:59]
v_fmac_f32 v182, v194, v194
v_fmac_f32 v183, v195, v195
s_add_u32 s48, s48, s75
v_mfma_f32_16x16x32_bf16 v[60:63], v[144:147], v[120:123], v[60:63]
v_lshlrev_b32 v198, 16, v159
v_and_b32 v199, s58, v159
s_mul_i32 s48, s48, 73728
v_mfma_f32_16x16x32_bf16 v[84:87], v[144:147], v[152:155], v[84:87]
ds_read_b64_tr_b16 v[144:145], v212 offset:8192
ds_read_b64_tr_b16 v[146:147], v212 offset:9216
v_add_f32 v180, v180, v196
v_add_f32 v181, v181, v197
s_add_u32 s10, s48, s76
v_mfma_f32_16x16x32_bf16 v[64:67], v[148:151], v[108:111], v[64:67]
v_fmac_f32 v182, v196, v196
v_fmac_f32 v183, v197, v197
s_add_u32 s14, s10, 4096
v_mfma_f32_16x16x32_bf16 v[68:71], v[148:151], v[112:115], v[68:71]
v_add_f32 v180, v180, v198
s_add_u32 s18, s48, s77
v_mfma_f32_16x16x32_bf16 v[72:75], v[148:151], v[116:119], v[72:75]
v_add_f32 v181, v181, v199
s_add_u32 s72, s48, s78
v_mfma_f32_16x16x32_bf16 v[76:79], v[148:151], v[120:123], v[76:79]
v_fmac_f32 v182, v198, v198
s_xor_b32 s48, s46, 3
v_mfma_f32_16x16x32_bf16 v[88:91], v[148:151], v[152:155], v[88:91]
ds_read_b64_tr_b16 v[148:149], v213 offset:16384
ds_read_b64_tr_b16 v[150:151], v213 offset:16896
v_fmac_f32 v183, v199, v199
s_add_u32 s48, s48, s75
s_waitcnt lgkmcnt(8)
v_mfma_f32_16x16x32_bf16 v[0:3], v[132:135], v[92:95], v[0:3]
s_mul_i32 s48, s48, 73728
v_mfma_f32_16x16x32_bf16 v[4:7], v[132:135], v[96:99], v[4:7]
s_add_u32 s11, s48, s76
v_mfma_f32_16x16x32_bf16 v[8:11], v[132:135], v[100:103], v[8:11]
s_add_u32 s15, s11, 4096
v_mfma_f32_16x16x32_bf16 v[12:15], v[132:135], v[104:107], v[12:15]
s_waitcnt vmcnt(9)
s_waitcnt lgkmcnt(0)
s_barrier
ds_read_b64_tr_b16 v[132:133], v211 offset:20480
ds_read_b64_tr_b16 v[134:135], v211 offset:21504
s_add_u32 s19, s48, s77
v_mfma_f32_16x16x32_bf16 v[16:19], v[136:139], v[92:95], v[16:19]
ds_read_b128 v[156:159], v217 offset:32768
ds_read_b128 v[108:111], v215 offset:32768
ds_read_b128 v[112:115], v215 offset:34816
s_add_u32 m0, s63, 32768
s_add_u32 s49, s100, 0
buffer_load_dwordx4 v168, s[28:31], s49 offen lds
s_add_u32 s73, s48, s78
v_mfma_f32_16x16x32_bf16 v[20:23], v[136:139], v[96:99], v[20:23]
ds_read_b128 v[116:119], v215 offset:36864
ds_read_b128 v[120:123], v215 offset:38912
v_mfma_f32_16x16x32_bf16 v[24:27], v[136:139], v[100:103], v[24:27]
v_mfma_f32_16x16x32_bf16 v[28:31], v[136:139], v[104:107], v[28:31]
ds_read_b64_tr_b16 v[136:137], v211 offset:28672
ds_read_b64_tr_b16 v[138:139], v211 offset:29696
s_add_u32 m0, s63, 33792
s_add_u32 s49, s100, 4096
buffer_load_dwordx4 v168, s[28:31], s49 offen lds
v_mfma_f32_16x16x32_bf16 v[32:35], v[140:143], v[92:95], v[32:35]
v_mfma_f32_16x16x32_bf16 v[36:39], v[140:143], v[96:99], v[36:39]
s_waitcnt lgkmcnt(6)
v_lshlrev_b32 v192, 16, v156
v_and_b32 v193, s58, v156
v_mfma_f32_16x16x32_bf16 v[40:43], v[140:143], v[100:103], v[40:43]
s_add_u32 m0, s63, 34816
s_add_u32 s49, s100, 16384
buffer_load_dwordx4 v168, s[28:31], s49 offen lds
v_lshlrev_b32 v194, 16, v157
v_and_b32 v195, s58, v157
v_mfma_f32_16x16x32_bf16 v[44:47], v[140:143], v[104:107], v[44:47]
v_add_f32 v180, v180, v192
v_add_f32 v181, v181, v193
v_mfma_f32_16x16x32_bf16 v[80:83], v[140:143], v[152:155], v[80:83]
ds_read_b64_tr_b16 v[140:141], v212 offset:20480
ds_read_b64_tr_b16 v[142:143], v212 offset:21504
v_fmac_f32 v182, v192, v192
v_fmac_f32 v183, v193, v193
v_mfma_f32_16x16x32_bf16 v[48:51], v[144:147], v[92:95], v[48:51]
s_add_u32 m0, s63, 35840
s_add_u32 s49, s100, 20480
buffer_load_dwordx4 v168, s[28:31], s49 offen lds
v_lshlrev_b32 v196, 16, v158
v_and_b32 v197, s58, v158
v_mfma_f32_16x16x32_bf16 v[52:55], v[144:147], v[96:99], v[52:55]
v_add_f32 v180, v180, v194
v_add_f32 v181, v181, v195
v_mfma_f32_16x16x32_bf16 v[56:59], v[144:147], v[100:103], v[56:59]
v_fmac_f32 v182, v194, v194
v_fmac_f32 v183, v195, v195
v_mfma_f32_16x16x32_bf16 v[60:63], v[144:147], v[104:107], v[60:63]
v_lshlrev_b32 v198, 16, v159
v_and_b32 v199, s58, v159
v_mfma_f32_16x16x32_bf16 v[84:87], v[144:147], v[152:155], v[84:87]
ds_read_b64_tr_b16 v[144:145], v212 offset:28672
ds_read_b64_tr_b16 v[146:147], v212 offset:29696
v_add_f32 v180, v180, v196
v_add_f32 v181, v181, v197
v_mfma_f32_16x16x32_bf16 v[64:67], v[148:151], v[92:95], v[64:67]
v_fmac_f32 v182, v196, v196
v_fmac_f32 v183, v197, v197
v_mfma_f32_16x16x32_bf16 v[68:71], v[148:151], v[96:99], v[68:71]
v_add_f32 v180, v180, v198
v_mfma_f32_16x16x32_bf16 v[72:75], v[148:151], v[100:103], v[72:75]
v_add_f32 v181, v181, v199
v_mfma_f32_16x16x32_bf16 v[76:79], v[148:151], v[104:107], v[76:79]
v_fmac_f32 v182, v198, v198
v_mfma_f32_16x16x32_bf16 v[88:91], v[148:151], v[152:155], v[88:91]
ds_read_b64_tr_b16 v[148:149], v213 offset:36864
ds_read_b64_tr_b16 v[150:151], v213 offset:37376
v_fmac_f32 v183, v199, v199
s_waitcnt lgkmcnt(8)
v_mfma_f32_16x16x32_bf16 v[0:3], v[132:135], v[108:111], v[0:3]
v_add_f32 v180, v180, v181
v_add_f32 v181, v182, v183
v_mov_b32 v192, v180
v_mfma_f32_16x16x32_bf16 v[4:7], v[132:135], v[112:115], v[4:7]
v_mov_b32 v193, v181
v_permlane32_swap_b32 v180, v192
s_nop 0
v_permlane32_swap_b32 v181, v193
v_mfma_f32_16x16x32_bf16 v[8:11], v[132:135], v[116:119], v[8:11]
v_add_f32 v180, v180, v192
v_add_f32 v181, v181, v193
v_mov_b32 v192, v180
v_mfma_f32_16x16x32_bf16 v[12:15], v[132:135], v[120:123], v[12:15]
v_mov_b32 v193, v181
v_permlane16_swap_b32 v180, v192
s_nop 0
v_permlane16_swap_b32 v181, v193
s_waitcnt lgkmcnt(6)
v_mfma_f32_16x16x32_bf16 v[16:19], v[136:139], v[108:111], v[16:19]
v_add_f32 v180, v180, v192
v_add_f32 v181, v181, v193
v_mul_f32 v180, 0x3b000000, v180
v_mfma_f32_16x16x32_bf16 v[20:23], v[136:139], v[112:115], v[20:23]
v_mul_f32 v181, 0x3b000000, v181
v_fma_f32 v181, -v180, v180, v181
v_max_f32 v181, 0, v181
v_mfma_f32_16x16x32_bf16 v[24:27], v[136:139], v[116:119], v[24:27]
v_cvt_pk_bf16_f32 v192, v180, v181
v_lshlrev_b32 v180, 16, v192
v_and_b32 v181, 0xffff0000, v192
v_mfma_f32_16x16x32_bf16 v[28:31], v[136:139], v[120:123], v[28:31]
v_add_f32 v181, 0x3727c5ac, v181
v_cvt_pk_bf16_f32 v181, v181, v181
s_waitcnt lgkmcnt(4)
v_mfma_f32_16x16x32_bf16 v[80:83], v[140:143], v[152:155], v[80:83]
v_lshlrev_b32 v181, 16, v181
v_sqrt_f32 v181, v181
s_waitcnt lgkmcnt(2)
v_mfma_f32_16x16x32_bf16 v[84:87], v[144:147], v[152:155], v[84:87]
v_cvt_pk_bf16_f32 v181, v181, v181
v_lshlrev_b32 v181, 16, v181
s_waitcnt lgkmcnt(0)
v_mfma_f32_16x16x32_bf16 v[88:91], v[148:151], v[152:155], v[88:91]
v_rcp_f32 v192, v181
v_xor_b32 v182, 0x80000000, v180
v_mfma_f32_16x16x32_bf16 v[32:35], v[140:143], v[108:111], v[32:35]
v_fma_f32 v181, -v181, v192, 1.0
v_fma_f32 v183, v181, v192, v192
v_mfma_f32_16x16x32_bf16 v[36:39], v[140:143], v[112:115], v[36:39]
s_not_b64 exec, s[60:61]
ds_write_b128 v246, v[80:83] offset:128
ds_write_b128 v246, v[84:87] offset:192
ds_write_b128 v246, v[88:91] offset:256
s_mov_b64 exec, 0xffff
ds_write_b64 v245, v[182:183]
v_lshrrev_b32 v192, 2, v164
buffer_store_dword v183, v192, s[20:23], s80 offen sc0 sc1
s_mov_b64 exec, -1
v_mfma_f32_16x16x32_bf16 v[40:43], v[140:143], v[116:119], v[40:43]
v_mfma_f32_16x16x32_bf16 v[44:47], v[140:143], v[120:123], v[44:47]
v_mfma_f32_16x16x32_bf16 v[48:51], v[144:147], v[108:111], v[48:51]
s_waitcnt lgkmcnt(0)
s_barrier
ds_read_b64 v[228:229], v244 offset:0
ds_read_b64 v[230:231], v244 offset:128
ds_read_b64 v[232:233], v244 offset:256
ds_read_b64 v[234:235], v244 offset:384
ds_read_b128 v[208:211], v246 offset:0
ds_read_b128 v[212:215], v246 offset:64
ds_read_b128 v[216:219], v246 offset:128
ds_read_b128 v[220:223], v246 offset:192
ds_read_b128 v[224:227], v246 offset:256
v_mfma_f32_16x16x32_bf16 v[52:55], v[144:147], v[112:115], v[52:55]
ds_read_b64 v[174:175], v174
v_mfma_f32_16x16x32_bf16 v[56:59], v[144:147], v[116:119], v[56:59]
s_add_u32 m0, s63, 65536
s_add_u32 s49, s100, 262144
buffer_load_dwordx4 v168, s[28:31], s49 offen lds
v_mfma_f32_16x16x32_bf16 v[60:63], v[144:147], v[120:123], v[60:63]
s_add_u32 m0, s63, 66560
s_add_u32 s49, s100, 266240
buffer_load_dwordx4 v168, s[28:31], s49 offen lds
v_mfma_f32_16x16x32_bf16 v[64:67], v[148:151], v[108:111], v[64:67]
s_add_u32 m0, s63, 67584
s_add_u32 s49, s100, 278528
buffer_load_dwordx4 v168, s[28:31], s49 offen lds
v_mfma_f32_16x16x32_bf16 v[68:71], v[148:151], v[112:115], v[68:71]
s_add_u32 m0, s63, 68608
s_add_u32 s49, s100, 282624
buffer_load_dwordx4 v168, s[28:31], s49 offen lds
v_mfma_f32_16x16x32_bf16 v[72:75], v[148:151], v[116:119], v[72:75]
v_mfma_f32_16x16x32_bf16 v[76:79], v[148:151], v[120:123], v[76:79]
L_epi2:
s_waitcnt vmcnt(8) lgkmcnt(0)
ds_read_b64_tr_b16 v[176:177], v169 offset:0
ds_read_b64_tr_b16 v[178:179], v169 offset:1024
ds_read_b64_tr_b16 v[180:181], v170 offset:0
ds_read_b64_tr_b16 v[182:183], v170 offset:1024
ds_read_b64_tr_b16 v[184:185], v171 offset:0
ds_read_b64_tr_b16 v[186:187], v171 offset:1024
ds_read_b64_tr_b16 v[188:189], v172 offset:0
ds_read_b64_tr_b16 v[190:191], v172 offset:1024
ds_read_b64_tr_b16 v[192:193], v248 offset:0
ds_read_b64_tr_b16 v[194:195], v248 offset:1024
ds_read_b64_tr_b16 v[196:197], v249 offset:0
ds_read_b64_tr_b16 v[198:199], v249 offset:1024
ds_read_b64_tr_b16 v[200:201], v250 offset:0
ds_read_b64_tr_b16 v[202:203], v250 offset:1024
ds_read_b64_tr_b16 v[204:205], v251 offset:0
ds_read_b64_tr_b16 v[206:207], v251 offset:1024
v_pk_fma_f32 v[16:17], v[212:213], v[228:229], v[16:17] op_sel_hi:[1,0,1]
v_pk_fma_f32 v[18:19], v[214:215], v[228:229], v[18:19] op_sel_hi:[1,0,1]
v_pk_fma_f32 v[0:1], v[208:209], v[228:229], v[0:1] op_sel_hi:[1,0,1]
v_pk_fma_f32 v[2:3], v[210:211], v[228:229], v[2:3] op_sel_hi:[1,0,1]
v_max_f32 v0, 0, v0
v_max_f32 v1, 0, v1
v_max_f32 v2, 0, v2
v_max_f32 v3, 0, v3
v_pk_mul_f32 v[0:1], v[0:1], v[16:17]
v_pk_mul_f32 v[2:3], v[2:3], v[18:19]
v_cvt_pk_bf16_f32 v92, v0, v1
v_cvt_pk_bf16_f32 v93, v2, v3
v_pk_fma_f32 v[48:49], v[220:221], v[228:229], v[48:49] op_sel_hi:[1,0,1]
v_pk_fma_f32 v[50:51], v[222:223], v[228:229], v[50:51] op_sel_hi:[1,0,1]
v_pk_fma_f32 v[32:33], v[216:217], v[228:229], v[32:33] op_sel_hi:[1,0,1]
v_pk_fma_f32 v[34:35], v[218:219], v[228:229], v[34:35] op_sel_hi:[1,0,1]
v_max_f32 v32, 0, v32
v_max_f32 v33, 0, v33
v_max_f32 v34, 0, v34
v_max_f32 v35, 0, v35
v_pk_mul_f32 v[32:33], v[32:33], v[48:49]
v_pk_mul_f32 v[34:35], v[34:35], v[50:51]
v_cvt_pk_bf16_f32 v94, v32, v33
v_cvt_pk_bf16_f32 v95, v34, v35
s_nop 0
v_permlane16_swap_b32 v92, v94
v_permlane16_swap_b32 v93, v95
buffer_store_dwordx4 v[92:95], v240, s[20:23], s50 offen sc0 sc1
v_pk_fma_f32 v[20:21], v[212:213], v[230:231], v[20:21] op_sel_hi:[1,0,1]
v_pk_fma_f32 v[22:23], v[214:215], v[230:231], v[22:23] op_sel_hi:[1,0,1]
v_pk_fma_f32 v[4:5], v[208:209], v[230:231], v[4:5] op_sel_hi:[1,0,1]
v_pk_fma_f32 v[6:7], v[210:211], v[230:231], v[6:7] op_sel_hi:[1,0,1]
v_max_f32 v4, 0, v4
v_max_f32 v5, 0, v5
v_max_f32 v6, 0, v6
v_max_f32 v7, 0, v7
v_pk_mul_f32 v[4:5], v[4:5], v[20:21]
v_pk_mul_f32 v[6:7], v[6:7], v[22:23]
v_cvt_pk_bf16_f32 v96, v4, v5
v_cvt_pk_bf16_f32 v97, v6, v7
v_pk_fma_f32 v[52:53], v[220:221], v[230:231], v[52:53] op_sel_hi:[1,0,1]
v_pk_fma_f32 v[54:55], v[222:223], v[230:231], v[54:55] op_sel_hi:[1,0,1]
v_pk_fma_f32 v[36:37], v[216:217], v[230:231], v[36:37] op_sel_hi:[1,0,1]
v_pk_fma_f32 v[38:39], v[218:219], v[230:231], v[38:39] op_sel_hi:[1,0,1]
v_max_f32 v36, 0, v36
v_max_f32 v37, 0, v37
v_max_f32 v38, 0, v38
v_max_f32 v39, 0, v39
v_pk_mul_f32 v[36:37], v[36:37], v[52:53]
v_pk_mul_f32 v[38:39], v[38:39], v[54:55]
v_cvt_pk_bf16_f32 v98, v36, v37
v_cvt_pk_bf16_f32 v99, v38, v39
s_nop 0
v_permlane16_swap_b32 v96, v98
v_permlane16_swap_b32 v97, v99
buffer_store_dwordx4 v[96:99], v240, s[20:23], s51 offen sc0 sc1
v_pk_fma_f32 v[24:25], v[212:213], v[232:233], v[24:25] op_sel_hi:[1,0,1]
v_pk_fma_f32 v[26:27], v[214:215], v[232:233], v[26:27] op_sel_hi:[1,0,1]
v_pk_fma_f32 v[8:9], v[208:209], v[232:233], v[8:9] op_sel_hi:[1,0,1]
v_pk_fma_f32 v[10:11], v[210:211], v[232:233], v[10:11] op_sel_hi:[1,0,1]
v_max_f32 v8, 0, v8
v_max_f32 v9, 0, v9
v_max_f32 v10, 0, v10
v_max_f32 v11, 0, v11
v_pk_mul_f32 v[8:9], v[8:9], v[24:25]
v_pk_mul_f32 v[10:11], v[10:11], v[26:27]
v_cvt_pk_bf16_f32 v100, v8, v9
v_cvt_pk_bf16_f32 v101, v10, v11
v_pk_fma_f32 v[56:57], v[220:221], v[232:233], v[56:57] op_sel_hi:[1,0,1]
v_pk_fma_f32 v[58:59], v[222:223], v[232:233], v[58:59] op_sel_hi:[1,0,1]
v_pk_fma_f32 v[40:41], v[216:217], v[232:233], v[40:41] op_sel_hi:[1,0,1]
v_pk_fma_f32 v[42:43], v[218:219], v[232:233], v[42:43] op_sel_hi:[1,0,1]
v_max_f32 v40, 0, v40
v_max_f32 v41, 0, v41
v_max_f32 v42, 0, v42
v_max_f32 v43, 0, v43
v_pk_mul_f32 v[40:41], v[40:41], v[56:57]
v_pk_mul_f32 v[42:43], v[42:43], v[58:59]
v_cvt_pk_bf16_f32 v102, v40, v41
v_cvt_pk_bf16_f32 v103, v42, v43
s_nop 0
v_permlane16_swap_b32 v100, v102
v_permlane16_swap_b32 v101, v103
buffer_store_dwordx4 v[100:103], v240, s[20:23], s52 offen sc0 sc1
v_pk_fma_f32 v[28:29], v[212:213], v[234:235], v[28:29] op_sel_hi:[1,0,1]
v_pk_fma_f32 v[30:31], v[214:215], v[234:235], v[30:31] op_sel_hi:[1,0,1]
v_pk_fma_f32 v[12:13], v[208:209], v[234:235], v[12:13] op_sel_hi:[1,0,1]
v_pk_fma_f32 v[14:15], v[210:211], v[234:235], v[14:15] op_sel_hi:[1,0,1]
v_max_f32 v12, 0, v12
v_max_f32 v13, 0, v13
v_max_f32 v14, 0, v14
v_max_f32 v15, 0, v15
v_pk_mul_f32 v[12:13], v[12:13], v[28:29]
v_pk_mul_f32 v[14:15], v[14:15], v[30:31]
v_cvt_pk_bf16_f32 v104, v12, v13
v_cvt_pk_bf16_f32 v105, v14, v15
v_pk_fma_f32 v[60:61], v[220:221], v[234:235], v[60:61] op_sel_hi:[1,0,1]
v_pk_fma_f32 v[62:63], v[222:223], v[234:235], v[62:63] op_sel_hi:[1,0,1]
v_pk_fma_f32 v[44:45], v[216:217], v[234:235], v[44:45] op_sel_hi:[1,0,1]
v_pk_fma_f32 v[46:47], v[218:219], v[234:235], v[46:47] op_sel_hi:[1,0,1]
v_max_f32 v44, 0, v44
v_max_f32 v45, 0, v45
v_max_f32 v46, 0, v46
v_max_f32 v47, 0, v47
v_pk_mul_f32 v[44:45], v[44:45], v[60:61]
v_pk_mul_f32 v[46:47], v[46:47], v[62:63]
v_cvt_pk_bf16_f32 v106, v44, v45
v_cvt_pk_bf16_f32 v107, v46, v47
s_nop 0
v_permlane16_swap_b32 v104, v106
v_permlane16_swap_b32 v105, v107
buffer_store_dwordx4 v[104:107], v240, s[20:23], s53 offen sc0 sc1
v_pk_fma_f32 v[64:65], v[224:225], v[228:229], v[64:65] op_sel_hi:[1,0,1]
v_pk_fma_f32 v[66:67], v[226:227], v[228:229], v[66:67] op_sel_hi:[1,0,1]
v_pk_fma_f32 v[68:69], v[224:225], v[230:231], v[68:69] op_sel_hi:[1,0,1]
v_pk_fma_f32 v[70:71], v[226:227], v[230:231], v[70:71] op_sel_hi:[1,0,1]
v_pk_fma_f32 v[72:73], v[224:225], v[232:233], v[72:73] op_sel_hi:[1,0,1]
v_pk_fma_f32 v[74:75], v[226:227], v[232:233], v[74:75] op_sel_hi:[1,0,1]
v_pk_fma_f32 v[76:77], v[224:225], v[234:235], v[76:77] op_sel_hi:[1,0,1]
v_pk_fma_f32 v[78:79], v[226:227], v[234:235], v[78:79] op_sel_hi:[1,0,1]
v_permlane32_swap_b32 v64, v68
v_permlane32_swap_b32 v65, v69
v_permlane32_swap_b32 v66, v70
v_permlane32_swap_b32 v67, v71
v_permlane32_swap_b32 v72, v76
v_permlane32_swap_b32 v73, v77
v_permlane32_swap_b32 v74, v78
v_permlane32_swap_b32 v75, v79
v_max_f32 v64, 0, v64
v_max_f32 v65, 0, v65
v_max_f32 v66, 0, v66
v_max_f32 v67, 0, v67
v_pk_mul_f32 v[64:65], v[64:65], v[68:69]
v_pk_mul_f32 v[66:67], v[66:67], v[70:71]
v_cvt_pk_bf16_f32 v108, v64, v65
v_cvt_pk_bf16_f32 v109, v66, v67
v_max_f32 v72, 0, v72
v_max_f32 v73, 0, v73
v_max_f32 v74, 0, v74
v_max_f32 v75, 0, v75
v_pk_mul_f32 v[72:73], v[72:73], v[76:77]
v_pk_mul_f32 v[74:75], v[74:75], v[78:79]
v_cvt_pk_bf16_f32 v110, v72, v73
v_cvt_pk_bf16_f32 v111, v74, v75
s_nop 0
v_permlane16_swap_b32 v108, v110
v_permlane16_swap_b32 v109, v111
buffer_store_dwordx4 v[108:111], v241, s[20:23], s54 offen sc0 sc1
v_readfirstlane_b32 s64, v174
v_readfirstlane_b32 s65, v175
s_cmp_lg_u32 s42, 0
s_cbranch_scc1 L_e2a
s_waitcnt vmcnt(0)
s_mov_b64 exec, 1
buffer_store_dwordx2 v[174:175], v164, s[20:23], s55 offen sc0 sc1
s_mov_b64 exec, -1
s_waitcnt lgkmcnt(0)
s_add_u32 m0, s63, 0
s_add_u32 s49, s3, 65536
buffer_load_dwordx4 v168, s[32:35], s49 offen lds
s_add_u32 m0, s63, 1024
s_add_u32 s49, s3, 69632
buffer_load_dwordx4 v168, s[32:35], s49 offen lds
s_add_u32 m0, s63, 2048
s_add_u32 s49, s3, 81920
buffer_load_dwordx4 v168, s[32:35], s49 offen lds
s_add_u32 m0, s63, 3072
s_add_u32 s49, s3, 86016
buffer_load_dwordx4 v168, s[32:35], s49 offen lds
s_add_u32 m0, s63, 102400
s_add_u32 s49, s3, 98304
buffer_load_dwordx4 v168, s[32:35], s49 offen lds
s_add_u32 m0, s63, 103424
s_add_u32 s49, s3, 102400
buffer_load_dwordx4 v168, s[32:35], s49 offen lds
s_add_u32 m0, s63, 104448
s_add_u32 s49, s3, 114688
buffer_load_dwordx4 v168, s[32:35], s49 offen lds
s_add_u32 m0, s63, 105472
s_add_u32 s49, s3, 118784
buffer_load_dwordx4 v168, s[32:35], s49 offen lds
s_waitcnt vmcnt(0)
s_branch L_e2b
L_e2a:
s_waitcnt lgkmcnt(0)
s_add_u32 m0, s63, 0
s_add_u32 s49, s3, 65536
buffer_load_dwordx4 v168, s[32:35], s49 offen lds
s_add_u32 m0, s63, 1024
s_add_u32 s49, s3, 69632
buffer_load_dwordx4 v168, s[32:35], s49 offen lds
s_add_u32 m0, s63, 2048
s_add_u32 s49, s3, 81920
buffer_load_dwordx4 v168, s[32:35], s49 offen lds
s_add_u32 m0, s63, 3072
s_add_u32 s49, s3, 86016
buffer_load_dwordx4 v168, s[32:35], s49 offen lds
s_add_u32 m0, s63, 102400
s_add_u32 s49, s3, 98304
buffer_load_dwordx4 v168, s[32:35], s49 offen lds
s_add_u32 m0, s63, 103424
s_add_u32 s49, s3, 102400
buffer_load_dwordx4 v168, s[32:35], s49 offen lds
s_add_u32 m0, s63, 104448
s_add_u32 s49, s3, 114688
buffer_load_dwordx4 v168, s[32:35], s49 offen lds
s_add_u32 m0, s63, 105472
s_add_u32 s49, s3, 118784
buffer_load_dwordx4 v168, s[32:35], s49 offen lds
s_waitcnt vmcnt(8)
s_mov_b64 exec, 1
buffer_store_dwordx2 v[174:175], v164, s[20:23], s55 offen sc0 sc1
s_mov_b64 exec, -1
s_waitcnt vmcnt(1)
L_e2b:
ds_read_b64_tr_b16 v[208:209], v169 offset:0
ds_read_b64_tr_b16 v[210:211], v169 offset:1024
ds_read_b64_tr_b16 v[212:213], v170 offset:0
ds_read_b64_tr_b16 v[214:215], v170 offset:1024
ds_read_b64_tr_b16 v[216:217], v171 offset:0
ds_read_b64_tr_b16 v[218:219], v171 offset:1024
ds_read_b64_tr_b16 v[220:221], v172 offset:0
ds_read_b64_tr_b16 v[222:223], v172 offset:1024
ds_read_b64_tr_b16 v[224:225], v248 offset:0
ds_read_b64_tr_b16 v[226:227], v248 offset:1024
ds_read_b64_tr_b16 v[228:229], v249 offset:0
ds_read_b64_tr_b16 v[230:231], v249 offset:1024
ds_read_b64_tr_b16 v[232:233], v250 offset:0
ds_read_b64_tr_b16 v[234:235], v250 offset:1024
ds_read_b64_tr_b16 v[236:237], v251 offset:0
ds_read_b64_tr_b16 v[238:239], v251 offset:1024
buffer_load_dwordx4 v[160:163], v165, s[4:7], s67 offen
s_waitcnt lgkmcnt(0)
s_add_u32 m0, s63, 0
s_add_u32 s49, s3, 131072
buffer_load_dwordx4 v168, s[32:35], s49 offen lds
s_add_u32 m0, s63, 1024
s_add_u32 s49, s3, 135168
buffer_load_dwordx4 v168, s[32:35], s49 offen lds
s_add_u32 m0, s63, 2048
s_add_u32 s49, s3, 147456
buffer_load_dwordx4 v168, s[32:35], s49 offen lds
s_add_u32 m0, s63, 3072
s_add_u32 s49, s3, 151552
buffer_load_dwordx4 v168, s[32:35], s49 offen lds
s_add_u32 m0, s63, 102400
s_add_u32 s49, s68, 0
buffer_load_dwordx4 v168, s[32:35], s49 offen lds
s_add_u32 m0, s63, 103424
s_add_u32 s49, s68, 4096
buffer_load_dwordx4 v168, s[32:35], s49 offen lds
s_add_u32 m0, s63, 104448
s_add_u32 s49, s68, 16384
buffer_load_dwordx4 v168, s[32:35], s49 offen lds
s_add_u32 m0, s63, 105472
s_add_u32 s49, s68, 20480
buffer_load_dwordx4 v168, s[32:35], s49 offen lds
s_barrier
s_waitcnt vmcnt(4)
ds_read_b64_tr_b16 v[240:241], v169 offset:0
ds_read_b64_tr_b16 v[242:243], v169 offset:1024
ds_read_b64_tr_b16 v[244:245], v170 offset:0
ds_read_b64_tr_b16 v[246:247], v170 offset:1024
ds_read_b64_tr_b16 v[248:249], v171 offset:0
ds_read_b64_tr_b16 v[250:251], v171 offset:1024
ds_read_b64_tr_b16 v[252:253], v172 offset:0
ds_read_b64_tr_b16 v[254:255], v172 offset:1024
s_waitcnt lgkmcnt(0)
s_add_u32 m0, s63, 0
s_add_u32 s49, s68, 32768
buffer_load_dwordx4 v168, s[32:35], s49 offen lds
s_add_u32 m0, s63, 1024
s_add_u32 s49, s68, 36864
buffer_load_dwordx4 v168, s[32:35], s49 offen lds
s_add_u32 m0, s63, 2048
s_add_u32 s49, s68, 49152
buffer_load_dwordx4 v168, s[32:35], s49 offen lds
s_add_u32 m0, s63, 3072
s_add_u32 s49, s68, 53248
buffer_load_dwordx4 v168, s[32:35], s49 offen lds
L_poll0:
L_poll:
s_mov_b64 exec, 0xff
buffer_load_dwordx2 v[174:175], v164, s[20:23], s57 offen sc0 sc1
s_mov_b64 exec, -1
s_waitcnt vmcnt(0)
s_sub_u32 s74, s74, 1
s_cmp_lt_i32 s74, 0
s_cbranch_scc1 L_poll_x
v_cmp_eq_u64 vcc, s[64:65], v[174:175]
s_and_b32 s45, vcc_lo, 0xff
s_cmp_eq_u32 s45, 0xff
s_cbranch_scc0 L_poll
L_poll_x:
L_loads:
v_bfe_u32 v174, v164, 4, 4
v_lshlrev_b32 v174, 2, v174
buffer_load_dword v174, v174, s[20:23], s82 offen
buffer_load_dwordx4 v[64:67], v164, s[20:23], s8 offen offset:0
buffer_load_dwordx4 v[68:71], v164, s[20:23], s9 offen offset:0
buffer_load_dwordx4 v[72:75], v164, s[20:23], s10 offen offset:0
buffer_load_dwordx4 v[76:79], v164, s[20:23], s11 offen offset:0
buffer_load_dwordx4 v[80:83], v164, s[20:23], s8 offen offset:1024
buffer_load_dwordx4 v[84:87], v164, s[20:23], s9 offen offset:1024
buffer_load_dwordx4 v[88:91], v164, s[20:23], s10 offen offset:1024
buffer_load_dwordx4 v[92:95], v164, s[20:23], s11 offen offset:1024
s_cmp_lg_u32 s42, 0
s_cbranch_scc1 L_lw
buffer_load_dwordx4 v[96:99], v164, s[20:23], s8 offen offset:2048
buffer_load_dwordx4 v[100:103], v164, s[20:23], s9 offen offset:2048
buffer_load_dwordx4 v[104:107], v164, s[20:23], s10 offen offset:2048
buffer_load_dwordx4 v[108:111], v164, s[20:23], s11 offen offset:2048
buffer_load_dwordx4 v[112:115], v164, s[20:23], s8 offen offset:3072
buffer_load_dwordx4 v[116:119], v164, s[20:23], s9 offen offset:3072
buffer_load_dwordx4 v[120:123], v164, s[20:23], s10 offen offset:3072
buffer_load_dwordx4 v[124:127], v164, s[20:23], s11 offen offset:3072
s_waitcnt vmcnt(12)
v_mfma_f32_16x16x32_bf16 v[0:3], v[176:179], v[64:67], 0
v_add_u32 v166, 102400, v169
v_mfma_f32_16x16x32_bf16 v[4:7], v[180:183], v[64:67], 0
v_add_u32 v167, 102400, v170
buffer_load_dwordx4 v[128:131], v164, s[20:23], s12 offen offset:0
v_mfma_f32_16x16x32_bf16 v[8:11], v[184:187], v[64:67], 0
v_add_u32 v173, 102400, v171
v_mfma_f32_16x16x32_bf16 v[12:15], v[188:191], v[64:67], 0
v_add_u32 v168, 102400, v172
v_mfma_f32_16x16x32_bf16 v[16:19], v[176:179], v[68:71], 0
s_add_u32 s52, s20, s66
v_mfma_f32_16x16x32_bf16 v[20:23], v[180:183], v[68:71], 0
s_addc_u32 s53, s21, 0
buffer_load_dwordx4 v[132:135], v164, s[20:23], s13 offen offset:0
v_mfma_f32_16x16x32_bf16 v[24:27], v[184:187], v[68:71], 0
v_mfma_f32_16x16x32_bf16 v[28:31], v[188:191], v[68:71], 0
v_mfma_f32_16x16x32_bf16 v[32:35], v[176:179], v[72:75], 0
v_mfma_f32_16x16x32_bf16 v[36:39], v[180:183], v[72:75], 0
buffer_load_dwordx4 v[136:139], v164, s[20:23], s14 offen offset:0
v_mfma_f32_16x16x32_bf16 v[40:43], v[184:187], v[72:75], 0
v_mfma_f32_16x16x32_bf16 v[44:47], v[188:191], v[72:75], 0
v_mfma_f32_16x16x32_bf16 v[48:51], v[176:179], v[76:79], 0
v_mfma_f32_16x16x32_bf16 v[52:55], v[180:183], v[76:79], 0
buffer_load_dwordx4 v[140:143], v164, s[20:23], s15 offen offset:0
v_mfma_f32_16x16x32_bf16 v[56:59], v[184:187], v[76:79], 0
v_mfma_f32_16x16x32_bf16 v[60:63], v[188:191], v[76:79], 0
ds_read_b64_tr_b16 v[176:177], v166 offset:0
ds_read_b64_tr_b16 v[178:179], v166 offset:1024
ds_read_b64_tr_b16 v[180:181], v167 offset:0
ds_read_b64_tr_b16 v[182:183], v167 offset:1024
ds_read_b64_tr_b16 v[184:185], v173 offset:0
ds_read_b64_tr_b16 v[186:187], v173 offset:1024
ds_read_b64_tr_b16 v[188:189], v168 offset:0
ds_read_b64_tr_b16 v[190:191], v168 offset:1024
s_waitcnt vmcnt(12)
v_mfma_f32_16x16x32_bf16 v[0:3], v[192:195], v[80:83], v[0:3]
v_add_u32 v166, s69, v169
v_mfma_f32_16x16x32_bf16 v[4:7], v[196:199], v[80:83], v[4:7]
v_add_u32 v167, s69, v170
buffer_load_dwordx4 v[144:147], v164, s[20:23], s16 offen offset:0
v_mfma_f32_16x16x32_bf16 v[8:11], v[200:203], v[80:83], v[8:11]
v_add_u32 v173, s69, v171
v_mfma_f32_16x16x32_bf16 v[12:15], v[204:207], v[80:83], v[12:15]
v_add_u32 v168, s69, v172
v_mfma_f32_16x16x32_bf16 v[16:19], v[192:195], v[84:87], v[16:19]
v_mfma_f32_16x16x32_bf16 v[20:23], v[196:199], v[84:87], v[20:23]
buffer_load_dwordx4 v[148:151], v164, s[20:23], s17 offen offset:0
v_mfma_f32_16x16x32_bf16 v[24:27], v[200:203], v[84:87], v[24:27]
v_mfma_f32_16x16x32_bf16 v[28:31], v[204:207], v[84:87], v[28:31]
v_mfma_f32_16x16x32_bf16 v[32:35], v[192:195], v[88:91], v[32:35]
v_mfma_f32_16x16x32_bf16 v[36:39], v[196:199], v[88:91], v[36:39]
buffer_load_dwordx4 v[152:155], v164, s[20:23], s18 offen offset:0
v_mfma_f32_16x16x32_bf16 v[40:43], v[200:203], v[88:91], v[40:43]
v_mfma_f32_16x16x32_bf16 v[44:47], v[204:207], v[88:91], v[44:47]
v_mfma_f32_16x16x32_bf16 v[48:51], v[192:195], v[92:95], v[48:51]
v_mfma_f32_16x16x32_bf16 v[52:55], v[196:199], v[92:95], v[52:55]
buffer_load_dwordx4 v[156:159], v164, s[20:23], s19 offen offset:0
v_mfma_f32_16x16x32_bf16 v[56:59], v[200:203], v[92:95], v[56:59]
v_mfma_f32_16x16x32_bf16 v[60:63], v[204:207], v[92:95], v[60:63]
ds_read_b64_tr_b16 v[192:193], v169 offset:0
ds_read_b64_tr_b16 v[194:195], v169 offset:1024
ds_read_b64_tr_b16 v[196:197], v170 offset:0
ds_read_b64_tr_b16 v[198:199], v170 offset:1024
ds_read_b64_tr_b16 v[200:201], v171 offset:0
ds_read_b64_tr_b16 v[202:203], v171 offset:1024
ds_read_b64_tr_b16 v[204:205], v172 offset:0
ds_read_b64_tr_b16 v[206:207], v172 offset:1024
s_load_dwordx2 s[24:25], s[52:53], 0
s_load_dwordx2 s[26:27], s[52:53], 16
s_load_dwordx2 s[28:29], s[52:53], 32
s_load_dwordx2 s[30:31], s[52:53], 48
s_load_dwordx2 s[32:33], s[52:53], 64
s_load_dwordx2 s[34:35], s[52:53], 80
s_load_dwordx2 s[48:49], s[52:53], 96
s_load_dwordx2 s[50:51], s[52:53], 112
s_waitcnt vmcnt(12)
v_mfma_f32_16x16x32_bf16 v[0:3], v[208:211], v[96:99], v[0:3]
v_mfma_f32_16x16x32_bf16 v[4:7], v[212:215], v[96:99], v[4:7]
buffer_load_dwordx4 v[64:67], v164, s[20:23], s16 offen offset:1024
v_mfma_f32_16x16x32_bf16 v[8:11], v[216:219], v[96:99], v[8:11]
v_mfma_f32_16x16x32_bf16 v[12:15], v[220:223], v[96:99], v[12:15]
v_mfma_f32_16x16x32_bf16 v[16:19], v[208:211], v[100:103], v[16:19]
v_mfma_f32_16x16x32_bf16 v[20:23], v[212:215], v[100:103], v[20:23]
buffer_load_dwordx4 v[68:71], v164, s[20:23], s17 offen offset:1024
v_mfma_f32_16x16x32_bf16 v[24:27], v[216:219], v[100:103], v[24:27]
v_mfma_f32_16x16x32_bf16 v[28:31], v[220:223], v[100:103], v[28:31]
v_mfma_f32_16x16x32_bf16 v[32:35], v[208:211], v[104:107], v[32:35]
v_mfma_f32_16x16x32_bf16 v[36:39], v[212:215], v[104:107], v[36:39]
buffer_load_dwordx4 v[72:75], v164, s[20:23], s18 offen offset:1024
v_mfma_f32_16x16x32_bf16 v[40:43], v[216:219], v[104:107], v[40:43]
v_mfma_f32_16x16x32_bf16 v[44:47], v[220:223], v[104:107], v[44:47]
v_mfma_f32_16x16x32_bf16 v[48:51], v[208:211], v[108:111], v[48:51]
v_mfma_f32_16x16x32_bf16 v[52:55], v[212:215], v[108:111], v[52:55]
buffer_load_dwordx4 v[76:79], v164, s[20:23], s19 offen offset:1024
v_mfma_f32_16x16x32_bf16 v[56:59], v[216:219], v[108:111], v[56:59]
v_mfma_f32_16x16x32_bf16 v[60:63], v[220:223], v[108:111], v[60:63]
ds_read_b64_tr_b16 v[208:209], v166 offset:0
ds_read_b64_tr_b16 v[210:211], v166 offset:1024
ds_read_b64_tr_b16 v[212:213], v167 offset:0
ds_read_b64_tr_b16 v[214:215], v167 offset:1024
ds_read_b64_tr_b16 v[216:217], v173 offset:0
ds_read_b64_tr_b16 v[218:219], v173 offset:1024
ds_read_b64_tr_b16 v[220:221], v168 offset:0
ds_read_b64_tr_b16 v[222:223], v168 offset:1024
s_waitcnt vmcnt(12)
v_mfma_f32_16x16x32_bf16 v[0:3], v[224:227], v[112:115], v[0:3]
v_mfma_f32_16x16x32_bf16 v[4:7], v[228:231], v[112:115], v[4:7]
v_mfma_f32_16x16x32_bf16 v[8:11], v[232:235], v[112:115], v[8:11]
v_mfma_f32_16x16x32_bf16 v[12:15], v[236:239], v[112:115], v[12:15]
v_mfma_f32_16x16x32_bf16 v[16:19], v[224:227], v[116:119], v[16:19]
v_mfma_f32_16x16x32_bf16 v[20:23], v[228:231], v[116:119], v[20:23]
v_mfma_f32_16x16x32_bf16 v[24:27], v[232:235], v[116:119], v[24:27]
v_mfma_f32_16x16x32_bf16 v[28:31], v[236:239], v[116:119], v[28:31]
v_mfma_f32_16x16x32_bf16 v[32:35], v[224:227], v[120:123], v[32:35]
v_mfma_f32_16x16x32_bf16 v[36:39], v[228:231], v[120:123], v[36:39]
v_mfma_f32_16x16x32_bf16 v[40:43], v[232:235], v[120:123], v[40:43]
v_mfma_f32_16x16x32_bf16 v[44:47], v[236:239], v[120:123], v[44:47]
v_mfma_f32_16x16x32_bf16 v[48:51], v[224:227], v[124:127], v[48:51]
v_mfma_f32_16x16x32_bf16 v[52:55], v[228:231], v[124:127], v[52:55]
v_mfma_f32_16x16x32_bf16 v[56:59], v[232:235], v[124:127], v[56:59]
v_mfma_f32_16x16x32_bf16 v[60:63], v[236:239], v[124:127], v[60:63]
ds_read_b64_tr_b16 v[224:225], v166 offset:4096
ds_read_b64_tr_b16 v[226:227], v166 offset:5120
ds_read_b64_tr_b16 v[228:229], v167 offset:4096
ds_read_b64_tr_b16 v[230:231], v167 offset:5120
ds_read_b64_tr_b16 v[232:233], v173 offset:4096
ds_read_b64_tr_b16 v[234:235], v173 offset:5120
ds_read_b64_tr_b16 v[236:237], v168 offset:4096
ds_read_b64_tr_b16 v[238:239], v168 offset:5120
s_waitcnt vmcnt(8)
v_mfma_f32_16x16x32_bf16 v[0:3], v[240:243], v[128:131], v[0:3]
v_mfma_f32_16x16x32_bf16 v[4:7], v[244:247], v[128:131], v[4:7]
v_mfma_f32_16x16x32_bf16 v[8:11], v[248:251], v[128:131], v[8:11]
v_mfma_f32_16x16x32_bf16 v[12:15], v[252:255], v[128:131], v[12:15]
v_mfma_f32_16x16x32_bf16 v[16:19], v[240:243], v[132:135], v[16:19]
v_mfma_f32_16x16x32_bf16 v[20:23], v[244:247], v[132:135], v[20:23]
v_mfma_f32_16x16x32_bf16 v[24:27], v[248:251], v[132:135], v[24:27]
v_mfma_f32_16x16x32_bf16 v[28:31], v[252:255], v[132:135], v[28:31]
v_mfma_f32_16x16x32_bf16 v[32:35], v[240:243], v[136:139], v[32:35]
v_mfma_f32_16x16x32_bf16 v[36:39], v[244:247], v[136:139], v[36:39]
v_mfma_f32_16x16x32_bf16 v[40:43], v[248:251], v[136:139], v[40:43]
v_mfma_f32_16x16x32_bf16 v[44:47], v[252:255], v[136:139], v[44:47]
v_mfma_f32_16x16x32_bf16 v[48:51], v[240:243], v[140:143], v[48:51]
v_mfma_f32_16x16x32_bf16 v[52:55], v[244:247], v[140:143], v[52:55]
v_mfma_f32_16x16x32_bf16 v[56:59], v[248:251], v[140:143], v[56:59]
v_mfma_f32_16x16x32_bf16 v[60:63], v[252:255], v[140:143], v[60:63]
ds_read_b64_tr_b16 v[240:241], v166 offset:8192
ds_read_b64_tr_b16 v[242:243], v166 offset:9216
ds_read_b64_tr_b16 v[244:245], v167 offset:8192
ds_read_b64_tr_b16 v[246:247], v167 offset:9216
ds_read_b64_tr_b16 v[248:249], v173 offset:8192
ds_read_b64_tr_b16 v[250:251], v173 offset:9216
ds_read_b64_tr_b16 v[252:253], v168 offset:8192
ds_read_b64_tr_b16 v[254:255], v168 offset:9216
s_waitcnt lgkmcnt(0)
s_xor_b64 s[24:25], s[24:25], s[64:65]
s_xor_b64 s[26:27], s[26:27], s[64:65]
s_xor_b64 s[28:29], s[28:29], s[64:65]
s_xor_b64 s[30:31], s[30:31], s[64:65]
s_xor_b64 s[32:33], s[32:33], s[64:65]
s_xor_b64 s[34:35], s[34:35], s[64:65]
s_xor_b64 s[48:49], s[48:49], s[64:65]
s_xor_b64 s[50:51], s[50:51], s[64:65]
s_or_b64 s[24:25], s[24:25], s[26:27]
s_or_b64 s[24:25], s[24:25], s[28:29]
s_or_b64 s[24:25], s[24:25], s[30:31]
s_or_b64 s[24:25], s[24:25], s[32:33]
s_or_b64 s[24:25], s[24:25], s[34:35]
s_or_b64 s[24:25], s[24:25], s[48:49]
s_or_b64 s[24:25], s[24:25], s[50:51]
s_cselect_b64 s[4:5], 0, -1
s_cselect_b32 s83, 0, 1
s_cbranch_scc0 L_oa
s_load_dwordx2 s[24:25], s[52:53], 16384
s_load_dwordx2 s[26:27], s[52:53], 16400
s_load_dwordx2 s[28:29], s[52:53], 16416
s_load_dwordx2 s[30:31], s[52:53], 16432
s_load_dwordx2 s[32:33], s[52:53], 16448
s_load_dwordx2 s[34:35], s[52:53], 16464
s_load_dwordx2 s[48:49], s[52:53], 16480
s_load_dwordx2 s[50:51], s[52:53], 16496
L_oa:
s_waitcnt vmcnt(4)
v_mfma_f32_16x16x32_bf16 v[0:3], v[176:179], v[144:147], v[0:3]
v_mfma_f32_16x16x32_bf16 v[4:7], v[180:183], v[144:147], v[4:7]
s_mov_b64 exec, s[4:5]
buffer_load_dwordx4 v[80:83], v164, s[20:23], s70 offen offset:0
s_mov_b64 exec, -1
v_mfma_f32_16x16x32_bf16 v[8:11], v[184:187], v[144:147], v[8:11]
v_mfma_f32_16x16x32_bf16 v[12:15], v[188:191], v[144:147], v[12:15]
s_mov_b64 exec, s[4:5]
buffer_load_dwordx4 v[84:87], v164, s[20:23], s71 offen offset:0
s_mov_b64 exec, -1
v_mfma_f32_16x16x32_bf16 v[16:19], v[176:179], v[148:151], v[16:19]
v_mfma_f32_16x16x32_bf16 v[20:23], v[180:183], v[148:151], v[20:23]
s_mov_b64 exec, s[4:5]
buffer_load_dwordx4 v[88:91], v164, s[20:23], s72 offen offset:0
s_mov_b64 exec, -1
v_mfma_f32_16x16x32_bf16 v[24:27], v[184:187], v[148:151], v[24:27]
v_mfma_f32_16x16x32_bf16 v[28:31], v[188:191], v[148:151], v[28:31]
s_mov_b64 exec, s[4:5]
buffer_load_dwordx4 v[92:95], v164, s[20:23], s73 offen offset:0
s_mov_b64 exec, -1
v_mfma_f32_16x16x32_bf16 v[32:35], v[176:179], v[152:155], v[32:35]
v_mfma_f32_16x16x32_bf16 v[36:39], v[180:183], v[152:155], v[36:39]
s_mov_b64 exec, s[4:5]
buffer_load_dwordx4 v[96:99], v164, s[20:23], s70 offen offset:1024
s_mov_b64 exec, -1
v_mfma_f32_16x16x32_bf16 v[40:43], v[184:187], v[152:155], v[40:43]
v_mfma_f32_16x16x32_bf16 v[44:47], v[188:191], v[152:155], v[44:47]
s_mov_b64 exec, s[4:5]
buffer_load_dwordx4 v[100:103], v164, s[20:23], s71 offen offset:1024
s_mov_b64 exec, -1
v_mfma_f32_16x16x32_bf16 v[48:51], v[176:179], v[156:159], v[48:51]
v_mfma_f32_16x16x32_bf16 v[52:55], v[180:183], v[156:159], v[52:55]
s_mov_b64 exec, s[4:5]
buffer_load_dwordx4 v[104:107], v164, s[20:23], s72 offen offset:1024
s_mov_b64 exec, -1
v_mfma_f32_16x16x32_bf16 v[56:59], v[184:187], v[156:159], v[56:59]
v_mfma_f32_16x16x32_bf16 v[60:63], v[188:191], v[156:159], v[60:63]
s_mov_b64 exec, s[4:5]
buffer_load_dwordx4 v[108:111], v164, s[20:23], s73 offen offset:1024
s_mov_b64 exec, -1
ds_read_b64_tr_b16 v[176:177], v166 offset:12288
ds_read_b64_tr_b16 v[178:179], v166 offset:13312
ds_read_b64_tr_b16 v[180:181], v167 offset:12288
ds_read_b64_tr_b16 v[182:183], v167 offset:13312
ds_read_b64_tr_b16 v[184:185], v173 offset:12288
ds_read_b64_tr_b16 v[186:187], v173 offset:13312
ds_read_b64_tr_b16 v[188:189], v168 offset:12288
ds_read_b64_tr_b16 v[190:191], v168 offset:13312
s_waitcnt vmcnt(8) lgkmcnt(0)
v_mfma_f32_16x16x32_bf16 v[0:3], v[192:195], v[64:67], v[0:3]
s_add_u32 s45, s69, s63
v_add_u32 v166, s45, v164
v_mov_b32 v167, 160520
s_lshl_b32 s45, 1, s41
v_mfma_f32_16x16x32_bf16 v[4:7], v[196:199], v[64:67], v[4:7]
v_mov_b32 v173, s45
s_xor_b32 s46, s41, 1
v_add_u32 v144, s63, v164
v_add_u32 v145, 102400, v144
s_mov_b64 exec, s[4:5]
buffer_load_dwordx4 v[112:115], v164, s[20:23], s70 offen offset:2048
s_mov_b64 exec, -1
v_mfma_f32_16x16x32_bf16 v[8:11], v[200:203], v[64:67], v[8:11]
v_xor_b32 v146, 0x1000, v144
v_add_u32 v147, 102400, v146
v_mfma_f32_16x16x32_bf16 v[12:15], v[204:207], v[64:67], v[12:15]
s_mov_b64 exec, s[4:5]
buffer_load_dwordx4 v[116:119], v164, s[20:23], s71 offen offset:2048
s_mov_b64 exec, -1
v_mfma_f32_16x16x32_bf16 v[16:19], v[192:195], v[68:71], v[16:19]
ds_write_b128 v166, v[0:3] offset:0
v_mfma_f32_16x16x32_bf16 v[20:23], v[196:199], v[68:71], v[20:23]
s_mov_b64 exec, s[4:5]
buffer_load_dwordx4 v[120:123], v164, s[20:23], s72 offen offset:2048
s_mov_b64 exec, -1
ds_write_b128 v166, v[4:7] offset:1024
v_mfma_f32_16x16x32_bf16 v[24:27], v[200:203], v[68:71], v[24:27]
ds_write_b128 v166, v[8:11] offset:2048
v_mfma_f32_16x16x32_bf16 v[28:31], v[204:207], v[68:71], v[28:31]
s_mov_b64 exec, s[4:5]
buffer_load_dwordx4 v[124:127], v164, s[20:23], s73 offen offset:2048
s_mov_b64 exec, -1
ds_write_b128 v166, v[12:15] offset:3072
v_mfma_f32_16x16x32_bf16 v[32:35], v[192:195], v[72:75], v[32:35]
ds_write_b128 v166, v[16:19] offset:4096
v_mfma_f32_16x16x32_bf16 v[36:39], v[196:199], v[72:75], v[36:39]
s_mov_b64 exec, s[4:5]
buffer_load_dwordx4 v[128:131], v164, s[20:23], s70 offen offset:3072
s_mov_b64 exec, -1
ds_write_b128 v166, v[20:23] offset:5120
v_mfma_f32_16x16x32_bf16 v[40:43], v[200:203], v[72:75], v[40:43]
ds_write_b128 v166, v[24:27] offset:6144
v_mfma_f32_16x16x32_bf16 v[44:47], v[204:207], v[72:75], v[44:47]
s_mov_b64 exec, s[4:5]
buffer_load_dwordx4 v[132:135], v164, s[20:23], s71 offen offset:3072
s_mov_b64 exec, -1
ds_write_b128 v166, v[28:31] offset:7168
v_mfma_f32_16x16x32_bf16 v[48:51], v[192:195], v[76:79], v[48:51]
ds_write_b128 v166, v[32:35] offset:8192
v_mfma_f32_16x16x32_bf16 v[52:55], v[196:199], v[76:79], v[52:55]
s_mov_b64 exec, s[4:5]
buffer_load_dwordx4 v[136:139], v164, s[20:23], s72 offen offset:3072
s_mov_b64 exec, -1
ds_write_b128 v166, v[36:39] offset:9216
v_mfma_f32_16x16x32_bf16 v[56:59], v[200:203], v[76:79], v[56:59]
ds_write_b128 v166, v[40:43] offset:10240
v_mfma_f32_16x16x32_bf16 v[60:63], v[204:207], v[76:79], v[60:63]
s_mov_b64 exec, s[4:5]
buffer_load_dwordx4 v[140:143], v164, s[20:23], s73 offen offset:3072
s_mov_b64 exec, -1
ds_write_b128 v166, v[44:47] offset:11264
v_permlane16_swap_b32 v160, v162
v_permlane16_swap_b32 v161, v163
v_lshlrev_b32 v192, 16, v160
v_and_b32 v193, s58, v160
ds_write_b128 v166, v[48:51] offset:12288
ds_write_b128 v166, v[52:55] offset:13312
ds_write_b128 v166, v[56:59] offset:14336
ds_write_b128 v166, v[60:63] offset:15360
v_lshlrev_b32 v194, 16, v161
v_and_b32 v195, s58, v161
v_lshlrev_b32 v196, 16, v162
v_and_b32 v197, s58, v162
v_lshlrev_b32 v198, 16, v163
v_and_b32 v199, s58, v163
s_waitcnt lgkmcnt(0)
s_mov_b64 exec, 1
ds_or_b32 v167, v173 offset:0
s_mov_b64 exec, -1
s_cmp_lg_u32 s83, 0
s_cbranch_scc1 L_oz
s_waitcnt lgkmcnt(0)
s_xor_b64 s[24:25], s[24:25], s[64:65]
s_xor_b64 s[26:27], s[26:27], s[64:65]
s_xor_b64 s[28:29], s[28:29], s[64:65]
s_xor_b64 s[30:31], s[30:31], s[64:65]
s_xor_b64 s[32:33], s[32:33], s[64:65]
s_xor_b64 s[34:35], s[34:35], s[64:65]
s_xor_b64 s[48:49], s[48:49], s[64:65]
s_xor_b64 s[50:51], s[50:51], s[64:65]
s_or_b64 s[24:25], s[24:25], s[26:27]
s_or_b64 s[24:25], s[24:25], s[28:29]
s_or_b64 s[24:25], s[24:25], s[30:31]
s_or_b64 s[24:25], s[24:25], s[32:33]
s_or_b64 s[24:25], s[24:25], s[34:35]
s_or_b64 s[24:25], s[24:25], s[48:49]
s_or_b64 s[24:25], s[24:25], s[50:51]
s_mov_b32 s83, 2
s_cbranch_scc0 L_oy
s_load_dwordx2 s[24:25], s[52:53], 32768
s_load_dwordx2 s[26:27], s[52:53], 32784
s_load_dwordx2 s[28:29], s[52:53], 32800
s_load_dwordx2 s[30:31], s[52:53], 32816
s_load_dwordx2 s[32:33], s[52:53], 32832
s_load_dwordx2 s[34:35], s[52:53], 32848
s_load_dwordx2 s[48:49], s[52:53], 32864
s_load_dwordx2 s[50:51], s[52:53], 32880
s_waitcnt lgkmcnt(0)
s_xor_b64 s[24:25], s[24:25], s[64:65]
s_xor_b64 s[26:27], s[26:27], s[64:65]
s_xor_b64 s[28:29], s[28:29], s[64:65]
s_xor_b64 s[30:31], s[30:31], s[64:65]
s_xor_b64 s[32:33], s[32:33], s[64:65]
s_xor_b64 s[34:35], s[34:35], s[64:65]
s_xor_b64 s[48:49], s[48:49], s[64:65]
s_xor_b64 s[50:51], s[50:51], s[64:65]
s_or_b64 s[24:25], s[24:25], s[26:27]
s_or_b64 s[24:25], s[24:25], s[28:29]
s_or_b64 s[24:25], s[24:25], s[30:31]
s_or_b64 s[24:25], s[24:25], s[32:33]
s_or_b64 s[24:25], s[24:25], s[34:35]
s_or_b64 s[24:25], s[24:25], s[48:49]
s_or_b64 s[24:25], s[24:25], s[50:51]
s_mov_b32 s83, 3
s_cbranch_scc0 L_oy
s_load_dwordx2 s[24:25], s[52:53], 49152
s_load_dwordx2 s[26:27], s[52:53], 49168
s_load_dwordx2 s[28:29], s[52:53], 49184
s_load_dwordx2 s[30:31], s[52:53], 49200
s_load_dwordx2 s[32:33], s[52:53], 49216
s_load_dwordx2 s[34:35], s[52:53], 49232
s_load_dwordx2 s[48:49], s[52:53], 49248
s_load_dwordx2 s[50:51], s[52:53], 49264
s_waitcnt lgkmcnt(0)
s_xor_b64 s[24:25], s[24:25], s[64:65]
s_xor_b64 s[26:27], s[26:27], s[64:65]
s_xor_b64 s[28:29], s[28:29], s[64:65]
s_xor_b64 s[30:31], s[30:31], s[64:65]
s_xor_b64 s[32:33], s[32:33], s[64:65]
s_xor_b64 s[34:35], s[34:35], s[64:65]
s_xor_b64 s[48:49], s[48:49], s[64:65]
s_xor_b64 s[50:51], s[50:51], s[64:65]
s_or_b64 s[24:25], s[24:25], s[26:27]
s_or_b64 s[24:25], s[24:25], s[28:29]
s_or_b64 s[24:25], s[24:25], s[30:31]
s_or_b64 s[24:25], s[24:25], s[32:33]
s_or_b64 s[24:25], s[24:25], s[34:35]
s_or_b64 s[24:25], s[24:25], s[48:49]
s_or_b64 s[24:25], s[24:25], s[50:51]
s_mov_b32 s83, 4
s_cbranch_scc0 L_oy
L_pollo:
s_mov_b64 exec, 0xff
buffer_load_dwordx2 v[156:157], v164, s[20:23], s66 offen sc0 sc1
s_mov_b64 exec, -1
s_waitcnt vmcnt(0)
s_sub_u32 s74, s74, 1
s_cmp_lt_i32 s74, 0
s_cbranch_scc1 L_pollo_x
v_cmp_eq_u64 vcc, s[64:65], v[156:157]
s_and_b32 s45, vcc_lo, 0xff
s_cmp_eq_u32 s45, 0xff
s_cbranch_scc0 L_pollo
L_pollo_x:
L_oy:
buffer_load_dwordx4 v[80:83], v164, s[20:23], s70 offen offset:0
buffer_load_dwordx4 v[84:87], v164, s[20:23], s71 offen offset:0
buffer_load_dwordx4 v[88:91], v164, s[20:23], s72 offen offset:0
buffer_load_dwordx4 v[92:95], v164, s[20:23], s73 offen offset:0
buffer_load_dwordx4 v[96:99], v164, s[20:23], s70 offen offset:1024
buffer_load_dwordx4 v[100:103], v164, s[20:23], s71 offen offset:1024
buffer_load_dwordx4 v[104:107], v164, s[20:23], s72 offen offset:1024
buffer_load_dwordx4 v[108:111], v164, s[20:23], s73 offen offset:1024
buffer_load_dwordx4 v[112:115], v164, s[20:23], s70 offen offset:2048
buffer_load_dwordx4 v[116:119], v164, s[20:23], s71 offen offset:2048
buffer_load_dwordx4 v[120:123], v164, s[20:23], s72 offen offset:2048
buffer_load_dwordx4 v[124:127], v164, s[20:23], s73 offen offset:2048
buffer_load_dwordx4 v[128:131], v164, s[20:23], s70 offen offset:3072
buffer_load_dwordx4 v[132:135], v164, s[20:23], s71 offen offset:3072
buffer_load_dwordx4 v[136:139], v164, s[20:23], s72 offen offset:3072
buffer_load_dwordx4 v[140:143], v164, s[20:23], s73 offen offset:3072
L_oz:
s_waitcnt vmcnt(12)
v_mfma_f32_16x16x32_bf16 v[0:3], v[208:211], v[80:83], 0
v_mfma_f32_16x16x32_bf16 v[4:7], v[212:215], v[80:83], 0
v_mfma_f32_16x16x32_bf16 v[8:11], v[216:219], v[80:83], 0
v_mfma_f32_16x16x32_bf16 v[12:15], v[220:223], v[80:83], 0
v_mfma_f32_16x16x32_bf16 v[16:19], v[208:211], v[84:87], 0
v_mfma_f32_16x16x32_bf16 v[20:23], v[212:215], v[84:87], 0
v_mfma_f32_16x16x32_bf16 v[24:27], v[216:219], v[84:87], 0
v_mfma_f32_16x16x32_bf16 v[28:31], v[220:223], v[84:87], 0
v_mfma_f32_16x16x32_bf16 v[32:35], v[208:211], v[88:91], 0
v_mfma_f32_16x16x32_bf16 v[36:39], v[212:215], v[88:91], 0
v_mfma_f32_16x16x32_bf16 v[40:43], v[216:219], v[88:91], 0
v_mfma_f32_16x16x32_bf16 v[44:47], v[220:223], v[88:91], 0
v_mfma_f32_16x16x32_bf16 v[48:51], v[208:211], v[92:95], 0
v_mfma_f32_16x16x32_bf16 v[52:55], v[212:215], v[92:95], 0
v_mfma_f32_16x16x32_bf16 v[56:59], v[216:219], v[92:95], 0
v_mfma_f32_16x16x32_bf16 v[60:63], v[220:223], v[92:95], 0
s_waitcnt vmcnt(8)
v_mfma_f32_16x16x32_bf16 v[0:3], v[224:227], v[96:99], v[0:3]
s_xor_b32 s45, s40, 4
v_mfma_f32_16x16x32_bf16 v[4:7], v[228:231], v[96:99], v[4:7]
s_lshl_b32 s45, s45, 11
v_mfma_f32_16x16x32_bf16 v[8:11], v[232:235], v[96:99], v[8:11]
s_add_u32 s45, s45, 32768
v_mfma_f32_16x16x32_bf16 v[12:15], v[236:239], v[96:99], v[12:15]
v_add_u32 v148, s45, v164
v_mfma_f32_16x16x32_bf16 v[16:19], v[224:227], v[100:103], v[16:19]
v_xor_b32 v149, 0x800, v148
v_mfma_f32_16x16x32_bf16 v[20:23], v[228:231], v[100:103], v[20:23]
v_xor_b32 v150, 0x1000, v148
v_mfma_f32_16x16x32_bf16 v[24:27], v[232:235], v[100:103], v[24:27]
v_xor_b32 v151, 0x1800, v148
v_mfma_f32_16x16x32_bf16 v[28:31], v[236:239], v[100:103], v[28:31]
s_andn2_b32 s45, 1, s40
v_mfma_f32_16x16x32_bf16 v[32:35], v[224:227], v[104:107], v[32:35]
s_lshl_b32 s45, s45, 12
v_mfma_f32_16x16x32_bf16 v[36:39], v[228:231], v[104:107], v[36:39]
s_and_b32 s47, s40, 2
v_mfma_f32_16x16x32_bf16 v[40:43], v[232:235], v[104:107], v[40:43]
s_lshl_b32 s47, s47, 10
v_mfma_f32_16x16x32_bf16 v[44:47], v[236:239], v[104:107], v[44:47]
s_add_u32 s45, s45, s47
v_mfma_f32_16x16x32_bf16 v[48:51], v[224:227], v[108:111], v[48:51]
s_mul_i32 s47, s42, 102400
v_mfma_f32_16x16x32_bf16 v[52:55], v[228:231], v[108:111], v[52:55]
s_add_u32 s45, s45, s47
v_mfma_f32_16x16x32_bf16 v[56:59], v[232:235], v[108:111], v[56:59]
v_add_u32 v154, s45, v164
v_mfma_f32_16x16x32_bf16 v[60:63], v[236:239], v[108:111], v[60:63]
v_xor_b32 v155, 0x800, v154
s_waitcnt vmcnt(4)
v_mfma_f32_16x16x32_bf16 v[0:3], v[240:243], v[112:115], v[0:3]
v_mfma_f32_16x16x32_bf16 v[4:7], v[244:247], v[112:115], v[4:7]
v_mfma_f32_16x16x32_bf16 v[8:11], v[248:251], v[112:115], v[8:11]
v_mfma_f32_16x16x32_bf16 v[12:15], v[252:255], v[112:115], v[12:15]
v_mfma_f32_16x16x32_bf16 v[16:19], v[240:243], v[116:119], v[16:19]
v_mfma_f32_16x16x32_bf16 v[20:23], v[244:247], v[116:119], v[20:23]
v_mfma_f32_16x16x32_bf16 v[24:27], v[248:251], v[116:119], v[24:27]
v_mfma_f32_16x16x32_bf16 v[28:31], v[252:255], v[116:119], v[28:31]
v_mfma_f32_16x16x32_bf16 v[32:35], v[240:243], v[120:123], v[32:35]
v_mfma_f32_16x16x32_bf16 v[36:39], v[244:247], v[120:123], v[36:39]
v_mfma_f32_16x16x32_bf16 v[40:43], v[248:251], v[120:123], v[40:43]
v_mfma_f32_16x16x32_bf16 v[44:47], v[252:255], v[120:123], v[44:47]
v_mfma_f32_16x16x32_bf16 v[48:51], v[240:243], v[124:127], v[48:51]
v_mfma_f32_16x16x32_bf16 v[52:55], v[244:247], v[124:127], v[52:55]
v_mfma_f32_16x16x32_bf16 v[56:59], v[248:251], v[124:127], v[56:59]
v_mfma_f32_16x16x32_bf16 v[60:63], v[252:255], v[124:127], v[60:63]
s_waitcnt vmcnt(0)
v_mfma_f32_16x16x32_bf16 v[8:11], v[184:187], v[128:131], v[8:11]
v_mfma_f32_16x16x32_bf16 v[12:15], v[188:191], v[128:131], v[12:15]
v_mfma_f32_16x16x32_bf16 v[24:27], v[184:187], v[132:135], v[24:27]
v_mfma_f32_16x16x32_bf16 v[28:31], v[188:191], v[132:135], v[28:31]
v_mfma_f32_16x16x32_bf16 v[40:43], v[184:187], v[136:139], v[40:43]
v_mfma_f32_16x16x32_bf16 v[44:47], v[188:191], v[136:139], v[44:47]
v_mfma_f32_16x16x32_bf16 v[56:59], v[184:187], v[140:143], v[56:59]
v_mfma_f32_16x16x32_bf16 v[60:63], v[188:191], v[140:143], v[60:63]
v_mfma_f32_16x16x32_bf16 v[0:3], v[176:179], v[128:131], v[0:3]
ds_write_b128 v144, v[8:11] offset:0
v_mfma_f32_16x16x32_bf16 v[4:7], v[180:183], v[128:131], v[4:7]
ds_write_b128 v144, v[12:15] offset:1024
v_mfma_f32_16x16x32_bf16 v[16:19], v[176:179], v[132:135], v[16:19]
ds_write_b128 v144, v[24:27] offset:2048
v_mfma_f32_16x16x32_bf16 v[20:23], v[180:183], v[132:135], v[20:23]
ds_write_b128 v144, v[28:31] offset:3072
v_mfma_f32_16x16x32_bf16 v[32:35], v[176:179], v[136:139], v[32:35]
ds_write_b128 v145, v[40:43] offset:0
v_mfma_f32_16x16x32_bf16 v[36:39], v[180:183], v[136:139], v[36:39]
ds_write_b128 v145, v[44:47] offset:1024
v_mfma_f32_16x16x32_bf16 v[48:51], v[176:179], v[140:143], v[48:51]
ds_write_b128 v145, v[56:59] offset:2048
v_mfma_f32_16x16x32_bf16 v[52:55], v[180:183], v[140:143], v[52:55]
ds_write_b128 v145, v[60:63] offset:3072
s_waitcnt lgkmcnt(0)
s_mov_b64 exec, 1
ds_or_b32 v167, v173 offset:4
s_mov_b64 exec, -1
L_sp1:
ds_read_b32 v168, v167 offset:4
s_sub_u32 s74, s74, 1
s_cmp_lt_i32 s74, 0
s_waitcnt lgkmcnt(0)
s_cbranch_scc1 L_sp1_x
v_readfirstlane_b32 s45, v168
s_bitcmp1_b32 s45, s46
s_cbranch_scc0 L_sp1
L_sp1_x:
ds_read_b128 v[80:83], v146 offset:0
ds_read_b128 v[84:87], v146 offset:1024
ds_read_b128 v[88:91], v146 offset:2048
ds_read_b128 v[92:95], v146 offset:3072
ds_read_b128 v[96:99], v147 offset:0
ds_read_b128 v[100:103], v147 offset:1024
ds_read_b128 v[104:107], v147 offset:2048
ds_read_b128 v[108:111], v147 offset:3072
s_waitcnt lgkmcnt(6)
v_pk_add_f32 v[0:1], v[0:1], v[80:81]
v_pk_add_f32 v[2:3], v[2:3], v[82:83]
v_pk_add_f32 v[4:5], v[4:5], v[84:85]
v_pk_add_f32 v[6:7], v[6:7], v[86:87]
ds_write_b128 v146, v[0:3] offset:0
ds_write_b128 v146, v[4:7] offset:1024
s_waitcnt lgkmcnt(6)
v_pk_add_f32 v[16:17], v[16:17], v[88:89]
v_pk_add_f32 v[18:19], v[18:19], v[90:91]
v_pk_add_f32 v[20:21], v[20:21], v[92:93]
v_pk_add_f32 v[22:23], v[22:23], v[94:95]
ds_write_b128 v146, v[16:19] offset:2048
ds_write_b128 v146, v[20:23] offset:3072
s_waitcnt lgkmcnt(6)
v_pk_add_f32 v[32:33], v[32:33], v[96:97]
v_pk_add_f32 v[34:35], v[34:35], v[98:99]
v_pk_add_f32 v[36:37], v[36:37], v[100:101]
v_pk_add_f32 v[38:39], v[38:39], v[102:103]
ds_write_b128 v147, v[32:35] offset:0
ds_write_b128 v147, v[36:39] offset:1024
s_waitcnt lgkmcnt(6)
v_pk_add_f32 v[48:49], v[48:49], v[104:105]
v_pk_add_f32 v[50:51], v[50:51], v[106:107]
v_pk_add_f32 v[52:53], v[52:53], v[108:109]
v_pk_add_f32 v[54:55], v[54:55], v[110:111]
ds_write_b128 v147, v[48:51] offset:2048
ds_write_b128 v147, v[52:55] offset:3072
s_branch L_fin
L_lw:
s_waitcnt vmcnt(4)
v_mfma_f32_16x16x32_bf16 v[0:3], v[176:179], v[64:67], 0
v_add_u32 v166, 102400, v169
v_mfma_f32_16x16x32_bf16 v[4:7], v[180:183], v[64:67], 0
v_add_u32 v167, 102400, v170
buffer_load_dwordx4 v[96:99], v164, s[20:23], s8 offen offset:2048
v_mfma_f32_16x16x32_bf16 v[8:11], v[184:187], v[64:67], 0
v_add_u32 v173, 102400, v171
v_mfma_f32_16x16x32_bf16 v[12:15], v[188:191], v[64:67], 0
v_add_u32 v168, 102400, v172
v_mfma_f32_16x16x32_bf16 v[16:19], v[176:179], v[68:71], 0
v_mfma_f32_16x16x32_bf16 v[20:23], v[180:183], v[68:71], 0
buffer_load_dwordx4 v[100:103], v164, s[20:23], s9 offen offset:2048
v_mfma_f32_16x16x32_bf16 v[24:27], v[184:187], v[68:71], 0
v_mfma_f32_16x16x32_bf16 v[28:31], v[188:191], v[68:71], 0
v_mfma_f32_16x16x32_bf16 v[32:35], v[176:179], v[72:75], 0
v_mfma_f32_16x16x32_bf16 v[36:39], v[180:183], v[72:75], 0
buffer_load_dwordx4 v[104:107], v164, s[20:23], s10 offen offset:2048
v_mfma_f32_16x16x32_bf16 v[40:43], v[184:187], v[72:75], 0
v_mfma_f32_16x16x32_bf16 v[44:47], v[188:191], v[72:75], 0
v_mfma_f32_16x16x32_bf16 v[48:51], v[176:179], v[76:79], 0
v_mfma_f32_16x16x32_bf16 v[52:55], v[180:183], v[76:79], 0
buffer_load_dwordx4 v[108:111], v164, s[20:23], s11 offen offset:2048
v_mfma_f32_16x16x32_bf16 v[56:59], v[184:187], v[76:79], 0
v_mfma_f32_16x16x32_bf16 v[60:63], v[188:191], v[76:79], 0
ds_read_b64_tr_b16 v[176:177], v166 offset:0
ds_read_b64_tr_b16 v[178:179], v166 offset:1024
ds_read_b64_tr_b16 v[180:181], v167 offset:0
ds_read_b64_tr_b16 v[182:183], v167 offset:1024
ds_read_b64_tr_b16 v[184:185], v173 offset:0
ds_read_b64_tr_b16 v[186:187], v173 offset:1024
ds_read_b64_tr_b16 v[188:189], v168 offset:0
ds_read_b64_tr_b16 v[190:191], v168 offset:1024
s_waitcnt vmcnt(4)
v_mfma_f32_16x16x32_bf16 v[0:3], v[192:195], v[80:83], v[0:3]
v_mfma_f32_16x16x32_bf16 v[4:7], v[196:199], v[80:83], v[4:7]
buffer_load_dwordx4 v[112:115], v164, s[20:23], s8 offen offset:3072
v_mfma_f32_16x16x32_bf16 v[8:11], v[200:203], v[80:83], v[8:11]
v_mfma_f32_16x16x32_bf16 v[12:15], v[204:207], v[80:83], v[12:15]
v_mfma_f32_16x16x32_bf16 v[16:19], v[192:195], v[84:87], v[16:19]
v_mfma_f32_16x16x32_bf16 v[20:23], v[196:199], v[84:87], v[20:23]
buffer_load_dwordx4 v[116:119], v164, s[20:23], s9 offen offset:3072
v_mfma_f32_16x16x32_bf16 v[24:27], v[200:203], v[84:87], v[24:27]
v_mfma_f32_16x16x32_bf16 v[28:31], v[204:207], v[84:87], v[28:31]
v_mfma_f32_16x16x32_bf16 v[32:35], v[192:195], v[88:91], v[32:35]
v_mfma_f32_16x16x32_bf16 v[36:39], v[196:199], v[88:91], v[36:39]
buffer_load_dwordx4 v[120:123], v164, s[20:23], s10 offen offset:3072
v_mfma_f32_16x16x32_bf16 v[40:43], v[200:203], v[88:91], v[40:43]
v_mfma_f32_16x16x32_bf16 v[44:47], v[204:207], v[88:91], v[44:47]
v_mfma_f32_16x16x32_bf16 v[48:51], v[192:195], v[92:95], v[48:51]
v_mfma_f32_16x16x32_bf16 v[52:55], v[196:199], v[92:95], v[52:55]
buffer_load_dwordx4 v[124:127], v164, s[20:23], s11 offen offset:3072
v_mfma_f32_16x16x32_bf16 v[56:59], v[200:203], v[92:95], v[56:59]
v_mfma_f32_16x16x32_bf16 v[60:63], v[204:207], v[92:95], v[60:63]
ds_read_b64_tr_b16 v[192:193], v169 offset:0
ds_read_b64_tr_b16 v[194:195], v169 offset:1024
ds_read_b64_tr_b16 v[196:197], v170 offset:0
ds_read_b64_tr_b16 v[198:199], v170 offset:1024
ds_read_b64_tr_b16 v[200:201], v171 offset:0
ds_read_b64_tr_b16 v[202:203], v171 offset:1024
ds_read_b64_tr_b16 v[204:205], v172 offset:0
ds_read_b64_tr_b16 v[206:207], v172 offset:1024
s_waitcnt vmcnt(4)
v_mfma_f32_16x16x32_bf16 v[0:3], v[208:211], v[96:99], v[0:3]
s_add_u32 s45, s69, s63
v_mfma_f32_16x16x32_bf16 v[4:7], v[212:215], v[96:99], v[4:7]
v_add_u32 v166, s45, v164
buffer_load_dwordx4 v[128:131], v164, s[20:23], s12 offen offset:0
v_mfma_f32_16x16x32_bf16 v[8:11], v[216:219], v[96:99], v[8:11]
v_mov_b32 v167, 160520
v_mfma_f32_16x16x32_bf16 v[12:15], v[220:223], v[96:99], v[12:15]
v_mfma_f32_16x16x32_bf16 v[16:19], v[208:211], v[100:103], v[16:19]
v_mfma_f32_16x16x32_bf16 v[20:23], v[212:215], v[100:103], v[20:23]
buffer_load_dwordx4 v[132:135], v164, s[20:23], s13 offen offset:0
v_mfma_f32_16x16x32_bf16 v[24:27], v[216:219], v[100:103], v[24:27]
v_mfma_f32_16x16x32_bf16 v[28:31], v[220:223], v[100:103], v[28:31]
v_mfma_f32_16x16x32_bf16 v[32:35], v[208:211], v[104:107], v[32:35]
v_mfma_f32_16x16x32_bf16 v[36:39], v[212:215], v[104:107], v[36:39]
buffer_load_dwordx4 v[136:139], v164, s[20:23], s14 offen offset:0
v_mfma_f32_16x16x32_bf16 v[40:43], v[216:219], v[104:107], v[40:43]
v_mfma_f32_16x16x32_bf16 v[44:47], v[220:223], v[104:107], v[44:47]
v_mfma_f32_16x16x32_bf16 v[48:51], v[208:211], v[108:111], v[48:51]
v_mfma_f32_16x16x32_bf16 v[52:55], v[212:215], v[108:111], v[52:55]
buffer_load_dwordx4 v[140:143], v164, s[20:23], s15 offen offset:0
v_mfma_f32_16x16x32_bf16 v[56:59], v[216:219], v[108:111], v[56:59]
v_mfma_f32_16x16x32_bf16 v[60:63], v[220:223], v[108:111], v[60:63]
s_waitcnt vmcnt(4)
v_mfma_f32_16x16x32_bf16 v[0:3], v[224:227], v[112:115], v[0:3]
v_mfma_f32_16x16x32_bf16 v[4:7], v[228:231], v[112:115], v[4:7]
buffer_load_dwordx4 v[144:147], v164, s[20:23], s16 offen offset:0
v_mfma_f32_16x16x32_bf16 v[8:11], v[232:235], v[112:115], v[8:11]
v_mfma_f32_16x16x32_bf16 v[12:15], v[236:239], v[112:115], v[12:15]
v_mfma_f32_16x16x32_bf16 v[16:19], v[224:227], v[116:119], v[16:19]
v_mfma_f32_16x16x32_bf16 v[20:23], v[228:231], v[116:119], v[20:23]
buffer_load_dwordx4 v[148:151], v164, s[20:23], s17 offen offset:0
v_mfma_f32_16x16x32_bf16 v[24:27], v[232:235], v[116:119], v[24:27]
v_mfma_f32_16x16x32_bf16 v[28:31], v[236:239], v[116:119], v[28:31]
v_mfma_f32_16x16x32_bf16 v[32:35], v[224:227], v[120:123], v[32:35]
v_mfma_f32_16x16x32_bf16 v[36:39], v[228:231], v[120:123], v[36:39]
buffer_load_dwordx4 v[152:155], v164, s[20:23], s18 offen offset:0
v_mfma_f32_16x16x32_bf16 v[40:43], v[232:235], v[120:123], v[40:43]
v_mfma_f32_16x16x32_bf16 v[44:47], v[236:239], v[120:123], v[44:47]
v_mfma_f32_16x16x32_bf16 v[48:51], v[224:227], v[124:127], v[48:51]
v_mfma_f32_16x16x32_bf16 v[52:55], v[228:231], v[124:127], v[52:55]
buffer_load_dwordx4 v[156:159], v164, s[20:23], s19 offen offset:0
v_mfma_f32_16x16x32_bf16 v[56:59], v[232:235], v[124:127], v[56:59]
v_mfma_f32_16x16x32_bf16 v[60:63], v[236:239], v[124:127], v[60:63]
s_waitcnt vmcnt(4)
v_mfma_f32_16x16x32_bf16 v[0:3], v[240:243], v[128:131], v[0:3]
v_mfma_f32_16x16x32_bf16 v[4:7], v[244:247], v[128:131], v[4:7]
buffer_load_dwordx4 v[64:67], v164, s[20:23], s16 offen offset:1024
v_mfma_f32_16x16x32_bf16 v[8:11], v[248:251], v[128:131], v[8:11]
v_mfma_f32_16x16x32_bf16 v[12:15], v[252:255], v[128:131], v[12:15]
v_mfma_f32_16x16x32_bf16 v[16:19], v[240:243], v[132:135], v[16:19]
v_mfma_f32_16x16x32_bf16 v[20:23], v[244:247], v[132:135], v[20:23]
buffer_load_dwordx4 v[68:71], v164, s[20:23], s17 offen offset:1024
v_mfma_f32_16x16x32_bf16 v[24:27], v[248:251], v[132:135], v[24:27]
v_mfma_f32_16x16x32_bf16 v[28:31], v[252:255], v[132:135], v[28:31]
v_mfma_f32_16x16x32_bf16 v[32:35], v[240:243], v[136:139], v[32:35]
v_mfma_f32_16x16x32_bf16 v[36:39], v[244:247], v[136:139], v[36:39]
buffer_load_dwordx4 v[72:75], v164, s[20:23], s18 offen offset:1024
v_mfma_f32_16x16x32_bf16 v[40:43], v[248:251], v[136:139], v[40:43]
v_mfma_f32_16x16x32_bf16 v[44:47], v[252:255], v[136:139], v[44:47]
v_mfma_f32_16x16x32_bf16 v[48:51], v[240:243], v[140:143], v[48:51]
v_mfma_f32_16x16x32_bf16 v[52:55], v[244:247], v[140:143], v[52:55]
buffer_load_dwordx4 v[76:79], v164, s[20:23], s19 offen offset:1024
v_mfma_f32_16x16x32_bf16 v[56:59], v[248:251], v[140:143], v[56:59]
v_mfma_f32_16x16x32_bf16 v[60:63], v[252:255], v[140:143], v[60:63]
s_waitcnt vmcnt(4) lgkmcnt(0)
v_mfma_f32_16x16x32_bf16 v[0:3], v[176:179], v[144:147], v[0:3]
v_mfma_f32_16x16x32_bf16 v[4:7], v[180:183], v[144:147], v[4:7]
v_mfma_f32_16x16x32_bf16 v[8:11], v[184:187], v[144:147], v[8:11]
v_mfma_f32_16x16x32_bf16 v[12:15], v[188:191], v[144:147], v[12:15]
v_mfma_f32_16x16x32_bf16 v[16:19], v[176:179], v[148:151], v[16:19]
v_mfma_f32_16x16x32_bf16 v[20:23], v[180:183], v[148:151], v[20:23]
v_mfma_f32_16x16x32_bf16 v[24:27], v[184:187], v[148:151], v[24:27]
v_mfma_f32_16x16x32_bf16 v[28:31], v[188:191], v[148:151], v[28:31]
v_mfma_f32_16x16x32_bf16 v[32:35], v[176:179], v[152:155], v[32:35]
v_mfma_f32_16x16x32_bf16 v[36:39], v[180:183], v[152:155], v[36:39]
v_mfma_f32_16x16x32_bf16 v[40:43], v[184:187], v[152:155], v[40:43]
v_mfma_f32_16x16x32_bf16 v[44:47], v[188:191], v[152:155], v[44:47]
v_mfma_f32_16x16x32_bf16 v[48:51], v[176:179], v[156:159], v[48:51]
v_mfma_f32_16x16x32_bf16 v[52:55], v[180:183], v[156:159], v[52:55]
v_mfma_f32_16x16x32_bf16 v[56:59], v[184:187], v[156:159], v[56:59]
v_mfma_f32_16x16x32_bf16 v[60:63], v[188:191], v[156:159], v[60:63]
L_sp0:
ds_read_b32 v168, v167 offset:0
s_sub_u32 s74, s74, 1
s_cmp_lt_i32 s74, 0
s_waitcnt lgkmcnt(0)
s_cbranch_scc1 L_sp0_x
v_readfirstlane_b32 s45, v168
s_bitcmp1_b32 s45, s41
s_cbranch_scc0 L_sp0
L_sp0_x:
ds_read_b128 v[80:83], v166 offset:8192
ds_read_b128 v[84:87], v166 offset:9216
ds_read_b128 v[88:91], v166 offset:10240
ds_read_b128 v[92:95], v166 offset:11264
ds_read_b128 v[96:99], v166 offset:12288
ds_read_b128 v[100:103], v166 offset:13312
ds_read_b128 v[104:107], v166 offset:14336
ds_read_b128 v[108:111], v166 offset:15360
ds_read_b128 v[112:115], v166 offset:0
ds_read_b128 v[116:119], v166 offset:1024
ds_read_b128 v[120:123], v166 offset:2048
ds_read_b128 v[124:127], v166 offset:3072
ds_read_b128 v[128:131], v166 offset:4096
ds_read_b128 v[132:135], v166 offset:5120
ds_read_b128 v[136:139], v166 offset:6144
ds_read_b128 v[140:143], v166 offset:7168
s_waitcnt vmcnt(0)
v_mfma_f32_16x16x32_bf16 v[0:3], v[192:195], v[64:67], v[0:3]
s_xor_b32 s45, s40, 4
s_lshl_b32 s45, s45, 11
s_add_u32 s45, s45, 32768
v_add_u32 v148, s45, v164
v_mfma_f32_16x16x32_bf16 v[4:7], v[196:199], v[64:67], v[4:7]
v_xor_b32 v149, 0x800, v148
v_xor_b32 v150, 0x1000, v148
v_xor_b32 v151, 0x1800, v148
s_andn2_b32 s45, 1, s40
v_mfma_f32_16x16x32_bf16 v[8:11], v[200:203], v[64:67], v[8:11]
s_lshl_b32 s45, s45, 12
s_and_b32 s47, s40, 2
s_lshl_b32 s47, s47, 10
s_add_u32 s45, s45, s47
v_mfma_f32_16x16x32_bf16 v[12:15], v[204:207], v[64:67], v[12:15]
s_mul_i32 s47, s42, 102400
s_add_u32 s45, s45, s47
v_add_u32 v154, s45, v164
v_xor_b32 v155, 0x800, v154
v_mfma_f32_16x16x32_bf16 v[16:19], v[192:195], v[68:71], v[16:19]
s_waitcnt lgkmcnt(0)
v_pk_add_f32 v[0:1], v[0:1], v[80:81]
v_pk_add_f32 v[2:3], v[2:3], v[82:83]
ds_write_b128 v166, v[0:3] offset:0
v_mfma_f32_16x16x32_bf16 v[20:23], v[196:199], v[68:71], v[20:23]
v_pk_add_f32 v[4:5], v[4:5], v[84:85]
v_pk_add_f32 v[6:7], v[6:7], v[86:87]
ds_write_b128 v166, v[4:7] offset:1024
v_mfma_f32_16x16x32_bf16 v[24:27], v[200:203], v[68:71], v[24:27]
v_pk_add_f32 v[8:9], v[8:9], v[88:89]
v_pk_add_f32 v[10:11], v[10:11], v[90:91]
ds_write_b128 v166, v[8:11] offset:2048
v_mfma_f32_16x16x32_bf16 v[28:31], v[204:207], v[68:71], v[28:31]
v_pk_add_f32 v[12:13], v[12:13], v[92:93]
v_pk_add_f32 v[14:15], v[14:15], v[94:95]
ds_write_b128 v166, v[12:15] offset:3072
v_mfma_f32_16x16x32_bf16 v[32:35], v[192:195], v[72:75], v[32:35]
v_pk_add_f32 v[16:17], v[16:17], v[96:97]
v_pk_add_f32 v[18:19], v[18:19], v[98:99]
ds_write_b128 v166, v[16:19] offset:4096
v_mfma_f32_16x16x32_bf16 v[36:39], v[196:199], v[72:75], v[36:39]
v_pk_add_f32 v[20:21], v[20:21], v[100:101]
v_pk_add_f32 v[22:23], v[22:23], v[102:103]
ds_write_b128 v166, v[20:23] offset:5120
v_mfma_f32_16x16x32_bf16 v[40:43], v[200:203], v[72:75], v[40:43]
v_pk_add_f32 v[24:25], v[24:25], v[104:105]
v_pk_add_f32 v[26:27], v[26:27], v[106:107]
ds_write_b128 v166, v[24:27] offset:6144
v_mfma_f32_16x16x32_bf16 v[44:47], v[204:207], v[72:75], v[44:47]
v_pk_add_f32 v[28:29], v[28:29], v[108:109]
v_pk_add_f32 v[30:31], v[30:31], v[110:111]
ds_write_b128 v166, v[28:31] offset:7168
v_mfma_f32_16x16x32_bf16 v[48:51], v[192:195], v[76:79], v[48:51]
v_pk_add_f32 v[32:33], v[32:33], v[112:113]
v_pk_add_f32 v[34:35], v[34:35], v[114:115]
ds_write_b128 v166, v[32:35] offset:8192
v_mfma_f32_16x16x32_bf16 v[52:55], v[196:199], v[76:79], v[52:55]
v_pk_add_f32 v[36:37], v[36:37], v[116:117]
v_pk_add_f32 v[38:39], v[38:39], v[118:119]
ds_write_b128 v166, v[36:39] offset:9216
v_mfma_f32_16x16x32_bf16 v[56:59], v[200:203], v[76:79], v[56:59]
v_pk_add_f32 v[40:41], v[40:41], v[120:121]
v_pk_add_f32 v[42:43], v[42:43], v[122:123]
ds_write_b128 v166, v[40:43] offset:10240
v_mfma_f32_16x16x32_bf16 v[60:63], v[204:207], v[76:79], v[60:63]
v_pk_add_f32 v[44:45], v[44:45], v[124:125]
v_pk_add_f32 v[46:47], v[46:47], v[126:127]
ds_write_b128 v166, v[44:47] offset:11264
v_permlane16_swap_b32 v160, v162
v_permlane16_swap_b32 v161, v163
v_lshlrev_b32 v192, 16, v160
v_and_b32 v193, s58, v160
v_pk_add_f32 v[48:49], v[48:49], v[128:129]
v_pk_add_f32 v[50:51], v[50:51], v[130:131]
ds_write_b128 v166, v[48:51] offset:12288
v_pk_add_f32 v[52:53], v[52:53], v[132:133]
v_pk_add_f32 v[54:55], v[54:55], v[134:135]
ds_write_b128 v166, v[52:55] offset:13312
v_pk_add_f32 v[56:57], v[56:57], v[136:137]
v_pk_add_f32 v[58:59], v[58:59], v[138:139]
ds_write_b128 v166, v[56:59] offset:14336
v_pk_add_f32 v[60:61], v[60:61], v[140:141]
v_pk_add_f32 v[62:63], v[62:63], v[142:143]
ds_write_b128 v166, v[60:63] offset:15360
v_lshlrev_b32 v194, 16, v161
v_and_b32 v195, s58, v161
v_lshlrev_b32 v196, 16, v162
v_and_b32 v197, s58, v162
v_lshlrev_b32 v198, 16, v163
v_and_b32 v199, s58, v163
L_fin:
v_mul_f32 v174, v174, v174
v_rcp_f32 v175, v174
v_mul_f32 v174, 0xbfb8aa3b, v174
s_waitcnt lgkmcnt(0)
s_barrier
ds_read_b128 v[0:3], v148 offset:0
ds_read_b128 v[4:7], v148 offset:1024
ds_read_b128 v[8:11], v149 offset:16384
ds_read_b128 v[12:15], v149 offset:17408
ds_read_b128 v[16:19], v150 offset:32768
ds_read_b128 v[20:23], v150 offset:33792
ds_read_b128 v[24:27], v151 offset:49152
ds_read_b128 v[28:31], v151 offset:50176
ds_read_b128 v[32:35], v154 offset:0
ds_read_b128 v[36:39], v154 offset:1024
ds_read_b128 v[40:43], v155 offset:8192
ds_read_b128 v[44:47], v155 offset:9216
s_waitcnt lgkmcnt(8)
v_pk_add_f32 v[0:1], v[0:1], v[8:9]
v_pk_add_f32 v[2:3], v[2:3], v[10:11]
v_pk_add_f32 v[4:5], v[4:5], v[12:13]
v_pk_add_f32 v[6:7], v[6:7], v[14:15]
s_waitcnt lgkmcnt(4)
v_pk_add_f32 v[16:17], v[16:17], v[24:25]
v_pk_add_f32 v[18:19], v[18:19], v[26:27]
v_pk_add_f32 v[20:21], v[20:21], v[28:29]
v_pk_add_f32 v[22:23], v[22:23], v[30:31]
v_pk_add_f32 v[0:1], v[0:1], v[16:17]
v_pk_add_f32 v[2:3], v[2:3], v[18:19]
v_pk_add_f32 v[4:5], v[4:5], v[20:21]
v_pk_add_f32 v[6:7], v[6:7], v[22:23]
v_mul_f32 v8, v174, v0
v_mul_f32 v9, v174, v1
v_mul_f32 v10, v174, v2
v_mul_f32 v11, v174, v3
v_mul_f32 v12, v174, v4
v_mul_f32 v13, v174, v5
v_mul_f32 v14, v174, v6
v_mul_f32 v15, v174, v7
v_exp_f32 v8, v8
v_exp_f32 v9, v9
v_exp_f32 v10, v10
v_exp_f32 v11, v11
v_exp_f32 v12, v12
v_exp_f32 v13, v13
v_exp_f32 v14, v14
v_exp_f32 v15, v15
s_waitcnt lgkmcnt(0)
v_pk_add_f32 v[32:33], v[32:33], v[40:41]
v_pk_add_f32 v[34:35], v[34:35], v[42:43]
v_pk_add_f32 v[36:37], v[36:37], v[44:45]
v_pk_add_f32 v[38:39], v[38:39], v[46:47]
v_fma_f32 v8, v8, v175, v175
v_fma_f32 v9, v9, v175, v175
v_fma_f32 v10, v10, v175, v175
v_fma_f32 v11, v11, v175, v175
v_fma_f32 v12, v12, v175, v175
v_fma_f32 v13, v13, v175, v175
v_fma_f32 v14, v14, v175, v175
v_fma_f32 v15, v15, v175, v175
v_pk_mul_f32 v[0:1], v[0:1], v[32:33]
v_pk_mul_f32 v[2:3], v[2:3], v[34:35]
v_pk_mul_f32 v[4:5], v[4:5], v[36:37]
v_pk_mul_f32 v[6:7], v[6:7], v[38:39]
v_rcp_f32 v8, v8
v_rcp_f32 v9, v9
v_rcp_f32 v10, v10
v_rcp_f32 v11, v11
v_rcp_f32 v12, v12
v_rcp_f32 v13, v13
v_rcp_f32 v14, v14
v_rcp_f32 v15, v15
v_fmac_f32 v192, v0, v8
v_fmac_f32 v193, v1, v9
v_fmac_f32 v194, v2, v10
v_fmac_f32 v195, v3, v11
v_fmac_f32 v196, v4, v12
v_fmac_f32 v197, v5, v13
v_fmac_f32 v198, v6, v14
v_fmac_f32 v199, v7, v15
v_cvt_pk_bf16_f32 v16, v192, v193
v_cvt_pk_bf16_f32 v17, v194, v195
v_cvt_pk_bf16_f32 v18, v196, v197
v_cvt_pk_bf16_f32 v19, v198, v199
s_nop 0
v_permlane16_swap_b32 v16, v18
v_permlane16_swap_b32 v17, v19
buffer_store_dwordx4 v[16:19], v165, s[36:39], s67 offen
L_end:
s_endpgm
.section .rodata,"a"
.p2align 6
.amdhsa_kernel recurrent_scan__sliding_local_dilated__glu_gated_reglu__prompt_kernel
  .amdhsa_next_free_vgpr 256
  .amdhsa_next_free_sgpr 102
  .amdhsa_accum_offset 256
  .amdhsa_group_segment_fixed_size 0
  .amdhsa_kernarg_size 80
  .amdhsa_user_sgpr_count 2
  .amdhsa_user_sgpr_kernarg_segment_ptr 1
  .amdhsa_system_sgpr_workgroup_id_x 1
.end_amdhsa_kernel
```
